```python
import torch

def _softmax(x, axis=-1):
    return torch.softmax(x, dim=axis)
def _gelu(x):
    return torch.nn.functional.gelu(x, approximate="tanh")
def _silu(x):
    return torch.nn.functional.silu(x)
def _sigmoid(x):
    return torch.sigmoid(x)
def _layernorm(x, axis=-1, eps=1e-5):
    m = x.mean(dim=axis, keepdim=True)
    v = x.var(dim=axis, keepdim=True, unbiased=False)
    return (x - m) / torch.sqrt(v + eps)
def _scatter_add(tgt, idx, src, axis=0):
    return tgt.clone().index_add_(axis, idx, src)
def _segment_sum(src, seg, n):
    out = torch.zeros((n,) + src.shape[1:], dtype=src.dtype)
    return out.index_add_(0, seg, src)
def _pad(x, pw):
    flat = tuple(v for pair in reversed(pw) for v in pair)
    return torch.nn.functional.pad(x, flat)

kernel_name = 'sequential_preLN__sliding_block__dense_activation_silu__prompt'

def setup_inputs():

    _w = (lambda a: (lambda t: t.to(torch.bfloat16) if t.is_floating_point() else t)(torch.as_tensor(a)))
    def _A_setup():
        B, S, D = 1, 2048, 640
        return {
            "x": _w((lambda *s: torch.randn(*s, dtype=torch.bfloat16) * 0.05)(B, S, D)),
            "wqkv": _w((lambda *s: torch.randn(*s, dtype=torch.bfloat16) * 0.05)(D, 3 * D)),
            "wo": _w((lambda *s: torch.randn(*s, dtype=torch.bfloat16) * 0.05)(D, D)),
        }
    _A_in = _A_setup()

    def _B_setup():
        B, S, D, F = 1, 2048, 640, 1536
        return {
            "x": _w((lambda *s: torch.randn(*s, dtype=torch.bfloat16) * 0.05)(B, S, D)),
            "w1": _w((lambda *s: torch.randn(*s, dtype=torch.bfloat16) * 3.2)(D, F) * (D ** -0.5)),
            "w2": _w((lambda *s: torch.randn(*s, dtype=torch.bfloat16) * 0.4)(F, D) * (F ** -0.5)),
        }
    _B_in = _B_setup()

    return {
        "A_x": _A_in["x"],
        "A_wqkv": _A_in["wqkv"],
        "A_wo": _A_in["wo"],
        "B_x": _B_in["x"],
        "B_w1": _B_in["w1"],
        "B_w2": _B_in["w2"],
    }

def reference(A_x, A_wqkv, A_wo, B_x, B_w1, B_w2):
    def _A_ref(x, wqkv, wo):
        B, S, D = x.shape
        H = 32; Dh = D // H; W = 256
        qkv = (lambda x, *d: x.permute(*d))((x @ wqkv).reshape(B, S, 3, H, Dh), 2, 0, 3, 1, 4)
        q, k, v = qkv[0], qkv[1], qkv[2]
        scores = torch.einsum("bhqd,bhkd->bhqk", q, k) * (Dh ** -0.5)
        idx = torch.arange(S)
        mask = (idx[:, None] - idx[None, :] >= 0) & (idx[:, None] - idx[None, :] < W)
        scores = torch.where(mask[None, None], scores, -1e9)
        p = _softmax(scores, axis=-1)
        o = torch.einsum("bhqk,bhkd->bhqd", p, v)
        return (lambda x, *d: x.permute(*d))(o, 0, 2, 1, 3).reshape(B, S, D) @ wo

    def _B_ref(x, w1, w2):
        h = torch.einsum("bsd,df->bsf", x, w1)
        h = _silu(h)
        out = torch.einsum("bsf,fd->bsd", h, w2)
        return out

    x = A_x
    h = x + _A_ref(_layernorm(x, axis=-1), A_wqkv, A_wo)
    h2 = h + _B_ref(_layernorm(h, axis=-1), B_w1, B_w2)
    return h2
```

```asm
; @launch grid=(256,1,1) block=(256,1,1) lds=163840
.amdgcn_target "amdgcn-amd-amdhsa--gfx950"
.text
.globl sequential_preLN__sliding_block__dense_activation_silu__prompt_kernel
.p2align 8
.type sequential_preLN__sliding_block__dense_activation_silu__prompt_kernel,@function
sequential_preLN__sliding_block__dense_activation_silu__prompt_kernel:
    s_cmp_ge_u32 s2, 256
    s_cbranch_scc1 L_end
    s_load_dwordx16 s[64:79], s[0:1], 0
    s_load_dwordx2 s[80:81], s[0:1], 64
    v_and_b32 v1, 63, v0
    v_lshrrev_b32 v4, 6, v0
    v_and_b32 v2, 15, v1
    v_lshrrev_b32 v3, 4, v1
    v_readfirstlane_b32 s36, v4
    s_and_b32 s3, s2, 7
    s_lshr_b32 s41, s2, 3
    s_lshr_b32 s37, s3, 1
    s_lshl_b32 s37, s37, 2
    s_lshr_b32 s62, s41, 3
    s_add_u32 s37, s37, s62
    s_and_b32 s38, s3, 1
    s_lshl_b32 s38, s38, 3
    s_and_b32 s62, s41, 7
    s_add_u32 s38, s38, s62
    s_lshl_b32 s39, s3, 1
    s_lshr_b32 s62, s41, 4
    s_add_u32 s39, s39, s62
    s_and_b32 s40, s41, 15
    s_mov_b32 s63, 0
    s_getreg_b32 s98, hwreg(HW_REG_XCC_ID, 0, 4)
    s_mov_b32 s99, 0
    v_and_b32 v4, 1, v3
    v_cmp_eq_u32 s[84:85], 1, v4
    v_lshrrev_b32 v208, 3, v1
    v_lshrrev_b32 v209, 1, v208
    v_xor_b32 v209, v209, v1
    v_and_b32 v209, 7, v209
    s_lshl_b32 s44, s37, 7
    s_lshl_b32 s45, s36, 5
    s_add_u32 s44, s44, s45
    v_add_u32 v208, s44, v208
    v_mul_u32_u24 v208, 1280, v208
    v_lshl_add_u32 v10, v209, 4, v208
    v_xor_b32 v209, 4, v209
    v_lshl_add_u32 v11, v209, 4, v208
    v_add_u32 v11, 10240, v11
    s_lshr_b32 s44, s36, 1
    s_lshl_b32 s44, s44, 3
    v_and_b32 v208, 1, v3
    v_and_b32 v209, 2, v3
    v_lshl_or_b32 v208, v209, 1, v208
    v_or_b32 v208, s44, v208
    v_xor_b32 v208, v208, v2
    s_lshl_b32 s45, s36, 2
    v_add_u32 v209, s45, v3
    v_mul_u32_u24 v209, 3840, v209
    v_lshl_add_u32 v209, v208, 4, v209
    s_lshl_b32 s44, s38, 8
    v_add_u32 v12, s44, v209
    s_lshl_b32 s47, s36, 10
    s_lshl_b32 s48, s36, 12
    v_lshrrev_b32 v208, 2, v2
    v_and_b32 v209, 3, v1
    v_and_b32 v210, 1, v208
    v_and_b32 v211, 2, v208
    v_lshl_or_b32 v210, v211, 1, v210
    v_and_b32 v211, 1, v3
    v_lshl_or_b32 v210, v211, 3, v210
    v_lshl_add_u32 v208, v3, 3, v208
    v_lshlrev_b32 v208, 8, v208
    s_lshr_b32 s50, s36, 1
    s_and_b32 s45, s36, 1
    s_lshl_b32 s45, s45, 1
    s_xor_b32 s44, s50, 0
    s_add_u32 s44, s44, s45
    s_lshl_b32 s44, s44, 2
    v_add_u32 v211, s44, v209
    v_xor_b32 v211, v211, v210
    v_lshl_add_u32 v212, v211, 4, v208
    v_and_b32 v211, 1, v209
    v_lshl_add_u32 v4, v211, 3, v212
    v_and_b32 v211, 1, v209
    v_xor_b32 v211, 1, v211
    v_lshl_add_u32 v5, v211, 3, v212
    s_xor_b32 s44, s50, 1
    s_add_u32 s44, s44, s45
    s_lshl_b32 s44, s44, 2
    v_add_u32 v211, s44, v209
    v_xor_b32 v211, v211, v210
    v_lshl_add_u32 v212, v211, 4, v208
    v_and_b32 v211, 1, v209
    v_lshl_add_u32 v6, v211, 3, v212
    v_and_b32 v211, 1, v209
    v_xor_b32 v211, 1, v211
    v_lshl_add_u32 v7, v211, 3, v212
    v_lshrrev_b32 v208, 1, v2
    v_xor_b32 v208, v208, v3
    v_lshlrev_b32 v208, 4, v208
    v_lshl_add_u32 v8, v2, 7, v208
    v_xor_b32 v9, 64, v8
    s_lshl_b32 s44, s50, 13
    s_add_u32 s44, s44, 16384
    v_add_u32 v8, s44, v8
    v_add_u32 v9, s44, v9
    v_mov_b32 v20, 0x3f803f80
    v_mov_b32 v21, 0x3f803f80
    v_mov_b32 v22, 0x3f803f80
    v_mov_b32 v23, 0x3f803f80
    s_waitcnt lgkmcnt(0)
    s_mov_b32 s4, s64
    s_and_b32 s5, s65, 0xffff
    s_mov_b32 s6, 0x280000
    s_mov_b32 s7, 0x20000
    s_mov_b32 s8, s66
    s_and_b32 s9, s67, 0xffff
    s_mov_b32 s10, 0x258000
    s_mov_b32 s11, 0x20000
    s_mov_b32 s28, s80
    s_and_b32 s29, s81, 0xffff
    s_mov_b32 s30, 0x1b00000
    s_mov_b32 s31, 0x20000
    s_mov_b32 s32, s78
    s_and_b32 s33, s79, 0xffff
    s_mov_b32 s34, 0x100
    s_mov_b32 s35, 0x20000
    s_lshl_b32 s44, s2, 2
    s_or_b32 s44, s44, s36
    s_cmp_lg_u32 s44, 0
    s_cbranch_scc1 NP_3
    s_memrealtime s[44:45]
    s_waitcnt lgkmcnt(0)
    s_or_b32 s44, s44, 1
    v_mov_b32 v204, s44
    v_mov_b32 v205, s45
    v_mov_b32 v206, 0
    s_mov_b64 exec, 1
    buffer_store_dwordx2 v[204:205], v206, s[32:35], 0 offen sc1
    s_mov_b64 exec, -1
NP_3:
    s_cmp_eq_u32 s38, 15
    s_cbranch_scc1 HELP_1
    s_and_b32 s44, s37, 3
    s_mul_i32 s44, s44, 5
    s_and_b32 s45, s38, 7
    s_mul_i32 s45, s45, 5
    s_add_u32 s44, s44, s45
    s_lshr_b32 s44, s44, 1
    s_cmp_ge_u32 s44, 20
    s_cselect_b32 s45, 20, 0
    s_sub_u32 s44, s44, s45
    s_cmp_ge_u32 s44, 10
    s_cselect_b32 s45, 10, 0
    s_sub_u32 s44, s44, s45
    s_mul_i32 s86, s44, 245760
    s_lshl_b32 s87, s44, 7
    s_add_u32 m0, s47, 0x0
    s_add_u32 s62, s86, 0x0
    buffer_load_dwordx4 v12, s[8:11], s62 offen lds
    s_add_u32 m0, s47, 0x1000
    s_add_u32 s62, s86, 0xf000
    buffer_load_dwordx4 v12, s[8:11], s62 offen lds
    s_add_u32 m0, s48, 0x4000
    s_add_u32 s62, s87, 0
    buffer_load_dwordx4 v10, s[4:7], s62 offen lds
    s_add_u32 m0, s48, 0x4400
    s_add_u32 s62, s87, 0
    buffer_load_dwordx4 v11, s[4:7], s62 offen lds
    s_add_u32 m0, s47, 0x2000
    s_add_u32 s62, s86, 0x1e000
    buffer_load_dwordx4 v12, s[8:11], s62 offen lds
    s_add_u32 m0, s47, 0x3000
    s_add_u32 s62, s86, 0x2d000
    buffer_load_dwordx4 v12, s[8:11], s62 offen lds
    s_add_u32 m0, s48, 0x4800
    s_add_u32 s62, s87, 20480
    buffer_load_dwordx4 v10, s[4:7], s62 offen lds
    s_add_u32 m0, s48, 0x4c00
    s_add_u32 s62, s87, 20480
    buffer_load_dwordx4 v11, s[4:7], s62 offen lds
    s_add_u32 s86, s86, 245760
    s_add_u32 s87, s87, 128
    s_cmp_ge_u32 s87, 1280
    s_cselect_b32 s86, 0, s86
    s_cselect_b32 s87, 0, s87
    s_add_u32 m0, s47, 0x8000
    s_add_u32 s62, s86, 0x0
    buffer_load_dwordx4 v12, s[8:11], s62 offen lds
    s_add_u32 m0, s47, 0x9000
    s_add_u32 s62, s86, 0xf000
    buffer_load_dwordx4 v12, s[8:11], s62 offen lds
    s_add_u32 m0, s48, 0xc000
    s_add_u32 s62, s87, 0
    buffer_load_dwordx4 v10, s[4:7], s62 offen lds
    s_add_u32 m0, s48, 0xc400
    s_add_u32 s62, s87, 0
    buffer_load_dwordx4 v11, s[4:7], s62 offen lds
    s_mov_b32 s12, s68
    s_and_b32 s13, s69, 0xffff
    s_mov_b32 s14, 0xc8000
    s_mov_b32 s15, 0x20000
    s_mov_b32 s16, s72
    s_and_b32 s17, s73, 0xffff
    s_mov_b32 s18, 0x1e0000
    s_mov_b32 s19, 0x20000
    s_mov_b32 s20, s74
    s_and_b32 s21, s75, 0xffff
    s_mov_b32 s22, 0x1e0000
    s_mov_b32 s23, 0x20000
    s_mov_b32 s24, s76
    s_and_b32 s25, s77, 0xffff
    s_mov_b32 s26, 0x280000
    s_mov_b32 s27, 0x20000
    s_add_u32 m0, s47, 0xa000
    s_add_u32 s62, s86, 0x1e000
    buffer_load_dwordx4 v12, s[8:11], s62 offen lds
    s_add_u32 m0, s47, 0xb000
    s_add_u32 s62, s86, 0x2d000
    buffer_load_dwordx4 v12, s[8:11], s62 offen lds
    s_add_u32 m0, s48, 0xc800
    s_add_u32 s62, s87, 20480
    buffer_load_dwordx4 v10, s[4:7], s62 offen lds
    s_add_u32 m0, s48, 0xcc00
    s_add_u32 s62, s87, 20480
    buffer_load_dwordx4 v11, s[4:7], s62 offen lds
    s_waitcnt vmcnt(8)
    s_barrier
    ds_read_b64_tr_b16 a[0:1], v4 offset:0
    ds_read_b64_tr_b16 a[2:3], v4 offset:1024
    ds_read_b64_tr_b16 a[4:5], v5 offset:0
    ds_read_b64_tr_b16 a[6:7], v5 offset:1024
    ds_read_b64_tr_b16 a[8:9], v6 offset:0
    ds_read_b64_tr_b16 a[10:11], v6 offset:1024
    ds_read_b64_tr_b16 a[12:13], v7 offset:0
    ds_read_b64_tr_b16 a[14:15], v7 offset:1024
    ds_read_b128 a[16:19], v8 offset:0
    ds_read_b128 a[20:23], v8 offset:2048
    ds_read_b128 a[24:27], v8 offset:4096
    ds_read_b128 a[28:31], v8 offset:6144
    s_waitcnt lgkmcnt(0)
    s_add_u32 s86, s86, 245760
    s_add_u32 s87, s87, 128
    s_cmp_ge_u32 s87, 1280
    s_cselect_b32 s86, 0, s86
    s_cselect_b32 s87, 0, s87
    s_add_u32 m0, s47, 0x10000
    s_add_u32 s62, s86, 0x0
    v_mfma_f32_16x16x32_bf16 v[32:35], a[0:3], a[16:19], 0
    ds_read_b64_tr_b16 a[32:33], v4 offset:8192
    buffer_load_dwordx4 v12, s[8:11], s62 offen lds
    v_mfma_f32_16x16x32_bf16 v[36:39], a[0:3], a[20:23], 0
    ds_read_b64_tr_b16 a[34:35], v4 offset:9216
    s_add_u32 m0, s47, 0x11000
    s_add_u32 s62, s86, 0xf000
    v_mfma_f32_16x16x32_bf16 v[40:43], a[0:3], a[24:27], 0
    ds_read_b64_tr_b16 a[36:37], v5 offset:8192
    buffer_load_dwordx4 v12, s[8:11], s62 offen lds
    v_mfma_f32_16x16x32_bf16 v[44:47], a[0:3], a[28:31], 0
    ds_read_b64_tr_b16 a[38:39], v5 offset:9216
    s_add_u32 m0, s48, 0x14000
    s_add_u32 s62, s87, 0
    v_mfma_f32_16x16x32_bf16 v[24:27], a[0:3], v[20:23], 0
    ds_read_b64_tr_b16 a[40:41], v6 offset:8192
    buffer_load_dwordx4 v10, s[4:7], s62 offen lds
    v_mfma_f32_16x16x32_bf16 v[48:51], a[4:7], a[16:19], 0
    ds_read_b64_tr_b16 a[42:43], v6 offset:9216
    v_mfma_f32_16x16x32_bf16 v[52:55], a[4:7], a[20:23], 0
    ds_read_b64_tr_b16 a[44:45], v7 offset:8192
    s_add_u32 m0, s48, 0x14400
    s_add_u32 s62, s87, 0
    v_mfma_f32_16x16x32_bf16 v[56:59], a[4:7], a[24:27], 0
    ds_read_b64_tr_b16 a[46:47], v7 offset:9216
    buffer_load_dwordx4 v11, s[4:7], s62 offen lds
    v_mfma_f32_16x16x32_bf16 v[60:63], a[4:7], a[28:31], 0
    ds_read_b128 a[48:51], v9 offset:0
    s_add_u32 m0, s47, 0x12000
    s_add_u32 s62, s86, 0x1e000
    v_mfma_f32_16x16x32_bf16 v[28:31], a[4:7], v[20:23], 0
    ds_read_b128 a[52:55], v9 offset:2048
    buffer_load_dwordx4 v12, s[8:11], s62 offen lds
    v_mfma_f32_16x16x32_bf16 v[64:67], a[8:11], a[16:19], 0
    ds_read_b128 a[56:59], v9 offset:4096
    s_add_u32 m0, s47, 0x13000
    s_add_u32 s62, s86, 0x2d000
    v_mfma_f32_16x16x32_bf16 v[68:71], a[8:11], a[20:23], 0
    ds_read_b128 a[60:63], v9 offset:6144
    buffer_load_dwordx4 v12, s[8:11], s62 offen lds
    v_mfma_f32_16x16x32_bf16 v[72:75], a[8:11], a[24:27], 0
    s_add_u32 m0, s48, 0x14800
    s_add_u32 s62, s87, 20480
    v_mfma_f32_16x16x32_bf16 v[76:79], a[8:11], a[28:31], 0
    buffer_load_dwordx4 v10, s[4:7], s62 offen lds
    v_mfma_f32_16x16x32_bf16 v[80:83], a[12:15], a[16:19], 0
    s_add_u32 m0, s48, 0x14c00
    s_add_u32 s62, s87, 20480
    v_mfma_f32_16x16x32_bf16 v[84:87], a[12:15], a[20:23], 0
    buffer_load_dwordx4 v11, s[4:7], s62 offen lds
    v_mfma_f32_16x16x32_bf16 v[88:91], a[12:15], a[24:27], 0
    v_mfma_f32_16x16x32_bf16 v[92:95], a[12:15], a[28:31], 0
    s_waitcnt lgkmcnt(0)
    s_waitcnt vmcnt(8)
    s_barrier
    s_add_u32 s86, s86, 245760
    s_add_u32 s87, s87, 128
    s_cmp_ge_u32 s87, 1280
    s_cselect_b32 s86, 0, s86
    s_cselect_b32 s87, 0, s87
    s_add_u32 m0, s47, 0x18000
    s_add_u32 s62, s86, 0x0
    v_mfma_f32_16x16x32_bf16 v[32:35], a[32:35], a[48:51], v[32:35]
    ds_read_b64_tr_b16 a[0:1], v4 offset:32768
    buffer_load_dwordx4 v12, s[8:11], s62 offen lds
    v_mfma_f32_16x16x32_bf16 v[36:39], a[32:35], a[52:55], v[36:39]
    ds_read_b64_tr_b16 a[2:3], v4 offset:33792
    s_add_u32 m0, s47, 0x19000
    s_add_u32 s62, s86, 0xf000
    v_mfma_f32_16x16x32_bf16 v[40:43], a[32:35], a[56:59], v[40:43]
    ds_read_b64_tr_b16 a[4:5], v5 offset:32768
    buffer_load_dwordx4 v12, s[8:11], s62 offen lds
    s_mul_i32 s49, s37, 15
    s_add_u32 s49, s49, s38
    s_cmp_lt_u32 s49, 80
    s_cselect_b32 s64, s12, s16
    s_cselect_b32 s65, s13, s17
    s_cselect_b32 s66, s14, s18
    s_mov_b32 s67, 0x20000
    s_mov_b32 s72, 1280
    s_cselect_b32 s72, s72, 3072
    s_cselect_b32 s73, 19, 23
    s_cselect_b32 s74, 2, 3
    s_cselect_b32 s75, 0, 80
    s_mov_b32 s76, 320
    s_cselect_b32 s76, s76, 384
    s_cselect_b32 s77, 5, 6
    s_mov_b32 s78, 20
    s_mov_b32 s79, 0x1500000
    s_cselect_b32 s79, s79, 0x1600000
    s_sub_u32 s50, s49, s75
    v_mfma_f32_16x16x32_bf16 v[44:47], a[32:35], a[60:63], v[44:47]
    ds_read_b64_tr_b16 a[6:7], v5 offset:33792
    s_add_u32 m0, s48, 0x1c000
    s_add_u32 s62, s87, 0
    v_mfma_f32_16x16x32_bf16 v[24:27], a[32:35], v[20:23], v[24:27]
    ds_read_b64_tr_b16 a[8:9], v6 offset:32768
    buffer_load_dwordx4 v10, s[4:7], s62 offen lds
    v_mfma_f32_16x16x32_bf16 v[48:51], a[36:39], a[48:51], v[48:51]
    ds_read_b64_tr_b16 a[10:11], v6 offset:33792
    s_lshr_b32 s51, s50, s74
    s_lshl_b32 s52, 1, s74
    s_sub_u32 s52, s52, 1
    s_and_b32 s52, s50, s52
    s_lshl_b32 s54, s36, 6
    s_add_u32 s54, s54, 0
    v_mfma_f32_16x16x32_bf16 v[52:55], a[36:39], a[52:55], v[52:55]
    ds_read_b64_tr_b16 a[12:13], v7 offset:32768
    s_add_u32 m0, s48, 0x1c400
    s_add_u32 s62, s87, 0
    v_mfma_f32_16x16x32_bf16 v[56:59], a[36:39], a[56:59], v[56:59]
    ds_read_b64_tr_b16 a[14:15], v7 offset:33792
    buffer_load_dwordx4 v11, s[4:7], s62 offen lds
    v_add_u32 v208, s54, v1
    v_mul_u32_u24 v136, 2731, v208
    v_lshrrev_b32 v136, 16, v136
    v_mul_u32_u24 v210, 24, v136
    v_sub_u32 v139, v208, v210
    s_lshl_b32 s54, s36, 6
    v_mfma_f32_16x16x32_bf16 v[60:63], a[36:39], a[60:63], v[60:63]
    ds_read_b128 a[16:19], v8 offset:32768
    s_add_u32 m0, s47, 0x1a000
    s_add_u32 s62, s86, 0x1e000
    v_mfma_f32_16x16x32_bf16 v[28:31], a[36:39], v[20:23], v[28:31]
    ds_read_b128 a[20:23], v8 offset:34816
    buffer_load_dwordx4 v12, s[8:11], s62 offen lds
    v_mfma_f32_16x16x32_bf16 v[64:67], a[40:43], a[48:51], v[64:67]
    ds_read_b128 a[24:27], v8 offset:36864
    s_add_u32 m0, s47, 0x1b000
    s_add_u32 s62, s86, 0x2d000
    v_mfma_f32_16x16x32_bf16 v[68:71], a[40:43], a[52:55], v[68:71]
    ds_read_b128 a[28:31], v8 offset:38912
    buffer_load_dwordx4 v12, s[8:11], s62 offen lds
    s_add_u32 s54, s54, 256
    v_add_u32 v208, s54, v1
    v_mul_u32_u24 v137, 2731, v208
    v_lshrrev_b32 v137, 16, v137
    v_mul_u32_u24 v210, 24, v137
    v_sub_u32 v140, v208, v210
    v_mfma_f32_16x16x32_bf16 v[72:75], a[40:43], a[56:59], v[72:75]
    s_add_u32 m0, s48, 0x1c800
    s_add_u32 s62, s87, 20480
    v_mfma_f32_16x16x32_bf16 v[76:79], a[40:43], a[60:63], v[76:79]
    buffer_load_dwordx4 v10, s[4:7], s62 offen lds
    v_mfma_f32_16x16x32_bf16 v[80:83], a[44:47], a[48:51], v[80:83]
    s_add_u32 m0, s48, 0x1cc00
    s_add_u32 s62, s87, 20480
    v_mfma_f32_16x16x32_bf16 v[84:87], a[44:47], a[52:55], v[84:87]
    buffer_load_dwordx4 v11, s[4:7], s62 offen lds
    v_mfma_f32_16x16x32_bf16 v[88:91], a[44:47], a[56:59], v[88:91]
    s_lshl_b32 s54, s36, 6
    s_add_u32 s54, s54, 512
    v_add_u32 v208, s54, v1
    v_mul_u32_u24 v138, 2731, v208
    v_lshrrev_b32 v138, 16, v138
    v_mul_u32_u24 v210, 24, v138
    v_mfma_f32_16x16x32_bf16 v[92:95], a[44:47], a[60:63], v[92:95]
    s_waitcnt lgkmcnt(0)
    s_add_u32 s86, s86, 245760
    s_add_u32 s87, s87, 128
    s_cmp_ge_u32 s87, 1280
    s_cselect_b32 s86, 0, s86
    s_cselect_b32 s87, 0, s87
    s_add_u32 m0, s47, 0x0
    s_add_u32 s62, s86, 0x0
    v_mfma_f32_16x16x32_bf16 v[32:35], a[0:3], a[16:19], v[32:35]
    ds_read_b64_tr_b16 a[32:33], v4 offset:40960
    buffer_load_dwordx4 v12, s[8:11], s62 offen lds
    v_mfma_f32_16x16x32_bf16 v[36:39], a[0:3], a[20:23], v[36:39]
    ds_read_b64_tr_b16 a[34:35], v4 offset:41984
    s_add_u32 m0, s47, 0x1000
    s_add_u32 s62, s86, 0xf000
    v_mfma_f32_16x16x32_bf16 v[40:43], a[0:3], a[24:27], v[40:43]
    ds_read_b64_tr_b16 a[36:37], v5 offset:40960
    buffer_load_dwordx4 v12, s[8:11], s62 offen lds
    v_sub_u32 v141, v208, v210
    v_lshrrev_b32 v209, 2, v2
    v_lshl_add_u32 v209, v3, 3, v209
    v_mul_u32_u24 v209, 384, v209
    v_and_b32 v208, 3, v1
    v_lshl_add_u32 v142, v208, 4, v209
    v_mfma_f32_16x16x32_bf16 v[44:47], a[0:3], a[28:31], v[44:47]
    ds_read_b64_tr_b16 a[38:39], v5 offset:41984
    s_add_u32 m0, s48, 0x4000
    s_add_u32 s62, s87, 0
    v_mfma_f32_16x16x32_bf16 v[24:27], a[0:3], v[20:23], v[24:27]
    ds_read_b64_tr_b16 a[40:41], v6 offset:40960
    buffer_load_dwordx4 v10, s[4:7], s62 offen lds
    v_mfma_f32_16x16x32_bf16 v[48:51], a[4:7], a[16:19], v[48:51]
    ds_read_b64_tr_b16 a[42:43], v6 offset:41984
    v_lshl_add_u32 v143, v208, 3, v209
    v_lshlrev_b32 v144, 4, v1
    s_lshr_b32 s60, s36, 1
    s_and_b32 s61, s36, 1
    s_mul_i32 s61, s61, 3
    s_mul_i32 s53, s51, s72
    v_mfma_f32_16x16x32_bf16 v[52:55], a[4:7], a[20:23], v[52:55]
    ds_read_b64_tr_b16 a[44:45], v7 offset:40960
    s_add_u32 m0, s48, 0x4400
    s_add_u32 s62, s87, 0
    v_mfma_f32_16x16x32_bf16 v[56:59], a[4:7], a[24:27], v[56:59]
    ds_read_b64_tr_b16 a[46:47], v7 offset:41984
    buffer_load_dwordx4 v11, s[4:7], s62 offen lds
    s_lshl_b32 s53, s53, 5
    s_mul_i32 s54, s52, s76
    s_add_u32 s53, s53, s54
    v_min_u32 v210, s73, v139
    v_mul_lo_u32 v209, v136, s72
    v_lshl_add_u32 v209, v210, 4, v209
    v_mfma_f32_16x16x32_bf16 v[60:63], a[4:7], a[28:31], v[60:63]
    ds_read_b128 a[48:51], v9 offset:32768
    s_add_u32 m0, s47, 0x2000
    s_add_u32 s62, s86, 0x1e000
    v_mfma_f32_16x16x32_bf16 v[28:31], a[4:7], v[20:23], v[28:31]
    ds_read_b128 a[52:55], v9 offset:34816
    buffer_load_dwordx4 v12, s[8:11], s62 offen lds
    v_mfma_f32_16x16x32_bf16 v[64:67], a[8:11], a[16:19], v[64:67]
    ds_read_b128 a[56:59], v9 offset:36864
    s_add_u32 m0, s47, 0x3000
    s_add_u32 s62, s86, 0x2d000
    v_mfma_f32_16x16x32_bf16 v[68:71], a[8:11], a[20:23], v[68:71]
    ds_read_b128 a[60:63], v9 offset:38912
    buffer_load_dwordx4 v12, s[8:11], s62 offen lds
    v_add_u32 v13, s53, v209
    v_min_u32 v210, s73, v140
    v_mul_lo_u32 v209, v137, s72
    v_lshl_add_u32 v209, v210, 4, v209
    v_add_u32 v14, s53, v209
    v_min_u32 v210, s73, v141
    v_mfma_f32_16x16x32_bf16 v[72:75], a[8:11], a[24:27], v[72:75]
    s_add_u32 m0, s48, 0x4800
    s_add_u32 s62, s87, 20480
    v_mfma_f32_16x16x32_bf16 v[76:79], a[8:11], a[28:31], v[76:79]
    buffer_load_dwordx4 v10, s[4:7], s62 offen lds
    v_mfma_f32_16x16x32_bf16 v[80:83], a[12:15], a[16:19], v[80:83]
    s_add_u32 m0, s48, 0x4c00
    s_add_u32 s62, s87, 20480
    v_mfma_f32_16x16x32_bf16 v[84:87], a[12:15], a[20:23], v[84:87]
    buffer_load_dwordx4 v11, s[4:7], s62 offen lds
    v_mfma_f32_16x16x32_bf16 v[88:91], a[12:15], a[24:27], v[88:91]
    v_mul_lo_u32 v209, v138, s72
    v_lshl_add_u32 v209, v210, 4, v209
    v_add_u32 v15, s53, v209
    s_lshl_b32 s57, s52, 1
    s_add_u32 s57, s57, s60
    s_mul_i32 s57, s57, s78
    v_mfma_f32_16x16x32_bf16 v[92:95], a[12:15], a[28:31], v[92:95]
    s_waitcnt lgkmcnt(0)
    s_waitcnt vmcnt(16)
    s_barrier
    v_add_u32 v4, 0x10000, v4
    v_add_u32 v5, 0x10000, v5
    v_add_u32 v6, 0x10000, v6
    v_add_u32 v7, 0x10000, v7
    v_add_u32 v8, 0x10000, v8
    v_add_u32 v9, 0x10000, v9
    s_add_u32 s86, s86, 245760
    s_add_u32 s87, s87, 128
    s_cmp_ge_u32 s87, 1280
    s_cselect_b32 s86, 0, s86
    s_cselect_b32 s87, 0, s87
    s_add_u32 m0, s47, 0x8000
    s_add_u32 s62, s86, 0x0
    v_mfma_f32_16x16x32_bf16 v[32:35], a[32:35], a[48:51], v[32:35]
    ds_read_b64_tr_b16 a[0:1], v4 offset:0
    buffer_load_dwordx4 v12, s[8:11], s62 offen lds
    v_mfma_f32_16x16x32_bf16 v[36:39], a[32:35], a[52:55], v[36:39]
    ds_read_b64_tr_b16 a[2:3], v4 offset:1024
    s_add_u32 m0, s47, 0x9000
    s_add_u32 s62, s86, 0xf000
    v_mfma_f32_16x16x32_bf16 v[40:43], a[32:35], a[56:59], v[40:43]
    ds_read_b64_tr_b16 a[4:5], v5 offset:0
    buffer_load_dwordx4 v12, s[8:11], s62 offen lds
    s_add_u32 s57, s57, s51
    s_mul_i32 s57, s57, s77
    s_lshl_b32 s57, s57, 10
    s_add_u32 s57, s57, s79
    s_mul_i32 s58, s60, s77
    s_lshl_b32 s58, s58, 5
    v_mfma_f32_16x16x32_bf16 v[44:47], a[32:35], a[60:63], v[44:47]
    ds_read_b64_tr_b16 a[6:7], v5 offset:1024
    s_add_u32 m0, s48, 0xc000
    s_add_u32 s62, s87, 0
    v_mfma_f32_16x16x32_bf16 v[24:27], a[32:35], v[20:23], v[24:27]
    ds_read_b64_tr_b16 a[8:9], v6 offset:0
    buffer_load_dwordx4 v10, s[4:7], s62 offen lds
    v_mfma_f32_16x16x32_bf16 v[48:51], a[36:39], a[48:51], v[48:51]
    ds_read_b64_tr_b16 a[10:11], v6 offset:1024
    s_add_u32 s58, s58, 131072
    s_add_u32 s56, s61, 0
    s_lshr_b32 s54, s56, 1
    s_lshl_b32 s54, s54, 6
    s_and_b32 s55, s56, 1
    s_lshl_b32 s55, s55, 3
    v_mfma_f32_16x16x32_bf16 v[52:55], a[36:39], a[52:55], v[52:55]
    ds_read_b64_tr_b16 a[12:13], v7 offset:0
    s_add_u32 m0, s48, 0xc400
    s_add_u32 s62, s87, 0
    v_mfma_f32_16x16x32_bf16 v[56:59], a[36:39], a[56:59], v[56:59]
    ds_read_b64_tr_b16 a[14:15], v7 offset:1024
    buffer_load_dwordx4 v11, s[4:7], s62 offen lds
    s_add_u32 s54, s54, s55
    s_add_u32 s54, s54, s58
    s_lshl_b32 s55, s77, 3
    s_add_u32 s55, s55, s56
    s_cmp_eq_u32 s55, 44
    s_cselect_b64 s[68:69], -1, 0
    v_cndmask_b32 v208, v142, v143, s[68:69]
    v_mfma_f32_16x16x32_bf16 v[60:63], a[36:39], a[60:63], v[60:63]
    ds_read_b128 a[16:19], v8 offset:0
    s_add_u32 m0, s47, 0xa000
    s_add_u32 s62, s86, 0x1e000
    v_mfma_f32_16x16x32_bf16 v[28:31], a[36:39], v[20:23], v[28:31]
    ds_read_b128 a[20:23], v8 offset:2048
    buffer_load_dwordx4 v12, s[8:11], s62 offen lds
    v_mfma_f32_16x16x32_bf16 v[64:67], a[40:43], a[48:51], v[64:67]
    ds_read_b128 a[24:27], v8 offset:4096
    s_add_u32 m0, s47, 0xb000
    s_add_u32 s62, s86, 0x2d000
    v_mfma_f32_16x16x32_bf16 v[68:71], a[40:43], a[52:55], v[68:71]
    ds_read_b128 a[28:31], v8 offset:6144
    buffer_load_dwordx4 v12, s[8:11], s62 offen lds
    v_add_u32 v124, s54, v208
    s_lshl_b32 s54, s56, 10
    s_add_u32 s54, s54, s57
    s_cmp_lt_u32 s56, s77
    s_cselect_b32 s54, s54, 0x7f000000
    v_add_u32 v130, s54, v144
    v_mfma_f32_16x16x32_bf16 v[72:75], a[40:43], a[56:59], v[72:75]
    s_add_u32 m0, s48, 0xc800
    s_add_u32 s62, s87, 20480
    v_mfma_f32_16x16x32_bf16 v[76:79], a[40:43], a[60:63], v[76:79]
    buffer_load_dwordx4 v10, s[4:7], s62 offen lds
    v_mfma_f32_16x16x32_bf16 v[80:83], a[44:47], a[48:51], v[80:83]
    s_add_u32 m0, s48, 0xcc00
    s_add_u32 s62, s87, 20480
    v_mfma_f32_16x16x32_bf16 v[84:87], a[44:47], a[52:55], v[84:87]
    buffer_load_dwordx4 v11, s[4:7], s62 offen lds
    v_mfma_f32_16x16x32_bf16 v[88:91], a[44:47], a[56:59], v[88:91]
    s_add_u32 s56, s61, 1
    s_lshr_b32 s54, s56, 1
    s_lshl_b32 s54, s54, 6
    s_and_b32 s55, s56, 1
    s_lshl_b32 s55, s55, 3
    s_add_u32 s54, s54, s55
    v_mfma_f32_16x16x32_bf16 v[92:95], a[44:47], a[60:63], v[92:95]
    s_waitcnt lgkmcnt(0)
    v_mfma_f32_16x16x32_bf16 v[32:35], a[0:3], a[16:19], v[32:35]
    ds_read_b64_tr_b16 a[32:33], v4 offset:8192
    v_mfma_f32_16x16x32_bf16 v[36:39], a[0:3], a[20:23], v[36:39]
    ds_read_b64_tr_b16 a[34:35], v4 offset:9216
    v_mfma_f32_16x16x32_bf16 v[40:43], a[0:3], a[24:27], v[40:43]
    ds_read_b64_tr_b16 a[36:37], v5 offset:8192
    s_add_u32 s54, s54, s58
    s_lshl_b32 s55, s77, 3
    s_add_u32 s55, s55, s56
    s_cmp_eq_u32 s55, 44
    s_cselect_b64 s[68:69], -1, 0
    v_cndmask_b32 v208, v142, v143, s[68:69]
    v_mfma_f32_16x16x32_bf16 v[44:47], a[0:3], a[28:31], v[44:47]
    ds_read_b64_tr_b16 a[38:39], v5 offset:9216
    v_mfma_f32_16x16x32_bf16 v[24:27], a[0:3], v[20:23], v[24:27]
    ds_read_b64_tr_b16 a[40:41], v6 offset:8192
    v_mfma_f32_16x16x32_bf16 v[48:51], a[4:7], a[16:19], v[48:51]
    ds_read_b64_tr_b16 a[42:43], v6 offset:9216
    v_add_u32 v125, s54, v208
    s_lshl_b32 s54, s56, 10
    s_add_u32 s54, s54, s57
    s_cmp_lt_u32 s56, s77
    s_cselect_b32 s54, s54, 0x7f000000
    v_add_u32 v131, s54, v144
    v_mfma_f32_16x16x32_bf16 v[52:55], a[4:7], a[20:23], v[52:55]
    ds_read_b64_tr_b16 a[44:45], v7 offset:8192
    v_mfma_f32_16x16x32_bf16 v[56:59], a[4:7], a[24:27], v[56:59]
    ds_read_b64_tr_b16 a[46:47], v7 offset:9216
    s_add_u32 s56, s61, 2
    s_lshr_b32 s54, s56, 1
    s_lshl_b32 s54, s54, 6
    s_and_b32 s55, s56, 1
    s_lshl_b32 s55, s55, 3
    s_add_u32 s54, s54, s55
    v_mfma_f32_16x16x32_bf16 v[60:63], a[4:7], a[28:31], v[60:63]
    ds_read_b128 a[48:51], v9 offset:0
    v_mfma_f32_16x16x32_bf16 v[28:31], a[4:7], v[20:23], v[28:31]
    ds_read_b128 a[52:55], v9 offset:2048
    v_mfma_f32_16x16x32_bf16 v[64:67], a[8:11], a[16:19], v[64:67]
    ds_read_b128 a[56:59], v9 offset:4096
    v_mfma_f32_16x16x32_bf16 v[68:71], a[8:11], a[20:23], v[68:71]
    ds_read_b128 a[60:63], v9 offset:6144
    s_add_u32 s54, s54, s58
    s_lshl_b32 s55, s77, 3
    s_add_u32 s55, s55, s56
    s_cmp_eq_u32 s55, 44
    s_cselect_b64 s[68:69], -1, 0
    v_cndmask_b32 v208, v142, v143, s[68:69]
    v_mfma_f32_16x16x32_bf16 v[72:75], a[8:11], a[24:27], v[72:75]
    v_mfma_f32_16x16x32_bf16 v[76:79], a[8:11], a[28:31], v[76:79]
    v_mfma_f32_16x16x32_bf16 v[80:83], a[12:15], a[16:19], v[80:83]
    v_add_u32 v126, s54, v208
    s_lshl_b32 s54, s56, 10
    s_add_u32 s54, s54, s57
    s_cmp_lt_u32 s56, s77
    s_cselect_b32 s54, s54, 0x7f000000
    v_add_u32 v132, s54, v144
    v_mfma_f32_16x16x32_bf16 v[84:87], a[12:15], a[20:23], v[84:87]
    v_mfma_f32_16x16x32_bf16 v[88:91], a[12:15], a[24:27], v[88:91]
    s_mov_b32 s72, 1280
    s_mov_b32 s73, 19
    s_mov_b32 s76, 320
    s_mov_b32 s77, 5
    s_mov_b32 s78, 48
    s_mov_b32 s79, 0x1800000
    s_lshr_b32 s51, s49, 2
    v_mfma_f32_16x16x32_bf16 v[92:95], a[12:15], a[28:31], v[92:95]
    s_waitcnt lgkmcnt(0)
    s_waitcnt vmcnt(16)
    s_barrier
    v_mfma_f32_16x16x32_bf16 v[32:35], a[32:35], a[48:51], v[32:35]
    ds_read_b64_tr_b16 a[0:1], v4 offset:32768
    s_add_u32 s86, s86, 245760
    s_add_u32 s87, s87, 128
    s_cmp_ge_u32 s87, 1280
    s_cselect_b32 s86, 0, s86
    s_cselect_b32 s87, 0, s87
    s_add_u32 m0, s47, 0x10000
    s_add_u32 s62, s86, 0x0
    v_mfma_f32_16x16x32_bf16 v[36:39], a[32:35], a[52:55], v[36:39]
    ds_read_b64_tr_b16 a[2:3], v4 offset:33792
    buffer_load_dwordx4 v12, s[8:11], s62 offen lds
    v_mfma_f32_16x16x32_bf16 v[40:43], a[32:35], a[56:59], v[40:43]
    ds_read_b64_tr_b16 a[4:5], v5 offset:32768
    s_and_b32 s52, s49, 3
    s_mul_i32 s53, s51, s72
    s_lshl_b32 s53, s53, 5
    s_mul_i32 s54, s52, s76
    s_add_u32 s53, s53, s54
    v_min_u32 v210, s73, v139
    v_mfma_f32_16x16x32_bf16 v[44:47], a[32:35], a[60:63], v[44:47]
    ds_read_b64_tr_b16 a[6:7], v5 offset:33792
    v_mfma_f32_16x16x32_bf16 v[24:27], a[32:35], v[20:23], v[24:27]
    ds_read_b64_tr_b16 a[8:9], v6 offset:32768
    s_add_u32 m0, s47, 0x11000
    s_add_u32 s62, s86, 0xf000
    v_mfma_f32_16x16x32_bf16 v[48:51], a[36:39], a[48:51], v[48:51]
    ds_read_b64_tr_b16 a[10:11], v6 offset:33792
    buffer_load_dwordx4 v12, s[8:11], s62 offen lds
    v_mul_lo_u32 v209, v136, s72
    v_lshl_add_u32 v209, v210, 4, v209
    v_add_u32 v16, s53, v209
    v_min_u32 v210, s73, v140
    v_mul_lo_u32 v209, v137, s72
    v_lshl_add_u32 v209, v210, 4, v209
    v_mfma_f32_16x16x32_bf16 v[52:55], a[36:39], a[52:55], v[52:55]
    ds_read_b64_tr_b16 a[12:13], v7 offset:32768
    v_mfma_f32_16x16x32_bf16 v[56:59], a[36:39], a[56:59], v[56:59]
    ds_read_b64_tr_b16 a[14:15], v7 offset:33792
    v_add_u32 v17, s53, v209
    v_min_u32 v210, s73, v141
    v_mul_lo_u32 v209, v138, s72
    v_lshl_add_u32 v209, v210, 4, v209
    v_add_u32 v18, s53, v209
    s_lshl_b32 s57, s52, 1
    v_mfma_f32_16x16x32_bf16 v[60:63], a[36:39], a[60:63], v[60:63]
    ds_read_b128 a[16:19], v8 offset:32768
    v_mfma_f32_16x16x32_bf16 v[28:31], a[36:39], v[20:23], v[28:31]
    ds_read_b128 a[20:23], v8 offset:34816
    s_add_u32 m0, s48, 0x14000
    s_add_u32 s62, s87, 0
    v_mfma_f32_16x16x32_bf16 v[64:67], a[40:43], a[48:51], v[64:67]
    ds_read_b128 a[24:27], v8 offset:36864
    buffer_load_dwordx4 v10, s[4:7], s62 offen lds
    v_mfma_f32_16x16x32_bf16 v[68:71], a[40:43], a[52:55], v[68:71]
    ds_read_b128 a[28:31], v8 offset:38912
    s_add_u32 s57, s57, s60
    s_mul_i32 s57, s57, s78
    s_add_u32 s57, s57, s51
    s_mul_i32 s57, s57, s77
    s_lshl_b32 s57, s57, 10
    s_add_u32 s57, s57, s79
    v_mfma_f32_16x16x32_bf16 v[72:75], a[40:43], a[56:59], v[72:75]
    v_mfma_f32_16x16x32_bf16 v[76:79], a[40:43], a[60:63], v[76:79]
    s_add_u32 m0, s48, 0x14400
    s_add_u32 s62, s87, 0
    v_mfma_f32_16x16x32_bf16 v[80:83], a[44:47], a[48:51], v[80:83]
    buffer_load_dwordx4 v11, s[4:7], s62 offen lds
    s_cmp_lt_u32 s49, 192
    s_cselect_b32 s57, s57, 0x7f000000
    s_mul_i32 s58, s60, s77
    s_lshl_b32 s58, s58, 5
    s_add_u32 s58, s58, 143360
    s_add_u32 s56, s61, 0
    v_mfma_f32_16x16x32_bf16 v[84:87], a[44:47], a[52:55], v[84:87]
    v_mfma_f32_16x16x32_bf16 v[88:91], a[44:47], a[56:59], v[88:91]
    s_lshr_b32 s54, s56, 1
    s_lshl_b32 s54, s54, 6
    s_and_b32 s55, s56, 1
    s_lshl_b32 s55, s55, 3
    s_add_u32 s54, s54, s55
    s_add_u32 s54, s54, s58
    v_mfma_f32_16x16x32_bf16 v[92:95], a[44:47], a[60:63], v[92:95]
    s_waitcnt lgkmcnt(0)
    v_mfma_f32_16x16x32_bf16 v[32:35], a[0:3], a[16:19], v[32:35]
    ds_read_b64_tr_b16 a[32:33], v4 offset:40960
    s_add_u32 m0, s47, 0x12000
    s_add_u32 s62, s86, 0x1e000
    v_mfma_f32_16x16x32_bf16 v[36:39], a[0:3], a[20:23], v[36:39]
    ds_read_b64_tr_b16 a[34:35], v4 offset:41984
    buffer_load_dwordx4 v12, s[8:11], s62 offen lds
    v_mfma_f32_16x16x32_bf16 v[40:43], a[0:3], a[24:27], v[40:43]
    ds_read_b64_tr_b16 a[36:37], v5 offset:40960
    s_lshl_b32 s55, s77, 3
    s_add_u32 s55, s55, s56
    s_cmp_eq_u32 s55, 44
    s_cselect_b64 s[68:69], -1, 0
    v_cndmask_b32 v208, v142, v143, s[68:69]
    v_add_u32 v127, s54, v208
    v_mfma_f32_16x16x32_bf16 v[44:47], a[0:3], a[28:31], v[44:47]
    ds_read_b64_tr_b16 a[38:39], v5 offset:41984
    v_mfma_f32_16x16x32_bf16 v[24:27], a[0:3], v[20:23], v[24:27]
    ds_read_b64_tr_b16 a[40:41], v6 offset:40960
    s_add_u32 m0, s47, 0x13000
    s_add_u32 s62, s86, 0x2d000
    v_mfma_f32_16x16x32_bf16 v[48:51], a[4:7], a[16:19], v[48:51]
    ds_read_b64_tr_b16 a[42:43], v6 offset:41984
    buffer_load_dwordx4 v12, s[8:11], s62 offen lds
    s_lshl_b32 s54, s56, 10
    s_add_u32 s54, s54, s57
    s_cmp_lt_u32 s56, s77
    s_cselect_b32 s54, s54, 0x7f000000
    v_add_u32 v133, s54, v144
    s_add_u32 s56, s61, 1
    v_mfma_f32_16x16x32_bf16 v[52:55], a[4:7], a[20:23], v[52:55]
    ds_read_b64_tr_b16 a[44:45], v7 offset:40960
    v_mfma_f32_16x16x32_bf16 v[56:59], a[4:7], a[24:27], v[56:59]
    ds_read_b64_tr_b16 a[46:47], v7 offset:41984
    s_lshr_b32 s54, s56, 1
    s_lshl_b32 s54, s54, 6
    s_and_b32 s55, s56, 1
    s_lshl_b32 s55, s55, 3
    s_add_u32 s54, s54, s55
    s_add_u32 s54, s54, s58
    v_mfma_f32_16x16x32_bf16 v[60:63], a[4:7], a[28:31], v[60:63]
    ds_read_b128 a[48:51], v9 offset:32768
    v_mfma_f32_16x16x32_bf16 v[28:31], a[4:7], v[20:23], v[28:31]
    ds_read_b128 a[52:55], v9 offset:34816
    s_add_u32 m0, s48, 0x14800
    s_add_u32 s62, s87, 20480
    v_mfma_f32_16x16x32_bf16 v[64:67], a[8:11], a[16:19], v[64:67]
    ds_read_b128 a[56:59], v9 offset:36864
    buffer_load_dwordx4 v10, s[4:7], s62 offen lds
    v_mfma_f32_16x16x32_bf16 v[68:71], a[8:11], a[20:23], v[68:71]
    ds_read_b128 a[60:63], v9 offset:38912
    s_lshl_b32 s55, s77, 3
    s_add_u32 s55, s55, s56
    s_cmp_eq_u32 s55, 44
    s_cselect_b64 s[68:69], -1, 0
    v_cndmask_b32 v208, v142, v143, s[68:69]
    v_add_u32 v128, s54, v208
    v_mfma_f32_16x16x32_bf16 v[72:75], a[8:11], a[24:27], v[72:75]
    v_mfma_f32_16x16x32_bf16 v[76:79], a[8:11], a[28:31], v[76:79]
    s_add_u32 m0, s48, 0x14c00
    s_add_u32 s62, s87, 20480
    v_mfma_f32_16x16x32_bf16 v[80:83], a[12:15], a[16:19], v[80:83]
    buffer_load_dwordx4 v11, s[4:7], s62 offen lds
    s_lshl_b32 s54, s56, 10
    s_add_u32 s54, s54, s57
    s_cmp_lt_u32 s56, s77
    s_cselect_b32 s54, s54, 0x7f000000
    v_add_u32 v134, s54, v144
    s_add_u32 s56, s61, 2
    v_mfma_f32_16x16x32_bf16 v[84:87], a[12:15], a[20:23], v[84:87]
    v_mfma_f32_16x16x32_bf16 v[88:91], a[12:15], a[24:27], v[88:91]
    s_lshr_b32 s54, s56, 1
    s_lshl_b32 s54, s54, 6
    s_and_b32 s55, s56, 1
    s_lshl_b32 s55, s55, 3
    s_add_u32 s54, s54, s55
    s_add_u32 s54, s54, s58
    v_mfma_f32_16x16x32_bf16 v[92:95], a[12:15], a[28:31], v[92:95]
    s_waitcnt lgkmcnt(0)
    s_waitcnt vmcnt(16)
    s_barrier
    v_subrev_u32 v4, 0x10000, v4
    v_subrev_u32 v5, 0x10000, v5
    v_subrev_u32 v6, 0x10000, v6
    v_subrev_u32 v7, 0x10000, v7
    v_subrev_u32 v8, 0x10000, v8
    v_subrev_u32 v9, 0x10000, v9
    v_mfma_f32_16x16x32_bf16 v[32:35], a[32:35], a[48:51], v[32:35]
    ds_read_b64_tr_b16 a[0:1], v4 offset:0
    s_add_u32 m0, s47, 0x20000
    s_nop 0
    v_mfma_f32_16x16x32_bf16 v[36:39], a[32:35], a[52:55], v[36:39]
    ds_read_b64_tr_b16 a[2:3], v4 offset:1024
    buffer_load_dwordx4 v13, s[64:67], 0 offen lds
    v_mfma_f32_16x16x32_bf16 v[40:43], a[32:35], a[56:59], v[40:43]
    ds_read_b64_tr_b16 a[4:5], v5 offset:0
    s_lshl_b32 s55, s77, 3
    s_add_u32 s55, s55, s56
    s_cmp_eq_u32 s55, 44
    s_cselect_b64 s[68:69], -1, 0
    v_cndmask_b32 v208, v142, v143, s[68:69]
    v_add_u32 v129, s54, v208
    v_mfma_f32_16x16x32_bf16 v[44:47], a[32:35], a[60:63], v[44:47]
    ds_read_b64_tr_b16 a[6:7], v5 offset:1024
    v_mfma_f32_16x16x32_bf16 v[24:27], a[32:35], v[20:23], v[24:27]
    ds_read_b64_tr_b16 a[8:9], v6 offset:0
    s_add_u32 m0, s47, 0x21000
    s_nop 0
    v_mfma_f32_16x16x32_bf16 v[48:51], a[36:39], a[48:51], v[48:51]
    ds_read_b64_tr_b16 a[10:11], v6 offset:1024
    buffer_load_dwordx4 v14, s[64:67], 0 offen lds
    s_lshl_b32 s54, s56, 10
    s_add_u32 s54, s54, s57
    s_cmp_lt_u32 s56, s77
    s_cselect_b32 s54, s54, 0x7f000000
    v_add_u32 v135, s54, v144
    v_mfma_f32_16x16x32_bf16 v[52:55], a[36:39], a[52:55], v[52:55]
    ds_read_b64_tr_b16 a[12:13], v7 offset:0
    v_mfma_f32_16x16x32_bf16 v[56:59], a[36:39], a[56:59], v[56:59]
    ds_read_b64_tr_b16 a[14:15], v7 offset:1024
    v_mfma_f32_16x16x32_bf16 v[60:63], a[36:39], a[60:63], v[60:63]
    ds_read_b128 a[16:19], v8 offset:0
    v_mfma_f32_16x16x32_bf16 v[28:31], a[36:39], v[20:23], v[28:31]
    ds_read_b128 a[20:23], v8 offset:2048
    s_add_u32 m0, s47, 0x22000
    s_nop 0
    v_mfma_f32_16x16x32_bf16 v[64:67], a[40:43], a[48:51], v[64:67]
    ds_read_b128 a[24:27], v8 offset:4096
    buffer_load_dwordx4 v15, s[64:67], 0 offen lds
    v_mfma_f32_16x16x32_bf16 v[68:71], a[40:43], a[52:55], v[68:71]
    ds_read_b128 a[28:31], v8 offset:6144
    v_mfma_f32_16x16x32_bf16 v[72:75], a[40:43], a[56:59], v[72:75]
    v_mfma_f32_16x16x32_bf16 v[76:79], a[40:43], a[60:63], v[76:79]
    s_add_u32 m0, s47, 0x23000
    s_nop 0
    v_mfma_f32_16x16x32_bf16 v[80:83], a[44:47], a[48:51], v[80:83]
    buffer_load_dwordx4 v16, s[20:23], 0 offen lds
    v_mfma_f32_16x16x32_bf16 v[84:87], a[44:47], a[52:55], v[84:87]
    v_mfma_f32_16x16x32_bf16 v[88:91], a[44:47], a[56:59], v[88:91]
    v_mfma_f32_16x16x32_bf16 v[92:95], a[44:47], a[60:63], v[92:95]
    s_waitcnt lgkmcnt(0)
    v_mfma_f32_16x16x32_bf16 v[32:35], a[0:3], a[16:19], v[32:35]
    ds_read_b64_tr_b16 a[32:33], v4 offset:8192
    s_add_u32 m0, s47, 0x24000
    s_nop 0
    v_mfma_f32_16x16x32_bf16 v[36:39], a[0:3], a[20:23], v[36:39]
    ds_read_b64_tr_b16 a[34:35], v4 offset:9216
    buffer_load_dwordx4 v17, s[20:23], 0 offen lds
    v_mfma_f32_16x16x32_bf16 v[40:43], a[0:3], a[24:27], v[40:43]
    ds_read_b64_tr_b16 a[36:37], v5 offset:8192
    v_mfma_f32_16x16x32_bf16 v[44:47], a[0:3], a[28:31], v[44:47]
    ds_read_b64_tr_b16 a[38:39], v5 offset:9216
    v_mfma_f32_16x16x32_bf16 v[24:27], a[0:3], v[20:23], v[24:27]
    ds_read_b64_tr_b16 a[40:41], v6 offset:8192
    s_add_u32 m0, s47, 0x25000
    s_nop 0
    v_mfma_f32_16x16x32_bf16 v[48:51], a[4:7], a[16:19], v[48:51]
    ds_read_b64_tr_b16 a[42:43], v6 offset:9216
    buffer_load_dwordx4 v18, s[20:23], 0 offen lds
    v_mfma_f32_16x16x32_bf16 v[52:55], a[4:7], a[20:23], v[52:55]
    ds_read_b64_tr_b16 a[44:45], v7 offset:8192
    v_mfma_f32_16x16x32_bf16 v[56:59], a[4:7], a[24:27], v[56:59]
    ds_read_b64_tr_b16 a[46:47], v7 offset:9216
    v_mfma_f32_16x16x32_bf16 v[60:63], a[4:7], a[28:31], v[60:63]
    ds_read_b128 a[48:51], v9 offset:0
    v_mfma_f32_16x16x32_bf16 v[28:31], a[4:7], v[20:23], v[28:31]
    ds_read_b128 a[52:55], v9 offset:2048
    s_add_u32 s86, s86, 245760
    s_add_u32 s87, s87, 128
    s_cmp_ge_u32 s87, 1280
    s_cselect_b32 s86, 0, s86
    s_cselect_b32 s87, 0, s87
    s_add_u32 m0, s47, 0x18000
    s_add_u32 s62, s86, 0x0
    v_mfma_f32_16x16x32_bf16 v[64:67], a[8:11], a[16:19], v[64:67]
    ds_read_b128 a[56:59], v9 offset:4096
    buffer_load_dwordx4 v12, s[8:11], s62 offen lds
    v_mfma_f32_16x16x32_bf16 v[68:71], a[8:11], a[20:23], v[68:71]
    ds_read_b128 a[60:63], v9 offset:6144
    v_mfma_f32_16x16x32_bf16 v[72:75], a[8:11], a[24:27], v[72:75]
    v_mfma_f32_16x16x32_bf16 v[76:79], a[8:11], a[28:31], v[76:79]
    s_add_u32 m0, s47, 0x19000
    s_add_u32 s62, s86, 0xf000
    v_mfma_f32_16x16x32_bf16 v[80:83], a[12:15], a[16:19], v[80:83]
    buffer_load_dwordx4 v12, s[8:11], s62 offen lds
    v_mfma_f32_16x16x32_bf16 v[84:87], a[12:15], a[20:23], v[84:87]
    v_mfma_f32_16x16x32_bf16 v[88:91], a[12:15], a[24:27], v[88:91]
    v_mfma_f32_16x16x32_bf16 v[92:95], a[12:15], a[28:31], v[92:95]
    s_waitcnt lgkmcnt(0)
    s_waitcnt vmcnt(16)
    s_barrier
    v_mfma_f32_16x16x32_bf16 v[32:35], a[32:35], a[48:51], v[32:35]
    ds_read_b64_tr_b16 a[0:1], v4 offset:32768
    s_add_u32 m0, s48, 0x1c000
    s_add_u32 s62, s87, 0
    v_mfma_f32_16x16x32_bf16 v[36:39], a[32:35], a[52:55], v[36:39]
    ds_read_b64_tr_b16 a[2:3], v4 offset:33792
    buffer_load_dwordx4 v10, s[4:7], s62 offen lds
    v_mfma_f32_16x16x32_bf16 v[40:43], a[32:35], a[56:59], v[40:43]
    ds_read_b64_tr_b16 a[4:5], v5 offset:32768
    v_mfma_f32_16x16x32_bf16 v[44:47], a[32:35], a[60:63], v[44:47]
    ds_read_b64_tr_b16 a[6:7], v5 offset:33792
    v_mfma_f32_16x16x32_bf16 v[24:27], a[32:35], v[20:23], v[24:27]
    ds_read_b64_tr_b16 a[8:9], v6 offset:32768
    s_add_u32 m0, s48, 0x1c400
    s_add_u32 s62, s87, 0
    v_mfma_f32_16x16x32_bf16 v[48:51], a[36:39], a[48:51], v[48:51]
    ds_read_b64_tr_b16 a[10:11], v6 offset:33792
    buffer_load_dwordx4 v11, s[4:7], s62 offen lds
    v_mfma_f32_16x16x32_bf16 v[52:55], a[36:39], a[52:55], v[52:55]
    ds_read_b64_tr_b16 a[12:13], v7 offset:32768
    v_mfma_f32_16x16x32_bf16 v[56:59], a[36:39], a[56:59], v[56:59]
    ds_read_b64_tr_b16 a[14:15], v7 offset:33792
    v_mfma_f32_16x16x32_bf16 v[60:63], a[36:39], a[60:63], v[60:63]
    ds_read_b128 a[16:19], v8 offset:32768
    v_mfma_f32_16x16x32_bf16 v[28:31], a[36:39], v[20:23], v[28:31]
    ds_read_b128 a[20:23], v8 offset:34816
    s_add_u32 m0, s47, 0x1a000
    s_add_u32 s62, s86, 0x1e000
    v_mfma_f32_16x16x32_bf16 v[64:67], a[40:43], a[48:51], v[64:67]
    ds_read_b128 a[24:27], v8 offset:36864
    buffer_load_dwordx4 v12, s[8:11], s62 offen lds
    v_mfma_f32_16x16x32_bf16 v[68:71], a[40:43], a[52:55], v[68:71]
    ds_read_b128 a[28:31], v8 offset:38912
    v_mfma_f32_16x16x32_bf16 v[72:75], a[40:43], a[56:59], v[72:75]
    v_mfma_f32_16x16x32_bf16 v[76:79], a[40:43], a[60:63], v[76:79]
    s_add_u32 m0, s47, 0x1b000
    s_add_u32 s62, s86, 0x2d000
    v_mfma_f32_16x16x32_bf16 v[80:83], a[44:47], a[48:51], v[80:83]
    buffer_load_dwordx4 v12, s[8:11], s62 offen lds
    v_mfma_f32_16x16x32_bf16 v[84:87], a[44:47], a[52:55], v[84:87]
    v_mfma_f32_16x16x32_bf16 v[88:91], a[44:47], a[56:59], v[88:91]
    v_mfma_f32_16x16x32_bf16 v[92:95], a[44:47], a[60:63], v[92:95]
    s_waitcnt lgkmcnt(0)
    v_mfma_f32_16x16x32_bf16 v[32:35], a[0:3], a[16:19], v[32:35]
    ds_read_b64_tr_b16 a[32:33], v4 offset:40960
    s_add_u32 m0, s48, 0x1c800
    s_add_u32 s62, s87, 20480
    v_mfma_f32_16x16x32_bf16 v[36:39], a[0:3], a[20:23], v[36:39]
    ds_read_b64_tr_b16 a[34:35], v4 offset:41984
    buffer_load_dwordx4 v10, s[4:7], s62 offen lds
    v_mfma_f32_16x16x32_bf16 v[40:43], a[0:3], a[24:27], v[40:43]
    ds_read_b64_tr_b16 a[36:37], v5 offset:40960
    v_mfma_f32_16x16x32_bf16 v[44:47], a[0:3], a[28:31], v[44:47]
    ds_read_b64_tr_b16 a[38:39], v5 offset:41984
    v_mfma_f32_16x16x32_bf16 v[24:27], a[0:3], v[20:23], v[24:27]
    ds_read_b64_tr_b16 a[40:41], v6 offset:40960
    s_add_u32 m0, s48, 0x1cc00
    s_add_u32 s62, s87, 20480
    v_mfma_f32_16x16x32_bf16 v[48:51], a[4:7], a[16:19], v[48:51]
    ds_read_b64_tr_b16 a[42:43], v6 offset:41984
    buffer_load_dwordx4 v11, s[4:7], s62 offen lds
    v_mfma_f32_16x16x32_bf16 v[52:55], a[4:7], a[20:23], v[52:55]
    ds_read_b64_tr_b16 a[44:45], v7 offset:40960
    v_mfma_f32_16x16x32_bf16 v[56:59], a[4:7], a[24:27], v[56:59]
    ds_read_b64_tr_b16 a[46:47], v7 offset:41984
    v_mfma_f32_16x16x32_bf16 v[60:63], a[4:7], a[28:31], v[60:63]
    ds_read_b128 a[48:51], v9 offset:32768
    v_mfma_f32_16x16x32_bf16 v[28:31], a[4:7], v[20:23], v[28:31]
    ds_read_b128 a[52:55], v9 offset:34816
    s_add_u32 s86, s86, 245760
    s_add_u32 s87, s87, 128
    s_cmp_ge_u32 s87, 1280
    s_cselect_b32 s86, 0, s86
    s_cselect_b32 s87, 0, s87
    s_add_u32 m0, s47, 0x0
    s_add_u32 s62, s86, 0x0
    v_mfma_f32_16x16x32_bf16 v[64:67], a[8:11], a[16:19], v[64:67]
    ds_read_b128 a[56:59], v9 offset:36864
    buffer_load_dwordx4 v12, s[8:11], s62 offen lds
    v_mfma_f32_16x16x32_bf16 v[68:71], a[8:11], a[20:23], v[68:71]
    ds_read_b128 a[60:63], v9 offset:38912
    v_mfma_f32_16x16x32_bf16 v[72:75], a[8:11], a[24:27], v[72:75]
    v_mfma_f32_16x16x32_bf16 v[76:79], a[8:11], a[28:31], v[76:79]
    s_add_u32 m0, s47, 0x1000
    s_add_u32 s62, s86, 0xf000
    v_mfma_f32_16x16x32_bf16 v[80:83], a[12:15], a[16:19], v[80:83]
    buffer_load_dwordx4 v12, s[8:11], s62 offen lds
    v_mfma_f32_16x16x32_bf16 v[84:87], a[12:15], a[20:23], v[84:87]
    v_mfma_f32_16x16x32_bf16 v[88:91], a[12:15], a[24:27], v[88:91]
    v_mfma_f32_16x16x32_bf16 v[92:95], a[12:15], a[28:31], v[92:95]
    s_waitcnt lgkmcnt(0)
    s_waitcnt vmcnt(16)
    s_barrier
    v_add_u32 v4, 0x10000, v4
    v_add_u32 v5, 0x10000, v5
    v_add_u32 v6, 0x10000, v6
    v_add_u32 v7, 0x10000, v7
    v_add_u32 v8, 0x10000, v8
    v_add_u32 v9, 0x10000, v9
    v_mfma_f32_16x16x32_bf16 v[32:35], a[32:35], a[48:51], v[32:35]
    ds_read_b64_tr_b16 a[0:1], v4 offset:0
    s_add_u32 m0, s48, 0x4000
    s_add_u32 s62, s87, 0
    v_mfma_f32_16x16x32_bf16 v[36:39], a[32:35], a[52:55], v[36:39]
    ds_read_b64_tr_b16 a[2:3], v4 offset:1024
    buffer_load_dwordx4 v10, s[4:7], s62 offen lds
    v_mfma_f32_16x16x32_bf16 v[40:43], a[32:35], a[56:59], v[40:43]
    ds_read_b64_tr_b16 a[4:5], v5 offset:0
    v_mfma_f32_16x16x32_bf16 v[44:47], a[32:35], a[60:63], v[44:47]
    ds_read_b64_tr_b16 a[6:7], v5 offset:1024
    v_mfma_f32_16x16x32_bf16 v[24:27], a[32:35], v[20:23], v[24:27]
    ds_read_b64_tr_b16 a[8:9], v6 offset:0
    s_add_u32 m0, s48, 0x4400
    s_add_u32 s62, s87, 0
    v_mfma_f32_16x16x32_bf16 v[48:51], a[36:39], a[48:51], v[48:51]
    ds_read_b64_tr_b16 a[10:11], v6 offset:1024
    buffer_load_dwordx4 v11, s[4:7], s62 offen lds
    v_mfma_f32_16x16x32_bf16 v[52:55], a[36:39], a[52:55], v[52:55]
    ds_read_b64_tr_b16 a[12:13], v7 offset:0
    v_mfma_f32_16x16x32_bf16 v[56:59], a[36:39], a[56:59], v[56:59]
    ds_read_b64_tr_b16 a[14:15], v7 offset:1024
    v_mfma_f32_16x16x32_bf16 v[60:63], a[36:39], a[60:63], v[60:63]
    ds_read_b128 a[16:19], v8 offset:0
    v_mfma_f32_16x16x32_bf16 v[28:31], a[36:39], v[20:23], v[28:31]
    ds_read_b128 a[20:23], v8 offset:2048
    s_add_u32 m0, s47, 0x2000
    s_add_u32 s62, s86, 0x1e000
    v_mfma_f32_16x16x32_bf16 v[64:67], a[40:43], a[48:51], v[64:67]
    ds_read_b128 a[24:27], v8 offset:4096
    buffer_load_dwordx4 v12, s[8:11], s62 offen lds
    v_mfma_f32_16x16x32_bf16 v[68:71], a[40:43], a[52:55], v[68:71]
    ds_read_b128 a[28:31], v8 offset:6144
    v_mfma_f32_16x16x32_bf16 v[72:75], a[40:43], a[56:59], v[72:75]
    v_mfma_f32_16x16x32_bf16 v[76:79], a[40:43], a[60:63], v[76:79]
    s_add_u32 m0, s47, 0x3000
    s_add_u32 s62, s86, 0x2d000
    v_mfma_f32_16x16x32_bf16 v[80:83], a[44:47], a[48:51], v[80:83]
    buffer_load_dwordx4 v12, s[8:11], s62 offen lds
    v_mfma_f32_16x16x32_bf16 v[84:87], a[44:47], a[52:55], v[84:87]
    v_mfma_f32_16x16x32_bf16 v[88:91], a[44:47], a[56:59], v[88:91]
    v_mfma_f32_16x16x32_bf16 v[92:95], a[44:47], a[60:63], v[92:95]
    s_waitcnt lgkmcnt(0)
    v_mfma_f32_16x16x32_bf16 v[32:35], a[0:3], a[16:19], v[32:35]
    ds_read_b64_tr_b16 a[32:33], v4 offset:8192
    s_add_u32 m0, s48, 0x4800
    s_add_u32 s62, s87, 20480
    v_mfma_f32_16x16x32_bf16 v[36:39], a[0:3], a[20:23], v[36:39]
    ds_read_b64_tr_b16 a[34:35], v4 offset:9216
    buffer_load_dwordx4 v10, s[4:7], s62 offen lds
    v_mfma_f32_16x16x32_bf16 v[40:43], a[0:3], a[24:27], v[40:43]
    ds_read_b64_tr_b16 a[36:37], v5 offset:8192
    v_mfma_f32_16x16x32_bf16 v[44:47], a[0:3], a[28:31], v[44:47]
    ds_read_b64_tr_b16 a[38:39], v5 offset:9216
    v_mfma_f32_16x16x32_bf16 v[24:27], a[0:3], v[20:23], v[24:27]
    ds_read_b64_tr_b16 a[40:41], v6 offset:8192
    s_add_u32 m0, s48, 0x4c00
    s_add_u32 s62, s87, 20480
    v_mfma_f32_16x16x32_bf16 v[48:51], a[4:7], a[16:19], v[48:51]
    ds_read_b64_tr_b16 a[42:43], v6 offset:9216
    buffer_load_dwordx4 v11, s[4:7], s62 offen lds
    v_mfma_f32_16x16x32_bf16 v[52:55], a[4:7], a[20:23], v[52:55]
    ds_read_b64_tr_b16 a[44:45], v7 offset:8192
    v_mfma_f32_16x16x32_bf16 v[56:59], a[4:7], a[24:27], v[56:59]
    ds_read_b64_tr_b16 a[46:47], v7 offset:9216
    v_mfma_f32_16x16x32_bf16 v[60:63], a[4:7], a[28:31], v[60:63]
    ds_read_b128 a[48:51], v9 offset:0
    v_mfma_f32_16x16x32_bf16 v[28:31], a[4:7], v[20:23], v[28:31]
    ds_read_b128 a[52:55], v9 offset:2048
    s_add_u32 s86, s86, 245760
    s_add_u32 s87, s87, 128
    s_cmp_ge_u32 s87, 1280
    s_cselect_b32 s86, 0, s86
    s_cselect_b32 s87, 0, s87
    s_add_u32 m0, s47, 0x8000
    s_add_u32 s62, s86, 0x0
    v_mfma_f32_16x16x32_bf16 v[64:67], a[8:11], a[16:19], v[64:67]
    ds_read_b128 a[56:59], v9 offset:4096
    buffer_load_dwordx4 v12, s[8:11], s62 offen lds
    v_mfma_f32_16x16x32_bf16 v[68:71], a[8:11], a[20:23], v[68:71]
    ds_read_b128 a[60:63], v9 offset:6144
    v_mfma_f32_16x16x32_bf16 v[72:75], a[8:11], a[24:27], v[72:75]
    v_mfma_f32_16x16x32_bf16 v[76:79], a[8:11], a[28:31], v[76:79]
    s_add_u32 m0, s47, 0x9000
    s_add_u32 s62, s86, 0xf000
    v_mfma_f32_16x16x32_bf16 v[80:83], a[12:15], a[16:19], v[80:83]
    buffer_load_dwordx4 v12, s[8:11], s62 offen lds
    v_mfma_f32_16x16x32_bf16 v[84:87], a[12:15], a[20:23], v[84:87]
    v_mfma_f32_16x16x32_bf16 v[88:91], a[12:15], a[24:27], v[88:91]
    v_mfma_f32_16x16x32_bf16 v[92:95], a[12:15], a[28:31], v[92:95]
    s_waitcnt lgkmcnt(0)
    s_waitcnt vmcnt(10)
    s_barrier
    v_mfma_f32_16x16x32_bf16 v[32:35], a[32:35], a[48:51], v[32:35]
    ds_read_b64_tr_b16 a[0:1], v4 offset:32768
    s_add_u32 m0, s48, 0xc000
    s_add_u32 s62, s87, 0
    v_mfma_f32_16x16x32_bf16 v[36:39], a[32:35], a[52:55], v[36:39]
    ds_read_b64_tr_b16 a[2:3], v4 offset:33792
    buffer_load_dwordx4 v10, s[4:7], s62 offen lds
    v_mfma_f32_16x16x32_bf16 v[40:43], a[32:35], a[56:59], v[40:43]
    ds_read_b64_tr_b16 a[4:5], v5 offset:32768
    v_mfma_f32_16x16x32_bf16 v[44:47], a[32:35], a[60:63], v[44:47]
    ds_read_b64_tr_b16 a[6:7], v5 offset:33792
    v_mfma_f32_16x16x32_bf16 v[24:27], a[32:35], v[20:23], v[24:27]
    ds_read_b64_tr_b16 a[8:9], v6 offset:32768
    s_add_u32 m0, s48, 0xc400
    s_add_u32 s62, s87, 0
    v_mfma_f32_16x16x32_bf16 v[48:51], a[36:39], a[48:51], v[48:51]
    ds_read_b64_tr_b16 a[10:11], v6 offset:33792
    buffer_load_dwordx4 v11, s[4:7], s62 offen lds
    v_mfma_f32_16x16x32_bf16 v[52:55], a[36:39], a[52:55], v[52:55]
    ds_read_b64_tr_b16 a[12:13], v7 offset:32768
    v_mfma_f32_16x16x32_bf16 v[56:59], a[36:39], a[56:59], v[56:59]
    ds_read_b64_tr_b16 a[14:15], v7 offset:33792
    v_mfma_f32_16x16x32_bf16 v[60:63], a[36:39], a[60:63], v[60:63]
    ds_read_b128 a[16:19], v8 offset:32768
    v_mfma_f32_16x16x32_bf16 v[28:31], a[36:39], v[20:23], v[28:31]
    ds_read_b128 a[20:23], v8 offset:34816
    s_add_u32 m0, s47, 0xa000
    s_add_u32 s62, s86, 0x1e000
    v_mfma_f32_16x16x32_bf16 v[64:67], a[40:43], a[48:51], v[64:67]
    ds_read_b128 a[24:27], v8 offset:36864
    buffer_load_dwordx4 v12, s[8:11], s62 offen lds
    v_mfma_f32_16x16x32_bf16 v[68:71], a[40:43], a[52:55], v[68:71]
    ds_read_b128 a[28:31], v8 offset:38912
    v_mfma_f32_16x16x32_bf16 v[72:75], a[40:43], a[56:59], v[72:75]
    ds_read_b64_tr_b16 v[120:121], v124
    v_mfma_f32_16x16x32_bf16 v[76:79], a[40:43], a[60:63], v[76:79]
    ds_read_b64_tr_b16 v[122:123], v124 offset:1536
    s_add_u32 m0, s47, 0xb000
    s_add_u32 s62, s86, 0x2d000
    v_mfma_f32_16x16x32_bf16 v[80:83], a[44:47], a[48:51], v[80:83]
    buffer_load_dwordx4 v12, s[8:11], s62 offen lds
    v_mfma_f32_16x16x32_bf16 v[84:87], a[44:47], a[52:55], v[84:87]
    v_mfma_f32_16x16x32_bf16 v[88:91], a[44:47], a[56:59], v[88:91]
    v_mfma_f32_16x16x32_bf16 v[92:95], a[44:47], a[60:63], v[92:95]
    s_waitcnt lgkmcnt(0)
    v_mfma_f32_16x16x32_bf16 v[32:35], a[0:3], a[16:19], v[32:35]
    ds_read_b64_tr_b16 a[32:33], v4 offset:40960
    s_add_u32 m0, s48, 0xc800
    s_add_u32 s62, s87, 20480
    v_mfma_f32_16x16x32_bf16 v[36:39], a[0:3], a[20:23], v[36:39]
    ds_read_b64_tr_b16 a[34:35], v4 offset:41984
    buffer_load_dwordx4 v10, s[4:7], s62 offen lds
    v_mfma_f32_16x16x32_bf16 v[40:43], a[0:3], a[24:27], v[40:43]
    ds_read_b64_tr_b16 a[36:37], v5 offset:40960
    v_mfma_f32_16x16x32_bf16 v[44:47], a[0:3], a[28:31], v[44:47]
    ds_read_b64_tr_b16 a[38:39], v5 offset:41984
    v_mfma_f32_16x16x32_bf16 v[24:27], a[0:3], v[20:23], v[24:27]
    ds_read_b64_tr_b16 a[40:41], v6 offset:40960
    s_add_u32 m0, s48, 0xcc00
    s_add_u32 s62, s87, 20480
    v_mfma_f32_16x16x32_bf16 v[48:51], a[4:7], a[16:19], v[48:51]
    ds_read_b64_tr_b16 a[42:43], v6 offset:41984
    buffer_load_dwordx4 v11, s[4:7], s62 offen lds
    v_mfma_f32_16x16x32_bf16 v[52:55], a[4:7], a[20:23], v[52:55]
    ds_read_b64_tr_b16 a[44:45], v7 offset:40960
    v_mfma_f32_16x16x32_bf16 v[56:59], a[4:7], a[24:27], v[56:59]
    ds_read_b64_tr_b16 a[46:47], v7 offset:41984
    v_mfma_f32_16x16x32_bf16 v[60:63], a[4:7], a[28:31], v[60:63]
    ds_read_b128 a[48:51], v9 offset:32768
    buffer_store_dwordx4 v[120:123], v130, s[28:31], 0 offen sc1
    v_mfma_f32_16x16x32_bf16 v[28:31], a[4:7], v[20:23], v[28:31]
    ds_read_b128 a[52:55], v9 offset:34816
    v_mfma_f32_16x16x32_bf16 v[64:67], a[8:11], a[16:19], v[64:67]
    ds_read_b128 a[56:59], v9 offset:36864
    v_mfma_f32_16x16x32_bf16 v[68:71], a[8:11], a[20:23], v[68:71]
    ds_read_b128 a[60:63], v9 offset:38912
    v_mfma_f32_16x16x32_bf16 v[72:75], a[8:11], a[24:27], v[72:75]
    ds_read_b64_tr_b16 v[116:117], v125
    v_mfma_f32_16x16x32_bf16 v[76:79], a[8:11], a[28:31], v[76:79]
    ds_read_b64_tr_b16 v[118:119], v125 offset:1536
    v_mfma_f32_16x16x32_bf16 v[80:83], a[12:15], a[16:19], v[80:83]
    v_mfma_f32_16x16x32_bf16 v[84:87], a[12:15], a[20:23], v[84:87]
    v_mfma_f32_16x16x32_bf16 v[88:91], a[12:15], a[24:27], v[88:91]
    v_mfma_f32_16x16x32_bf16 v[92:95], a[12:15], a[28:31], v[92:95]
    s_waitcnt lgkmcnt(0)
    s_waitcnt vmcnt(9)
    s_barrier
    v_subrev_u32 v4, 0x10000, v4
    v_subrev_u32 v5, 0x10000, v5
    v_subrev_u32 v6, 0x10000, v6
    v_subrev_u32 v7, 0x10000, v7
    v_subrev_u32 v8, 0x10000, v8
    v_subrev_u32 v9, 0x10000, v9
    v_mfma_f32_16x16x32_bf16 v[32:35], a[32:35], a[48:51], v[32:35]
    ds_read_b64_tr_b16 a[0:1], v4 offset:0
    v_mfma_f32_16x16x32_bf16 v[36:39], a[32:35], a[52:55], v[36:39]
    ds_read_b64_tr_b16 a[2:3], v4 offset:1024
    v_mfma_f32_16x16x32_bf16 v[40:43], a[32:35], a[56:59], v[40:43]
    ds_read_b64_tr_b16 a[4:5], v5 offset:0
    v_mfma_f32_16x16x32_bf16 v[44:47], a[32:35], a[60:63], v[44:47]
    ds_read_b64_tr_b16 a[6:7], v5 offset:1024
    v_mfma_f32_16x16x32_bf16 v[24:27], a[32:35], v[20:23], v[24:27]
    ds_read_b64_tr_b16 a[8:9], v6 offset:0
    v_mfma_f32_16x16x32_bf16 v[48:51], a[36:39], a[48:51], v[48:51]
    ds_read_b64_tr_b16 a[10:11], v6 offset:1024
    v_mfma_f32_16x16x32_bf16 v[52:55], a[36:39], a[52:55], v[52:55]
    ds_read_b64_tr_b16 a[12:13], v7 offset:0
    v_mfma_f32_16x16x32_bf16 v[56:59], a[36:39], a[56:59], v[56:59]
    ds_read_b64_tr_b16 a[14:15], v7 offset:1024
    v_mfma_f32_16x16x32_bf16 v[60:63], a[36:39], a[60:63], v[60:63]
    ds_read_b128 a[16:19], v8 offset:0
    buffer_store_dwordx4 v[116:119], v131, s[28:31], 0 offen sc1
    v_mfma_f32_16x16x32_bf16 v[28:31], a[36:39], v[20:23], v[28:31]
    ds_read_b128 a[20:23], v8 offset:2048
    v_mfma_f32_16x16x32_bf16 v[64:67], a[40:43], a[48:51], v[64:67]
    ds_read_b128 a[24:27], v8 offset:4096
    v_mfma_f32_16x16x32_bf16 v[68:71], a[40:43], a[52:55], v[68:71]
    ds_read_b128 a[28:31], v8 offset:6144
    v_mfma_f32_16x16x32_bf16 v[72:75], a[40:43], a[56:59], v[72:75]
    ds_read_b64_tr_b16 v[120:121], v126
    v_mfma_f32_16x16x32_bf16 v[76:79], a[40:43], a[60:63], v[76:79]
    ds_read_b64_tr_b16 v[122:123], v126 offset:1536
    v_mfma_f32_16x16x32_bf16 v[80:83], a[44:47], a[48:51], v[80:83]
    v_mfma_f32_16x16x32_bf16 v[84:87], a[44:47], a[52:55], v[84:87]
    v_mfma_f32_16x16x32_bf16 v[88:91], a[44:47], a[56:59], v[88:91]
    v_mov_b32 v114, 0
    buffer_load_dwordx2 v[112:113], v114, s[32:35], 0 offen sc1
    v_mfma_f32_16x16x32_bf16 v[92:95], a[44:47], a[60:63], v[92:95]
    s_waitcnt lgkmcnt(0)
    v_mfma_f32_16x16x32_bf16 v[32:35], a[0:3], a[16:19], v[32:35]
    ds_read_b64_tr_b16 a[32:33], v4 offset:8192
    v_mfma_f32_16x16x32_bf16 v[36:39], a[0:3], a[20:23], v[36:39]
    ds_read_b64_tr_b16 a[34:35], v4 offset:9216
    v_mfma_f32_16x16x32_bf16 v[40:43], a[0:3], a[24:27], v[40:43]
    ds_read_b64_tr_b16 a[36:37], v5 offset:8192
    v_mfma_f32_16x16x32_bf16 v[44:47], a[0:3], a[28:31], v[44:47]
    ds_read_b64_tr_b16 a[38:39], v5 offset:9216
    v_mfma_f32_16x16x32_bf16 v[24:27], a[0:3], v[20:23], v[24:27]
    ds_read_b64_tr_b16 a[40:41], v6 offset:8192
    v_mfma_f32_16x16x32_bf16 v[48:51], a[4:7], a[16:19], v[48:51]
    ds_read_b64_tr_b16 a[42:43], v6 offset:9216
    v_mfma_f32_16x16x32_bf16 v[52:55], a[4:7], a[20:23], v[52:55]
    ds_read_b64_tr_b16 a[44:45], v7 offset:8192
    v_mfma_f32_16x16x32_bf16 v[56:59], a[4:7], a[24:27], v[56:59]
    ds_read_b64_tr_b16 a[46:47], v7 offset:9216
    v_mfma_f32_16x16x32_bf16 v[60:63], a[4:7], a[28:31], v[60:63]
    ds_read_b128 a[48:51], v9 offset:0
    buffer_store_dwordx4 v[120:123], v132, s[28:31], 0 offen sc1
    v_mfma_f32_16x16x32_bf16 v[28:31], a[4:7], v[20:23], v[28:31]
    ds_read_b128 a[52:55], v9 offset:2048
    v_mfma_f32_16x16x32_bf16 v[64:67], a[8:11], a[16:19], v[64:67]
    ds_read_b128 a[56:59], v9 offset:4096
    v_mfma_f32_16x16x32_bf16 v[68:71], a[8:11], a[20:23], v[68:71]
    ds_read_b128 a[60:63], v9 offset:6144
    v_mfma_f32_16x16x32_bf16 v[72:75], a[8:11], a[24:27], v[72:75]
    ds_read_b64_tr_b16 v[116:117], v127
    v_mfma_f32_16x16x32_bf16 v[76:79], a[8:11], a[28:31], v[76:79]
    ds_read_b64_tr_b16 v[118:119], v127 offset:1536
    v_mfma_f32_16x16x32_bf16 v[80:83], a[12:15], a[16:19], v[80:83]
    v_mfma_f32_16x16x32_bf16 v[84:87], a[12:15], a[20:23], v[84:87]
    v_mfma_f32_16x16x32_bf16 v[88:91], a[12:15], a[24:27], v[88:91]
    v_mfma_f32_16x16x32_bf16 v[92:95], a[12:15], a[28:31], v[92:95]
    s_waitcnt lgkmcnt(0)
    s_waitcnt vmcnt(4)
    s_barrier
    v_mfma_f32_16x16x32_bf16 v[32:35], a[32:35], a[48:51], v[32:35]
    ds_read_b64_tr_b16 a[0:1], v4 offset:32768
    v_mfma_f32_16x16x32_bf16 v[36:39], a[32:35], a[52:55], v[36:39]
    ds_read_b64_tr_b16 a[2:3], v4 offset:33792
    v_mfma_f32_16x16x32_bf16 v[40:43], a[32:35], a[56:59], v[40:43]
    ds_read_b64_tr_b16 a[4:5], v5 offset:32768
    v_mfma_f32_16x16x32_bf16 v[44:47], a[32:35], a[60:63], v[44:47]
    ds_read_b64_tr_b16 a[6:7], v5 offset:33792
    v_mfma_f32_16x16x32_bf16 v[24:27], a[32:35], v[20:23], v[24:27]
    ds_read_b64_tr_b16 a[8:9], v6 offset:32768
    v_mfma_f32_16x16x32_bf16 v[48:51], a[36:39], a[48:51], v[48:51]
    ds_read_b64_tr_b16 a[10:11], v6 offset:33792
    v_mfma_f32_16x16x32_bf16 v[52:55], a[36:39], a[52:55], v[52:55]
    ds_read_b64_tr_b16 a[12:13], v7 offset:32768
    v_mfma_f32_16x16x32_bf16 v[56:59], a[36:39], a[56:59], v[56:59]
    ds_read_b64_tr_b16 a[14:15], v7 offset:33792
    v_mfma_f32_16x16x32_bf16 v[60:63], a[36:39], a[60:63], v[60:63]
    ds_read_b128 a[16:19], v8 offset:32768
    buffer_store_dwordx4 v[116:119], v133, s[28:31], 0 offen sc1
    v_mfma_f32_16x16x32_bf16 v[28:31], a[36:39], v[20:23], v[28:31]
    ds_read_b128 a[20:23], v8 offset:34816
    v_mfma_f32_16x16x32_bf16 v[64:67], a[40:43], a[48:51], v[64:67]
    ds_read_b128 a[24:27], v8 offset:36864
    v_mfma_f32_16x16x32_bf16 v[68:71], a[40:43], a[52:55], v[68:71]
    ds_read_b128 a[28:31], v8 offset:38912
    v_mfma_f32_16x16x32_bf16 v[72:75], a[40:43], a[56:59], v[72:75]
    ds_read_b64_tr_b16 v[120:121], v128
    v_mfma_f32_16x16x32_bf16 v[76:79], a[40:43], a[60:63], v[76:79]
    ds_read_b64_tr_b16 v[122:123], v128 offset:1536
    v_mfma_f32_16x16x32_bf16 v[80:83], a[44:47], a[48:51], v[80:83]
    v_mfma_f32_16x16x32_bf16 v[84:87], a[44:47], a[52:55], v[84:87]
    v_mfma_f32_16x16x32_bf16 v[88:91], a[44:47], a[56:59], v[88:91]
    s_lshl_b32 s44, s37, 7
    s_lshr_b32 s45, s36, 1
    s_lshl_b32 s45, s45, 6
    s_add_u32 s44, s44, s45
    v_add_u32 v208, s44, v2
    v_lshlrev_b32 v208, 4, v208
    v_add_u32 v19, 0x20000, v208
    buffer_load_dwordx4 v[96:99], v19, s[28:31], 0 offen offset:0 sc1
    buffer_load_dwordx4 v[100:103], v19, s[28:31], 0 offen offset:256 sc1
    buffer_load_dwordx4 v[104:107], v19, s[28:31], 0 offen offset:512 sc1
    buffer_load_dwordx4 v[108:111], v19, s[28:31], 0 offen offset:768 sc1
    v_mfma_f32_16x16x32_bf16 v[92:95], a[44:47], a[60:63], v[92:95]
    s_waitcnt lgkmcnt(0)
    v_mfma_f32_16x16x32_bf16 v[32:35], a[0:3], a[16:19], v[32:35]
    ds_read_b64_tr_b16 a[32:33], v4 offset:40960
    v_mfma_f32_16x16x32_bf16 v[36:39], a[0:3], a[20:23], v[36:39]
    ds_read_b64_tr_b16 a[34:35], v4 offset:41984
    v_mfma_f32_16x16x32_bf16 v[40:43], a[0:3], a[24:27], v[40:43]
    ds_read_b64_tr_b16 a[36:37], v5 offset:40960
    v_mfma_f32_16x16x32_bf16 v[44:47], a[0:3], a[28:31], v[44:47]
    ds_read_b64_tr_b16 a[38:39], v5 offset:41984
    v_mfma_f32_16x16x32_bf16 v[24:27], a[0:3], v[20:23], v[24:27]
    ds_read_b64_tr_b16 a[40:41], v6 offset:40960
    v_mfma_f32_16x16x32_bf16 v[48:51], a[4:7], a[16:19], v[48:51]
    ds_read_b64_tr_b16 a[42:43], v6 offset:41984
    v_mfma_f32_16x16x32_bf16 v[52:55], a[4:7], a[20:23], v[52:55]
    ds_read_b64_tr_b16 a[44:45], v7 offset:40960
    v_mfma_f32_16x16x32_bf16 v[56:59], a[4:7], a[24:27], v[56:59]
    ds_read_b64_tr_b16 a[46:47], v7 offset:41984
    v_mfma_f32_16x16x32_bf16 v[60:63], a[4:7], a[28:31], v[60:63]
    ds_read_b128 a[48:51], v9 offset:32768
    buffer_store_dwordx4 v[120:123], v134, s[28:31], 0 offen sc1
    v_mfma_f32_16x16x32_bf16 v[28:31], a[4:7], v[20:23], v[28:31]
    ds_read_b128 a[52:55], v9 offset:34816
    v_mfma_f32_16x16x32_bf16 v[64:67], a[8:11], a[16:19], v[64:67]
    ds_read_b128 a[56:59], v9 offset:36864
    v_mfma_f32_16x16x32_bf16 v[68:71], a[8:11], a[20:23], v[68:71]
    ds_read_b128 a[60:63], v9 offset:38912
    v_mfma_f32_16x16x32_bf16 v[72:75], a[8:11], a[24:27], v[72:75]
    ds_read_b64_tr_b16 v[116:117], v129
    v_mfma_f32_16x16x32_bf16 v[76:79], a[8:11], a[28:31], v[76:79]
    ds_read_b64_tr_b16 v[118:119], v129 offset:1536
    v_mfma_f32_16x16x32_bf16 v[80:83], a[12:15], a[16:19], v[80:83]
    v_mfma_f32_16x16x32_bf16 v[84:87], a[12:15], a[20:23], v[84:87]
    v_mfma_f32_16x16x32_bf16 v[88:91], a[12:15], a[24:27], v[88:91]
    v_mfma_f32_16x16x32_bf16 v[92:95], a[12:15], a[28:31], v[92:95]
    s_waitcnt lgkmcnt(0)
    v_mfma_f32_16x16x32_bf16 v[32:35], a[32:35], a[48:51], v[32:35]
    v_mfma_f32_16x16x32_bf16 v[36:39], a[32:35], a[52:55], v[36:39]
    v_mfma_f32_16x16x32_bf16 v[40:43], a[32:35], a[56:59], v[40:43]
    v_mfma_f32_16x16x32_bf16 v[44:47], a[32:35], a[60:63], v[44:47]
    v_mfma_f32_16x16x32_bf16 v[24:27], a[32:35], v[20:23], v[24:27]
    v_mfma_f32_16x16x32_bf16 v[48:51], a[36:39], a[48:51], v[48:51]
    v_mfma_f32_16x16x32_bf16 v[52:55], a[36:39], a[52:55], v[52:55]
    v_mfma_f32_16x16x32_bf16 v[56:59], a[36:39], a[56:59], v[56:59]
    v_mfma_f32_16x16x32_bf16 v[60:63], a[36:39], a[60:63], v[60:63]
    buffer_store_dwordx4 v[116:119], v135, s[28:31], 0 offen sc1
    v_mfma_f32_16x16x32_bf16 v[28:31], a[36:39], v[20:23], v[28:31]
    v_mfma_f32_16x16x32_bf16 v[64:67], a[40:43], a[48:51], v[64:67]
    v_mfma_f32_16x16x32_bf16 v[68:71], a[40:43], a[52:55], v[68:71]
    v_mfma_f32_16x16x32_bf16 v[72:75], a[40:43], a[56:59], v[72:75]
    v_mfma_f32_16x16x32_bf16 v[76:79], a[40:43], a[60:63], v[76:79]
    v_mfma_f32_16x16x32_bf16 v[80:83], a[44:47], a[48:51], v[80:83]
    v_mfma_f32_16x16x32_bf16 v[84:87], a[44:47], a[52:55], v[84:87]
    v_mfma_f32_16x16x32_bf16 v[88:91], a[44:47], a[56:59], v[88:91]
    v_mfma_f32_16x16x32_bf16 v[92:95], a[44:47], a[60:63], v[92:95]
    s_lshr_b32 s44, s36, 1
    s_and_b32 s45, s36, 1
    s_lshl_b32 s45, s45, 1
    s_add_u32 s46, s44, s45
    s_xor_b32 s44, s44, 1
    s_add_u32 s50, s44, s45
    s_lshl_b32 s51, s46, 7
    s_add_u32 s51, s51, 0x26000
    v_lshlrev_b32 v208, 4, v3
    v_add_u32 v209, s51, v208
    v_cmp_eq_u32 vcc, 0, v2
    s_nop 1
    s_and_saveexec_b64 s[52:53], vcc
    ds_write_b128 v209, v[24:27]
    ds_write_b128 v209, v[28:31] offset:64
    s_mov_b64 exec, s[52:53]
    s_mov_b32 s61, s46
    s_waitcnt vmcnt(8)
    v_readfirstlane_b32 s42, v112
    v_readfirstlane_b32 s43, v113
    s_nop 0
    s_cmp_lg_u32 s42, 0
    s_cbranch_scc1 ND_5
    s_mov_b32 s44, 0
NL_4:
    buffer_load_dwordx2 v[112:113], v114, s[32:35], 0 offen sc1
    s_waitcnt vmcnt(0)
    v_readfirstlane_b32 s42, v112
    v_readfirstlane_b32 s43, v113
    s_add_u32 s44, s44, 1
    s_cmp_gt_u32 s44, 20000
    s_cbranch_scc1 ND_5
    s_cmp_eq_u32 s42, 0
    s_cbranch_scc1 NL_4
ND_5:
    s_waitcnt vmcnt(2)
    s_mov_b32 s44, 0
SR_6:
    s_mov_b64 s[52:53], -1
    v_cmp_eq_u32 s[54:55], s42, v98
    v_cmp_eq_u32 s[56:57], s43, v99
    s_nop 0
    s_and_b64 s[52:53], s[52:53], s[54:55]
    s_and_b64 s[52:53], s[52:53], s[56:57]
    v_cmp_eq_u32 s[54:55], s42, v102
    v_cmp_eq_u32 s[56:57], s43, v103
    s_nop 0
    s_and_b64 s[52:53], s[52:53], s[54:55]
    s_and_b64 s[52:53], s[52:53], s[56:57]
    v_cmp_eq_u32 s[54:55], s42, v106
    v_cmp_eq_u32 s[56:57], s43, v107
    s_nop 0
    s_and_b64 s[52:53], s[52:53], s[54:55]
    s_and_b64 s[52:53], s[52:53], s[56:57]
    v_cmp_eq_u32 s[54:55], s42, v110
    v_cmp_eq_u32 s[56:57], s43, v111
    s_nop 0
    s_and_b64 s[52:53], s[52:53], s[54:55]
    s_and_b64 s[52:53], s[52:53], s[56:57]
    s_cmp_eq_u64 s[52:53], -1
    s_cbranch_scc1 SD_7
    s_add_u32 s44, s44, 1
    s_cmp_gt_u32 s44, 20000
    s_cbranch_scc1 SD_7
    buffer_load_dwordx4 v[96:99], v19, s[28:31], 0 offen offset:0 sc1
    buffer_load_dwordx4 v[100:103], v19, s[28:31], 0 offen offset:256 sc1
    buffer_load_dwordx4 v[104:107], v19, s[28:31], 0 offen offset:512 sc1
    buffer_load_dwordx4 v[108:111], v19, s[28:31], 0 offen offset:768 sc1
    s_waitcnt vmcnt(0)
    s_branch SR_6
SD_7:
    s_waitcnt lgkmcnt(0)
    s_barrier
    s_lshl_b32 s52, s50, 7
    s_add_u32 s52, s52, 0x26000
    v_add_u32 v209, s52, v208
    ds_read_b128 v[154:157], v209
    ds_read_b128 v[158:161], v209 offset:64
    v_mov_b32 v146, v24
    v_mov_b32 v147, v25
    v_mov_b32 v148, v26
    v_mov_b32 v149, v27
    v_mov_b32 v150, v28
    v_mov_b32 v151, v29
    v_mov_b32 v152, v30
    v_mov_b32 v153, v31
    s_cmp_lt_u32 s38, 5
    s_mov_b32 s53, 0x3f800000
    s_cselect_b32 s53, 0x3ea52b5c, s53
    v_mul_f32 v97, s53, v97
    v_xor_b32 v96, 0x80000000, v96
    v_mul_f32 v101, s53, v101
    v_xor_b32 v100, 0x80000000, v100
    v_mul_f32 v105, s53, v105
    v_xor_b32 v104, 0x80000000, v104
    v_mul_f32 v109, s53, v109
    v_xor_b32 v108, 0x80000000, v108
    v_lshlrev_b32 v210, 11, v3
    v_add_u32 v210, v210, v2
    v_lshlrev_b32 v210, 4, v210
    s_lshl_b32 s54, s37, 7
    s_lshr_b32 s55, s36, 1
    s_lshl_b32 s55, s55, 6
    s_add_u32 s54, s54, s55
    s_lshl_b32 s55, s38, 4
    s_lshl_b32 s56, s61, 2
    s_add_u32 s56, s56, s55
    s_lshl_b32 s56, s56, 11
    s_add_u32 s56, s56, s54
    s_lshl_b32 s56, s56, 4
    s_add_u32 s58, s56, 0x100000
    s_lshl_b32 s56, s50, 2
    s_add_u32 s56, s56, s55
    s_lshl_b32 s56, s56, 11
    s_add_u32 s56, s56, s54
    s_lshl_b32 s56, s56, 4
    s_add_u32 s59, s56, 0x100000
    s_waitcnt lgkmcnt(0)
    v_pk_fma_f32 v[32:33], v[146:147], v[96:97], v[32:33] op_sel_hi:[1,0,1]
    v_pk_fma_f32 v[34:35], v[148:149], v[96:97], v[34:35] op_sel_hi:[1,0,1]
    v_pk_mul_f32 v[32:33], v[32:33], v[96:97] op_sel:[0,1] op_sel_hi:[1,1]
    v_pk_mul_f32 v[34:35], v[34:35], v[96:97] op_sel:[0,1] op_sel_hi:[1,1]
    v_cvt_pk_bf16_f32 v32, v32, v33
    v_cvt_pk_bf16_f32 v33, v34, v35
    v_pk_fma_f32 v[48:49], v[150:151], v[96:97], v[48:49] op_sel_hi:[1,0,1]
    v_pk_fma_f32 v[50:51], v[152:153], v[96:97], v[50:51] op_sel_hi:[1,0,1]
    v_pk_mul_f32 v[48:49], v[48:49], v[96:97] op_sel:[0,1] op_sel_hi:[1,1]
    v_pk_mul_f32 v[50:51], v[50:51], v[96:97] op_sel:[0,1] op_sel_hi:[1,1]
    v_cvt_pk_bf16_f32 v48, v48, v49
    v_cvt_pk_bf16_f32 v49, v50, v51
    v_cndmask_b32 v188, v32, v48, s[84:85]
    v_cndmask_b32 v189, v33, v49, s[84:85]
    v_cndmask_b32 v190, v48, v32, s[84:85]
    v_cndmask_b32 v191, v49, v33, s[84:85]
    buffer_store_dwordx4 v[188:191], v210, s[28:31], s58 offen offset:0 sc1
    v_pk_fma_f32 v[36:37], v[146:147], v[100:101], v[36:37] op_sel_hi:[1,0,1]
    v_pk_fma_f32 v[38:39], v[148:149], v[100:101], v[38:39] op_sel_hi:[1,0,1]
    v_pk_mul_f32 v[36:37], v[36:37], v[100:101] op_sel:[0,1] op_sel_hi:[1,1]
    v_pk_mul_f32 v[38:39], v[38:39], v[100:101] op_sel:[0,1] op_sel_hi:[1,1]
    v_cvt_pk_bf16_f32 v36, v36, v37
    v_cvt_pk_bf16_f32 v37, v38, v39
    v_pk_fma_f32 v[52:53], v[150:151], v[100:101], v[52:53] op_sel_hi:[1,0,1]
    v_pk_fma_f32 v[54:55], v[152:153], v[100:101], v[54:55] op_sel_hi:[1,0,1]
    v_pk_mul_f32 v[52:53], v[52:53], v[100:101] op_sel:[0,1] op_sel_hi:[1,1]
    v_pk_mul_f32 v[54:55], v[54:55], v[100:101] op_sel:[0,1] op_sel_hi:[1,1]
    v_cvt_pk_bf16_f32 v52, v52, v53
    v_cvt_pk_bf16_f32 v53, v54, v55
    v_cndmask_b32 v192, v36, v52, s[84:85]
    v_cndmask_b32 v193, v37, v53, s[84:85]
    v_cndmask_b32 v194, v52, v36, s[84:85]
    v_cndmask_b32 v195, v53, v37, s[84:85]
    buffer_store_dwordx4 v[192:195], v210, s[28:31], s58 offen offset:256 sc1
    v_pk_fma_f32 v[40:41], v[146:147], v[104:105], v[40:41] op_sel_hi:[1,0,1]
    v_pk_fma_f32 v[42:43], v[148:149], v[104:105], v[42:43] op_sel_hi:[1,0,1]
    v_pk_mul_f32 v[40:41], v[40:41], v[104:105] op_sel:[0,1] op_sel_hi:[1,1]
    v_pk_mul_f32 v[42:43], v[42:43], v[104:105] op_sel:[0,1] op_sel_hi:[1,1]
    v_cvt_pk_bf16_f32 v40, v40, v41
    v_cvt_pk_bf16_f32 v41, v42, v43
    v_pk_fma_f32 v[56:57], v[150:151], v[104:105], v[56:57] op_sel_hi:[1,0,1]
    v_pk_fma_f32 v[58:59], v[152:153], v[104:105], v[58:59] op_sel_hi:[1,0,1]
    v_pk_mul_f32 v[56:57], v[56:57], v[104:105] op_sel:[0,1] op_sel_hi:[1,1]
    v_pk_mul_f32 v[58:59], v[58:59], v[104:105] op_sel:[0,1] op_sel_hi:[1,1]
    v_cvt_pk_bf16_f32 v56, v56, v57
    v_cvt_pk_bf16_f32 v57, v58, v59
    v_cndmask_b32 v196, v40, v56, s[84:85]
    v_cndmask_b32 v197, v41, v57, s[84:85]
    v_cndmask_b32 v198, v56, v40, s[84:85]
    v_cndmask_b32 v199, v57, v41, s[84:85]
    buffer_store_dwordx4 v[196:199], v210, s[28:31], s58 offen offset:512 sc1
    v_pk_fma_f32 v[44:45], v[146:147], v[108:109], v[44:45] op_sel_hi:[1,0,1]
    v_pk_fma_f32 v[46:47], v[148:149], v[108:109], v[46:47] op_sel_hi:[1,0,1]
    v_pk_mul_f32 v[44:45], v[44:45], v[108:109] op_sel:[0,1] op_sel_hi:[1,1]
    v_pk_mul_f32 v[46:47], v[46:47], v[108:109] op_sel:[0,1] op_sel_hi:[1,1]
    v_cvt_pk_bf16_f32 v44, v44, v45
    v_cvt_pk_bf16_f32 v45, v46, v47
    v_pk_fma_f32 v[60:61], v[150:151], v[108:109], v[60:61] op_sel_hi:[1,0,1]
    v_pk_fma_f32 v[62:63], v[152:153], v[108:109], v[62:63] op_sel_hi:[1,0,1]
    v_pk_mul_f32 v[60:61], v[60:61], v[108:109] op_sel:[0,1] op_sel_hi:[1,1]
    v_pk_mul_f32 v[62:63], v[62:63], v[108:109] op_sel:[0,1] op_sel_hi:[1,1]
    v_cvt_pk_bf16_f32 v60, v60, v61
    v_cvt_pk_bf16_f32 v61, v62, v63
    v_cndmask_b32 v200, v44, v60, s[84:85]
    v_cndmask_b32 v201, v45, v61, s[84:85]
    v_cndmask_b32 v202, v60, v44, s[84:85]
    v_cndmask_b32 v203, v61, v45, s[84:85]
    buffer_store_dwordx4 v[200:203], v210, s[28:31], s58 offen offset:768 sc1
    v_pk_fma_f32 v[64:65], v[154:155], v[96:97], v[64:65] op_sel_hi:[1,0,1]
    v_pk_fma_f32 v[66:67], v[156:157], v[96:97], v[66:67] op_sel_hi:[1,0,1]
    v_pk_mul_f32 v[64:65], v[64:65], v[96:97] op_sel:[0,1] op_sel_hi:[1,1]
    v_pk_mul_f32 v[66:67], v[66:67], v[96:97] op_sel:[0,1] op_sel_hi:[1,1]
    v_cvt_pk_bf16_f32 v64, v64, v65
    v_cvt_pk_bf16_f32 v65, v66, v67
    v_pk_fma_f32 v[80:81], v[158:159], v[96:97], v[80:81] op_sel_hi:[1,0,1]
    v_pk_fma_f32 v[82:83], v[160:161], v[96:97], v[82:83] op_sel_hi:[1,0,1]
    v_pk_mul_f32 v[80:81], v[80:81], v[96:97] op_sel:[0,1] op_sel_hi:[1,1]
    v_pk_mul_f32 v[82:83], v[82:83], v[96:97] op_sel:[0,1] op_sel_hi:[1,1]
    v_cvt_pk_bf16_f32 v80, v80, v81
    v_cvt_pk_bf16_f32 v81, v82, v83
    v_cndmask_b32 v188, v64, v80, s[84:85]
    v_cndmask_b32 v189, v65, v81, s[84:85]
    v_cndmask_b32 v190, v80, v64, s[84:85]
    v_cndmask_b32 v191, v81, v65, s[84:85]
    buffer_store_dwordx4 v[188:191], v210, s[28:31], s59 offen offset:0 sc1
    v_pk_fma_f32 v[68:69], v[154:155], v[100:101], v[68:69] op_sel_hi:[1,0,1]
    v_pk_fma_f32 v[70:71], v[156:157], v[100:101], v[70:71] op_sel_hi:[1,0,1]
    v_pk_mul_f32 v[68:69], v[68:69], v[100:101] op_sel:[0,1] op_sel_hi:[1,1]
    v_pk_mul_f32 v[70:71], v[70:71], v[100:101] op_sel:[0,1] op_sel_hi:[1,1]
    v_cvt_pk_bf16_f32 v68, v68, v69
    v_cvt_pk_bf16_f32 v69, v70, v71
    v_pk_fma_f32 v[84:85], v[158:159], v[100:101], v[84:85] op_sel_hi:[1,0,1]
    v_pk_fma_f32 v[86:87], v[160:161], v[100:101], v[86:87] op_sel_hi:[1,0,1]
    v_pk_mul_f32 v[84:85], v[84:85], v[100:101] op_sel:[0,1] op_sel_hi:[1,1]
    v_pk_mul_f32 v[86:87], v[86:87], v[100:101] op_sel:[0,1] op_sel_hi:[1,1]
    v_cvt_pk_bf16_f32 v84, v84, v85
    v_cvt_pk_bf16_f32 v85, v86, v87
    v_cndmask_b32 v192, v68, v84, s[84:85]
    v_cndmask_b32 v193, v69, v85, s[84:85]
    v_cndmask_b32 v194, v84, v68, s[84:85]
    v_cndmask_b32 v195, v85, v69, s[84:85]
    buffer_store_dwordx4 v[192:195], v210, s[28:31], s59 offen offset:256 sc1
    v_pk_fma_f32 v[72:73], v[154:155], v[104:105], v[72:73] op_sel_hi:[1,0,1]
    v_pk_fma_f32 v[74:75], v[156:157], v[104:105], v[74:75] op_sel_hi:[1,0,1]
    v_pk_mul_f32 v[72:73], v[72:73], v[104:105] op_sel:[0,1] op_sel_hi:[1,1]
    v_pk_mul_f32 v[74:75], v[74:75], v[104:105] op_sel:[0,1] op_sel_hi:[1,1]
    v_cvt_pk_bf16_f32 v72, v72, v73
    v_cvt_pk_bf16_f32 v73, v74, v75
    v_pk_fma_f32 v[88:89], v[158:159], v[104:105], v[88:89] op_sel_hi:[1,0,1]
    v_pk_fma_f32 v[90:91], v[160:161], v[104:105], v[90:91] op_sel_hi:[1,0,1]
    v_pk_mul_f32 v[88:89], v[88:89], v[104:105] op_sel:[0,1] op_sel_hi:[1,1]
    v_pk_mul_f32 v[90:91], v[90:91], v[104:105] op_sel:[0,1] op_sel_hi:[1,1]
    v_cvt_pk_bf16_f32 v88, v88, v89
    v_cvt_pk_bf16_f32 v89, v90, v91
    v_cndmask_b32 v196, v72, v88, s[84:85]
    v_cndmask_b32 v197, v73, v89, s[84:85]
    v_cndmask_b32 v198, v88, v72, s[84:85]
    v_cndmask_b32 v199, v89, v73, s[84:85]
    buffer_store_dwordx4 v[196:199], v210, s[28:31], s59 offen offset:512 sc1
    v_pk_fma_f32 v[76:77], v[154:155], v[108:109], v[76:77] op_sel_hi:[1,0,1]
    v_pk_fma_f32 v[78:79], v[156:157], v[108:109], v[78:79] op_sel_hi:[1,0,1]
    v_pk_mul_f32 v[76:77], v[76:77], v[108:109] op_sel:[0,1] op_sel_hi:[1,1]
    v_pk_mul_f32 v[78:79], v[78:79], v[108:109] op_sel:[0,1] op_sel_hi:[1,1]
    v_cvt_pk_bf16_f32 v76, v76, v77
    v_cvt_pk_bf16_f32 v77, v78, v79
    v_pk_fma_f32 v[92:93], v[158:159], v[108:109], v[92:93] op_sel_hi:[1,0,1]
    v_pk_fma_f32 v[94:95], v[160:161], v[108:109], v[94:95] op_sel_hi:[1,0,1]
    v_pk_mul_f32 v[92:93], v[92:93], v[108:109] op_sel:[0,1] op_sel_hi:[1,1]
    v_pk_mul_f32 v[94:95], v[94:95], v[108:109] op_sel:[0,1] op_sel_hi:[1,1]
    v_cvt_pk_bf16_f32 v92, v92, v93
    v_cvt_pk_bf16_f32 v93, v94, v95
    v_cndmask_b32 v200, v76, v92, s[84:85]
    v_cndmask_b32 v201, v77, v93, s[84:85]
    v_cndmask_b32 v202, v92, v76, s[84:85]
    v_cndmask_b32 v203, v93, v77, s[84:85]
    buffer_store_dwordx4 v[200:203], v210, s[28:31], s59 offen offset:768 sc1
    s_branch P1J_2
HELP_1:
    s_mov_b32 s12, s68
    s_and_b32 s13, s69, 0xffff
    s_mov_b32 s14, 0xc8000
    s_mov_b32 s15, 0x20000
    s_mov_b32 s16, s72
    s_and_b32 s17, s73, 0xffff
    s_mov_b32 s18, 0x1e0000
    s_mov_b32 s19, 0x20000
    s_mov_b32 s20, s74
    s_and_b32 s21, s75, 0xffff
    s_mov_b32 s22, 0x1e0000
    s_mov_b32 s23, 0x20000
    s_mov_b32 s24, s76
    s_and_b32 s25, s77, 0xffff
    s_mov_b32 s26, 0x280000
    s_mov_b32 s27, 0x20000
    v_lshrrev_b32 v208, 3, v1
    v_lshrrev_b32 v209, 1, v208
    v_xor_b32 v209, v209, v1
    v_and_b32 v209, 7, v209
    s_lshl_b32 s44, s37, 7
    s_lshl_b32 s45, s36, 5
    s_add_u32 s44, s44, s45
    v_add_u32 v208, s44, v208
    v_mul_u32_u24 v208, 1280, v208
    v_lshl_add_u32 v12, v209, 4, v208
    v_xor_b32 v209, 4, v209
    v_lshl_add_u32 v13, v209, 4, v208
    v_add_u32 v13, 10240, v13
    v_lshrrev_b32 v208, 1, v2
    v_xor_b32 v208, v208, v3
    v_lshlrev_b32 v208, 4, v208
    v_lshl_add_u32 v14, v2, 7, v208
    v_xor_b32 v15, 64, v14
    s_lshl_b32 s47, s36, 15
    v_add_u32 v14, s47, v14
    v_add_u32 v15, s47, v15
    s_add_u32 m0, s47, 0x0
    s_mov_b32 s62, 0
    buffer_load_dwordx4 v12, s[4:7], s62 offen lds
    s_add_u32 m0, s47, 0x400
    s_mov_b32 s62, 0
    buffer_load_dwordx4 v13, s[4:7], s62 offen lds
    s_add_u32 m0, s47, 0x800
    s_mov_b32 s62, 20480
    buffer_load_dwordx4 v12, s[4:7], s62 offen lds
    s_add_u32 m0, s47, 0xc00
    s_mov_b32 s62, 20480
    buffer_load_dwordx4 v13, s[4:7], s62 offen lds
    s_add_u32 m0, s47, 0x1000
    s_mov_b32 s62, 128
    buffer_load_dwordx4 v12, s[4:7], s62 offen lds
    s_add_u32 m0, s47, 0x1400
    s_mov_b32 s62, 128
    buffer_load_dwordx4 v13, s[4:7], s62 offen lds
    s_add_u32 m0, s47, 0x1800
    s_mov_b32 s62, 20608
    buffer_load_dwordx4 v12, s[4:7], s62 offen lds
    s_add_u32 m0, s47, 0x1c00
    s_mov_b32 s62, 20608
    buffer_load_dwordx4 v13, s[4:7], s62 offen lds
    s_add_u32 m0, s47, 0x2000
    s_mov_b32 s62, 256
    buffer_load_dwordx4 v12, s[4:7], s62 offen lds
    s_add_u32 m0, s47, 0x2400
    s_mov_b32 s62, 256
    buffer_load_dwordx4 v13, s[4:7], s62 offen lds
    s_add_u32 m0, s47, 0x2800
    s_mov_b32 s62, 20736
    buffer_load_dwordx4 v12, s[4:7], s62 offen lds
    s_add_u32 m0, s47, 0x2c00
    s_mov_b32 s62, 20736
    buffer_load_dwordx4 v13, s[4:7], s62 offen lds
    s_add_u32 m0, s47, 0x3000
    s_mov_b32 s62, 384
    buffer_load_dwordx4 v12, s[4:7], s62 offen lds
    s_add_u32 m0, s47, 0x3400
    s_mov_b32 s62, 384
    buffer_load_dwordx4 v13, s[4:7], s62 offen lds
    s_add_u32 m0, s47, 0x3800
    s_mov_b32 s62, 20864
    buffer_load_dwordx4 v12, s[4:7], s62 offen lds
    s_add_u32 m0, s47, 0x3c00
    s_mov_b32 s62, 20864
    buffer_load_dwordx4 v13, s[4:7], s62 offen lds
    s_add_u32 m0, s47, 0x4000
    s_mov_b32 s62, 512
    buffer_load_dwordx4 v12, s[4:7], s62 offen lds
    s_add_u32 m0, s47, 0x4400
    s_mov_b32 s62, 512
    buffer_load_dwordx4 v13, s[4:7], s62 offen lds
    s_add_u32 m0, s47, 0x4800
    s_mov_b32 s62, 20992
    buffer_load_dwordx4 v12, s[4:7], s62 offen lds
    s_add_u32 m0, s47, 0x4c00
    s_mov_b32 s62, 20992
    buffer_load_dwordx4 v13, s[4:7], s62 offen lds
    s_add_u32 m0, s47, 0x5000
    s_mov_b32 s62, 640
    buffer_load_dwordx4 v12, s[4:7], s62 offen lds
    s_add_u32 m0, s47, 0x5400
    s_mov_b32 s62, 640
    buffer_load_dwordx4 v13, s[4:7], s62 offen lds
    s_add_u32 m0, s47, 0x5800
    s_mov_b32 s62, 21120
    buffer_load_dwordx4 v12, s[4:7], s62 offen lds
    s_add_u32 m0, s47, 0x5c00
    s_mov_b32 s62, 21120
    buffer_load_dwordx4 v13, s[4:7], s62 offen lds
    s_add_u32 m0, s47, 0x6000
    s_mov_b32 s62, 768
    buffer_load_dwordx4 v12, s[4:7], s62 offen lds
    s_add_u32 m0, s47, 0x6400
    s_mov_b32 s62, 768
    buffer_load_dwordx4 v13, s[4:7], s62 offen lds
    s_add_u32 m0, s47, 0x6800
    s_mov_b32 s62, 21248
    buffer_load_dwordx4 v12, s[4:7], s62 offen lds
    s_add_u32 m0, s47, 0x6c00
    s_mov_b32 s62, 21248
    buffer_load_dwordx4 v13, s[4:7], s62 offen lds
    s_add_u32 m0, s47, 0x7000
    s_mov_b32 s62, 896
    buffer_load_dwordx4 v12, s[4:7], s62 offen lds
    s_add_u32 m0, s47, 0x7400
    s_mov_b32 s62, 896
    buffer_load_dwordx4 v13, s[4:7], s62 offen lds
    s_add_u32 m0, s47, 0x7800
    s_mov_b32 s62, 21376
    buffer_load_dwordx4 v12, s[4:7], s62 offen lds
    s_add_u32 m0, s47, 0x7c00
    s_mov_b32 s62, 21376
    buffer_load_dwordx4 v13, s[4:7], s62 offen lds
    v_mov_b32 v18, 0
    buffer_load_dwordx2 v[16:17], v18, s[32:35], 0 offen sc1
    v_mov_b32 v20, 0x3f803f80
    v_mov_b32 v21, 0x3f803f80
    v_mov_b32 v22, 0x3f803f80
    v_mov_b32 v23, 0x3f803f80
    v_mov_b32 v32, 0
    v_mov_b32 v33, 0
    v_mov_b32 v34, 0
    v_mov_b32 v35, 0
    v_mov_b32 v36, 0
    v_mov_b32 v37, 0
    v_mov_b32 v38, 0
    v_mov_b32 v39, 0
    v_mov_b32 v40, 0
    v_mov_b32 v41, 0
    v_mov_b32 v42, 0
    v_mov_b32 v43, 0
    v_mov_b32 v44, 0
    v_mov_b32 v45, 0
    v_mov_b32 v46, 0
    v_mov_b32 v47, 0
    s_waitcnt vmcnt(29)
    ds_read_b128 a[0:3], v14 offset:0
    ds_read_b128 a[4:7], v14 offset:2048
    s_waitcnt lgkmcnt(0)
    v_mfma_f32_16x16x32_bf16 v[32:35], a[0:3], a[0:3], v[32:35]
    v_mfma_f32_16x16x32_bf16 v[40:43], v[20:23], a[0:3], v[40:43]
    v_mfma_f32_16x16x32_bf16 v[36:39], a[4:7], a[4:7], v[36:39]
    v_mfma_f32_16x16x32_bf16 v[44:47], v[20:23], a[4:7], v[44:47]
    ds_read_b128 a[8:11], v15 offset:0
    ds_read_b128 a[12:15], v15 offset:2048
    s_waitcnt lgkmcnt(0)
    s_add_u32 m0, s47, 0x0
    s_mov_b32 s62, 1024
    buffer_load_dwordx4 v12, s[4:7], s62 offen lds
    s_add_u32 m0, s47, 0x400
    s_mov_b32 s62, 1024
    buffer_load_dwordx4 v13, s[4:7], s62 offen lds
    s_add_u32 m0, s47, 0x800
    s_mov_b32 s62, 21504
    buffer_load_dwordx4 v12, s[4:7], s62 offen lds
    s_add_u32 m0, s47, 0xc00
    s_mov_b32 s62, 21504
    buffer_load_dwordx4 v13, s[4:7], s62 offen lds
    v_mfma_f32_16x16x32_bf16 v[32:35], a[8:11], a[8:11], v[32:35]
    v_mfma_f32_16x16x32_bf16 v[40:43], v[20:23], a[8:11], v[40:43]
    v_mfma_f32_16x16x32_bf16 v[36:39], a[12:15], a[12:15], v[36:39]
    v_mfma_f32_16x16x32_bf16 v[44:47], v[20:23], a[12:15], v[44:47]
    s_waitcnt vmcnt(29)
    ds_read_b128 a[0:3], v14 offset:4096
    ds_read_b128 a[4:7], v14 offset:6144
    s_waitcnt lgkmcnt(0)
    v_mfma_f32_16x16x32_bf16 v[32:35], a[0:3], a[0:3], v[32:35]
    v_mfma_f32_16x16x32_bf16 v[40:43], v[20:23], a[0:3], v[40:43]
    v_mfma_f32_16x16x32_bf16 v[36:39], a[4:7], a[4:7], v[36:39]
    v_mfma_f32_16x16x32_bf16 v[44:47], v[20:23], a[4:7], v[44:47]
    ds_read_b128 a[8:11], v15 offset:4096
    ds_read_b128 a[12:15], v15 offset:6144
    s_waitcnt lgkmcnt(0)
    s_add_u32 m0, s47, 0x1000
    s_mov_b32 s62, 1152
    buffer_load_dwordx4 v12, s[4:7], s62 offen lds
    s_add_u32 m0, s47, 0x1400
    s_mov_b32 s62, 1152
    buffer_load_dwordx4 v13, s[4:7], s62 offen lds
    s_add_u32 m0, s47, 0x1800
    s_mov_b32 s62, 21632
    buffer_load_dwordx4 v12, s[4:7], s62 offen lds
    s_add_u32 m0, s47, 0x1c00
    s_mov_b32 s62, 21632
    buffer_load_dwordx4 v13, s[4:7], s62 offen lds
    v_mfma_f32_16x16x32_bf16 v[32:35], a[8:11], a[8:11], v[32:35]
    v_mfma_f32_16x16x32_bf16 v[40:43], v[20:23], a[8:11], v[40:43]
    v_mfma_f32_16x16x32_bf16 v[36:39], a[12:15], a[12:15], v[36:39]
    v_mfma_f32_16x16x32_bf16 v[44:47], v[20:23], a[12:15], v[44:47]
    s_waitcnt vmcnt(29)
    ds_read_b128 a[0:3], v14 offset:8192
    ds_read_b128 a[4:7], v14 offset:10240
    s_waitcnt lgkmcnt(0)
    v_mfma_f32_16x16x32_bf16 v[32:35], a[0:3], a[0:3], v[32:35]
    v_mfma_f32_16x16x32_bf16 v[40:43], v[20:23], a[0:3], v[40:43]
    v_mfma_f32_16x16x32_bf16 v[36:39], a[4:7], a[4:7], v[36:39]
    v_mfma_f32_16x16x32_bf16 v[44:47], v[20:23], a[4:7], v[44:47]
    ds_read_b128 a[8:11], v15 offset:8192
    ds_read_b128 a[12:15], v15 offset:10240
    s_waitcnt lgkmcnt(0)
    v_mfma_f32_16x16x32_bf16 v[32:35], a[8:11], a[8:11], v[32:35]
    v_mfma_f32_16x16x32_bf16 v[40:43], v[20:23], a[8:11], v[40:43]
    v_mfma_f32_16x16x32_bf16 v[36:39], a[12:15], a[12:15], v[36:39]
    v_mfma_f32_16x16x32_bf16 v[44:47], v[20:23], a[12:15], v[44:47]
    s_waitcnt vmcnt(25)
    ds_read_b128 a[0:3], v14 offset:12288
    ds_read_b128 a[4:7], v14 offset:14336
    s_waitcnt lgkmcnt(0)
    v_mfma_f32_16x16x32_bf16 v[32:35], a[0:3], a[0:3], v[32:35]
    v_mfma_f32_16x16x32_bf16 v[40:43], v[20:23], a[0:3], v[40:43]
    v_mfma_f32_16x16x32_bf16 v[36:39], a[4:7], a[4:7], v[36:39]
    v_mfma_f32_16x16x32_bf16 v[44:47], v[20:23], a[4:7], v[44:47]
    ds_read_b128 a[8:11], v15 offset:12288
    ds_read_b128 a[12:15], v15 offset:14336
    s_waitcnt lgkmcnt(0)
    v_mfma_f32_16x16x32_bf16 v[32:35], a[8:11], a[8:11], v[32:35]
    v_mfma_f32_16x16x32_bf16 v[40:43], v[20:23], a[8:11], v[40:43]
    v_mfma_f32_16x16x32_bf16 v[36:39], a[12:15], a[12:15], v[36:39]
    v_mfma_f32_16x16x32_bf16 v[44:47], v[20:23], a[12:15], v[44:47]
    s_waitcnt vmcnt(21)
    ds_read_b128 a[0:3], v14 offset:16384
    ds_read_b128 a[4:7], v14 offset:18432
    s_waitcnt lgkmcnt(0)
    v_mfma_f32_16x16x32_bf16 v[32:35], a[0:3], a[0:3], v[32:35]
    v_mfma_f32_16x16x32_bf16 v[40:43], v[20:23], a[0:3], v[40:43]
    v_mfma_f32_16x16x32_bf16 v[36:39], a[4:7], a[4:7], v[36:39]
    v_mfma_f32_16x16x32_bf16 v[44:47], v[20:23], a[4:7], v[44:47]
    ds_read_b128 a[8:11], v15 offset:16384
    ds_read_b128 a[12:15], v15 offset:18432
    s_waitcnt lgkmcnt(0)
    v_mfma_f32_16x16x32_bf16 v[32:35], a[8:11], a[8:11], v[32:35]
    v_mfma_f32_16x16x32_bf16 v[40:43], v[20:23], a[8:11], v[40:43]
    v_mfma_f32_16x16x32_bf16 v[36:39], a[12:15], a[12:15], v[36:39]
    v_mfma_f32_16x16x32_bf16 v[44:47], v[20:23], a[12:15], v[44:47]
    s_waitcnt vmcnt(17)
    ds_read_b128 a[0:3], v14 offset:20480
    ds_read_b128 a[4:7], v14 offset:22528
    s_waitcnt lgkmcnt(0)
    v_mfma_f32_16x16x32_bf16 v[32:35], a[0:3], a[0:3], v[32:35]
    v_mfma_f32_16x16x32_bf16 v[40:43], v[20:23], a[0:3], v[40:43]
    v_mfma_f32_16x16x32_bf16 v[36:39], a[4:7], a[4:7], v[36:39]
    v_mfma_f32_16x16x32_bf16 v[44:47], v[20:23], a[4:7], v[44:47]
    ds_read_b128 a[8:11], v15 offset:20480
    ds_read_b128 a[12:15], v15 offset:22528
    s_waitcnt lgkmcnt(0)
    v_mfma_f32_16x16x32_bf16 v[32:35], a[8:11], a[8:11], v[32:35]
    v_mfma_f32_16x16x32_bf16 v[40:43], v[20:23], a[8:11], v[40:43]
    v_mfma_f32_16x16x32_bf16 v[36:39], a[12:15], a[12:15], v[36:39]
    v_mfma_f32_16x16x32_bf16 v[44:47], v[20:23], a[12:15], v[44:47]
    s_waitcnt vmcnt(13)
    ds_read_b128 a[0:3], v14 offset:24576
    ds_read_b128 a[4:7], v14 offset:26624
    s_waitcnt lgkmcnt(0)
    v_mfma_f32_16x16x32_bf16 v[32:35], a[0:3], a[0:3], v[32:35]
    v_mfma_f32_16x16x32_bf16 v[40:43], v[20:23], a[0:3], v[40:43]
    v_mfma_f32_16x16x32_bf16 v[36:39], a[4:7], a[4:7], v[36:39]
    v_mfma_f32_16x16x32_bf16 v[44:47], v[20:23], a[4:7], v[44:47]
    ds_read_b128 a[8:11], v15 offset:24576
    ds_read_b128 a[12:15], v15 offset:26624
    s_waitcnt lgkmcnt(0)
    v_mfma_f32_16x16x32_bf16 v[32:35], a[8:11], a[8:11], v[32:35]
    v_mfma_f32_16x16x32_bf16 v[40:43], v[20:23], a[8:11], v[40:43]
    v_mfma_f32_16x16x32_bf16 v[36:39], a[12:15], a[12:15], v[36:39]
    v_mfma_f32_16x16x32_bf16 v[44:47], v[20:23], a[12:15], v[44:47]
    s_waitcnt vmcnt(9)
    ds_read_b128 a[0:3], v14 offset:28672
    ds_read_b128 a[4:7], v14 offset:30720
    s_waitcnt lgkmcnt(0)
    v_mfma_f32_16x16x32_bf16 v[32:35], a[0:3], a[0:3], v[32:35]
    v_mfma_f32_16x16x32_bf16 v[40:43], v[20:23], a[0:3], v[40:43]
    v_mfma_f32_16x16x32_bf16 v[36:39], a[4:7], a[4:7], v[36:39]
    v_mfma_f32_16x16x32_bf16 v[44:47], v[20:23], a[4:7], v[44:47]
    ds_read_b128 a[8:11], v15 offset:28672
    ds_read_b128 a[12:15], v15 offset:30720
    s_waitcnt lgkmcnt(0)
    v_mfma_f32_16x16x32_bf16 v[32:35], a[8:11], a[8:11], v[32:35]
    v_mfma_f32_16x16x32_bf16 v[40:43], v[20:23], a[8:11], v[40:43]
    v_mfma_f32_16x16x32_bf16 v[36:39], a[12:15], a[12:15], v[36:39]
    v_mfma_f32_16x16x32_bf16 v[44:47], v[20:23], a[12:15], v[44:47]
    s_waitcnt vmcnt(4)
    ds_read_b128 a[0:3], v14 offset:0
    ds_read_b128 a[4:7], v14 offset:2048
    s_waitcnt lgkmcnt(0)
    v_mfma_f32_16x16x32_bf16 v[32:35], a[0:3], a[0:3], v[32:35]
    v_mfma_f32_16x16x32_bf16 v[40:43], v[20:23], a[0:3], v[40:43]
    v_mfma_f32_16x16x32_bf16 v[36:39], a[4:7], a[4:7], v[36:39]
    v_mfma_f32_16x16x32_bf16 v[44:47], v[20:23], a[4:7], v[44:47]
    ds_read_b128 a[8:11], v15 offset:0
    ds_read_b128 a[12:15], v15 offset:2048
    s_waitcnt lgkmcnt(0)
    v_mfma_f32_16x16x32_bf16 v[32:35], a[8:11], a[8:11], v[32:35]
    v_mfma_f32_16x16x32_bf16 v[40:43], v[20:23], a[8:11], v[40:43]
    v_mfma_f32_16x16x32_bf16 v[36:39], a[12:15], a[12:15], v[36:39]
    v_mfma_f32_16x16x32_bf16 v[44:47], v[20:23], a[12:15], v[44:47]
    s_waitcnt vmcnt(0)
    ds_read_b128 a[0:3], v14 offset:4096
    ds_read_b128 a[4:7], v14 offset:6144
    s_waitcnt lgkmcnt(0)
    v_mfma_f32_16x16x32_bf16 v[32:35], a[0:3], a[0:3], v[32:35]
    v_mfma_f32_16x16x32_bf16 v[40:43], v[20:23], a[0:3], v[40:43]
    v_mfma_f32_16x16x32_bf16 v[36:39], a[4:7], a[4:7], v[36:39]
    v_mfma_f32_16x16x32_bf16 v[44:47], v[20:23], a[4:7], v[44:47]
    ds_read_b128 a[8:11], v15 offset:4096
    ds_read_b128 a[12:15], v15 offset:6144
    s_waitcnt lgkmcnt(0)
    v_mfma_f32_16x16x32_bf16 v[32:35], a[8:11], a[8:11], v[32:35]
    v_mfma_f32_16x16x32_bf16 v[40:43], v[20:23], a[8:11], v[40:43]
    v_mfma_f32_16x16x32_bf16 v[36:39], a[12:15], a[12:15], v[36:39]
    v_mfma_f32_16x16x32_bf16 v[44:47], v[20:23], a[12:15], v[44:47]
    s_waitcnt vmcnt(8)
    v_readfirstlane_b32 s42, v16
    v_readfirstlane_b32 s43, v17
    s_nop 0
    s_cmp_lg_u32 s42, 0
    s_cbranch_scc1 ND_9
    s_mov_b32 s44, 0
NL_8:
    buffer_load_dwordx2 v[16:17], v18, s[32:35], 0 offen sc1
    s_waitcnt vmcnt(0)
    v_readfirstlane_b32 s42, v16
    v_readfirstlane_b32 s43, v17
    s_add_u32 s44, s44, 1
    s_cmp_gt_u32 s44, 20000
    s_cbranch_scc1 ND_9
    s_cmp_eq_u32 s42, 0
    s_cbranch_scc1 NL_8
ND_9:
    v_and_b32 v208, 3, v2
    v_lshrrev_b32 v209, 2, v2
    v_cmp_eq_u32 s[46:47], v209, v3
    v_cmp_eq_u32 vcc, 1, v208
    s_nop 1
    v_cndmask_b32 v32, v32, v33, vcc
    v_cmp_eq_u32 vcc, 2, v208
    s_nop 1
    v_cndmask_b32 v32, v32, v34, vcc
    v_cmp_eq_u32 vcc, 3, v208
    s_nop 1
    v_cndmask_b32 v32, v32, v35, vcc
    v_cndmask_b32 v32, 0, v32, s[46:47]
    v_mov_b32 v210, v32
    s_nop 1
    v_permlane16_swap_b32 v32, v210
    v_add_f32 v32, v32, v210
    v_mov_b32 v210, v32
    s_nop 1
    v_permlane32_swap_b32 v32, v210
    v_add_f32 v32, v32, v210
    v_mul_f32 v40, 0x3acccccd, v40
    v_mul_f32 v32, 0x3acccccd, v32
    v_fma_f32 v32, -v40, v40, v32
    v_max_f32 v32, 0, v32
    v_add_f32 v32, 0x3727c5ac, v32
    v_rsq_f32 v32, v32
    v_mov_b32 v48, v40
    v_mov_b32 v49, v32
    v_mov_b32 v50, s42
    v_mov_b32 v51, s43
    v_cmp_eq_u32 vcc, 1, v208
    s_nop 1
    v_cndmask_b32 v36, v36, v37, vcc
    v_cmp_eq_u32 vcc, 2, v208
    s_nop 1
    v_cndmask_b32 v36, v36, v38, vcc
    v_cmp_eq_u32 vcc, 3, v208
    s_nop 1
    v_cndmask_b32 v36, v36, v39, vcc
    v_cndmask_b32 v36, 0, v36, s[46:47]
    v_mov_b32 v210, v36
    s_nop 1
    v_permlane16_swap_b32 v36, v210
    v_add_f32 v36, v36, v210
    v_mov_b32 v210, v36
    s_nop 1
    v_permlane32_swap_b32 v36, v210
    v_add_f32 v36, v36, v210
    v_mul_f32 v44, 0x3acccccd, v44
    v_mul_f32 v36, 0x3acccccd, v36
    v_fma_f32 v36, -v44, v44, v36
    v_max_f32 v36, 0, v36
    v_add_f32 v36, 0x3727c5ac, v36
    v_rsq_f32 v36, v36
    v_mov_b32 v52, v44
    v_mov_b32 v53, v36
    v_mov_b32 v54, s42
    v_mov_b32 v55, s43
    s_lshl_b32 s44, s37, 7
    s_lshl_b32 s45, s36, 5
    s_add_u32 s44, s44, s45
    v_add_u32 v208, s44, v2
    v_lshlrev_b32 v208, 4, v208
    v_add_u32 v208, 0x20000, v208
    s_mov_b64 exec, 0xffff
    buffer_store_dwordx4 v[48:51], v208, s[28:31], 0 offen offset:0 sc1
    buffer_store_dwordx4 v[52:55], v208, s[28:31], 0 offen offset:256 sc1
    s_mov_b64 exec, -1
    s_waitcnt vmcnt(0)
P1J_2:
    s_barrier
    s_lshl_b32 s89, s37, 4
    s_add_u32 s89, s89, s38
    v_lshlrev_b32 v4, 4, v1
    s_lshl_b32 s93, s36, 10
    s_sub_u32 s94, s93, 1024
    s_lshr_b32 s87, s40, 1
    s_mul_i32 s90, s87, 102400
    s_add_u32 s90, s90, 0x1500000
    s_add_u32 s90, s90, s93
    s_mul_i32 s91, s40, 122880
    s_add_u32 s91, s91, 0x1600000
    s_add_u32 s91, s91, s93
    s_mul_i32 s92, s87, 245760
    s_add_u32 s92, s92, 0x1800000
    s_add_u32 s92, s92, s93
    s_lshl_b32 s86, s39, 3
    s_and_b32 s52, s40, 1
    s_lshl_b32 s52, s52, 2
    s_add_u32 s86, s86, s52
    s_add_u32 s86, s86, s36
    s_lshl_b32 s52, s39, 7
    s_sub_i32 s52, 256, s52
    v_mov_b32 v204, 0xf149
    v_mov_b32 v209, 0
    v_mov_b32 v210, 0x3f80
    v_mov_b32 v211, 0
    v_cmp_gt_i32 vcc, s52, v0
    s_nop 1
    v_cndmask_b32 v208, 0, v204, vcc
    v_lshlrev_b32 v201, 4, v0
    v_add_u32 v201, 62080, v201
    ds_write_b128 v201, v[208:211]
    v_add_u32 v202, 256, v0
    v_cmp_gt_i32 vcc, s52, v202
    s_nop 1
    v_cndmask_b32 v212, 0, v204, vcc
    v_mov_b32 v213, 0
    v_mov_b32 v214, 0x3f80
    v_mov_b32 v215, 0
    v_cmp_gt_u32 vcc, 160, v0
    s_nop 1
    s_and_saveexec_b64 s[54:55], vcc
    ds_write_b128 v201, v[212:215] offset:4096
    s_mov_b64 exec, s[54:55]
    s_mul_i32 s55, s40, 5
    s_lshl_b32 s56, s39, 7
    s_sub_i32 s56, s56, 256
    s_cmp_ge_u32 s36, 2
    s_cselect_b32 s57, -2, 4
    s_cselect_b32 s70, 26624, 0
    s_cselect_b32 s71, 128, 0
    s_add_i32 s57, s57, s36
    s_add_i32 s58, s36, 0
    s_lshl_b32 s58, s58, 6
    s_add_i32 s58, s58, s56
    s_cmp_lt_i32 s58, 0
    s_cselect_b32 s64, 0x7f000000, 0
    s_add_i32 s58, s57, 0
    s_lshl_b32 s58, s58, 6
    s_add_i32 s58, s58, s56
    s_cmp_lt_i32 s58, 0
    s_cselect_b32 s65, 0x7f000000, 0
    s_add_i32 s58, s36, 2
    s_lshl_b32 s58, s58, 6
    s_add_i32 s58, s58, s56
    s_cmp_lt_i32 s58, 0
    s_cselect_b32 s66, 0x7f000000, 0
    s_add_u32 s65, s65, s70
    s_lshl_b32 s56, s56, 4
    s_add_u32 s56, s56, s93
    s_add_u32 s58, s55, 80
    s_lshl_b32 s58, s58, 15
    s_add_u32 s58, s58, 0x100000
    s_add_u32 s68, s58, s56
    s_add_u32 s69, s68, 0x280000
    s_lshr_b32 s58, s36, 1
    s_add_u32 s58, s58, s55
    s_lshl_b32 s58, s58, 15
    s_lshl_b32 s59, s39, 11
    s_add_u32 s58, s58, s59
    s_and_b32 s59, s36, 1
    s_lshl_b32 s59, s59, 10
    s_add_u32 s58, s58, s59
    s_add_u32 s72, s58, 0x100000
    s_mul_i32 s95, s36, 2560
    s_add_u32 s95, s95, 153600
    v_mul_u32_u24 v200, 80, v2
    v_add_u32 v200, s95, v200
    v_lshl_add_u32 v236, v3, 4, v200
    v_mul_u32_u24 v202, 1280, v3
    v_add_u32 v202, v202, v200
    v_min_u32 v237, 163760, v202
    s_lshl_b32 s58, s39, 3
    s_lshl_b32 s59, s36, 1
    s_add_u32 s58, s58, s59
    s_mul_i32 s58, s58, 20480
    s_add_u32 s78, s58, 0x900000
    s_add_u32 s79, s78, 20480
    v_add_u32 v200, s55, v3
    v_lshrrev_b32 v201, 2, v200
    v_lshlrev_b32 v201, 10, v201
    v_and_b32 v200, 3, v200
    v_lshl_add_u32 v201, v200, 8, v201
    v_lshl_add_u32 v238, v2, 4, v201
    s_add_u32 s59, s55, 4
    s_lshr_b32 s60, s59, 2
    s_lshl_b32 s60, s60, 10
    s_and_b32 s59, s59, 3
    s_lshl_b32 s59, s59, 8
    s_add_u32 s60, s60, s59
    v_mul_u32_u24 v203, 20480, v3
    v_lshl_add_u32 v203, v2, 4, v203
    v_add_u32 v239, s60, v203
    v_lshrrev_b32 v200, 3, v1
    v_and_b32 v200, 3, v200
    v_min_u32 v200, 2, v200
    v_lshrrev_b32 v201, 1, v1
    v_and_b32 v201, 3, v201
    v_min_u32 v201, 2, v201
    v_and_b32 v202, 1, v1
    v_lshlrev_b32 v202, 2, v202
    v_mul_u32_u24 v200, 80, v200
    v_add3_u32 v200, v200, v202, s55
    v_lshrrev_b32 v200, 4, v200
    s_sub_i32 s58, s39, 2
    v_add_u32 v201, s58, v201
    v_max_i32 v201, 0, v201
    v_lshl_add_u32 v200, v201, 4, v200
    v_lshlrev_b32 v219, 6, v200
    s_lshl_b32 s57, s36, 5
    v_add_u32 v200, s57, v2
    v_lshlrev_b32 v200, 4, v200
    v_cmp_eq_u32 s[58:59], 3, v3
    v_cmp_eq_u32 s[60:61], 2, v3
    v_mul_u32_u24 v201, 6144, v3
    v_mov_b32 v202, 62080
    v_cndmask_b32 v5, v201, v202, s[58:59]
    v_add_u32 v203, 18432, v201
    v_mov_b32 v204, 12288
    v_cndmask_b32 v203, v203, v204, s[60:61]
    v_cndmask_b32 v6, v203, v202, s[58:59]
    v_add_u32 v5, v5, v200
    v_add_u32 v6, v6, v200
    v_lshlrev_b32 v201, 11, v3
    v_cndmask_b32 v52, v201, 0, s[58:59]
    v_add_u32 v203, 6144, v201
    v_mov_b32 v204, 4096
    v_cndmask_b32 v203, v203, v204, s[60:61]
    v_cndmask_b32 v53, v203, 0, s[58:59]
    v_add_u32 v203, 69632, v200
    v_add_u32 v52, v52, v203
    v_add_u32 v53, v53, v203
    v_lshrrev_b32 v200, 2, v2
    v_lshl_add_u32 v200, v3, 2, v200
    v_add_u32 v200, s57, v200
    v_lshlrev_b32 v200, 4, v200
    v_and_b32 v201, 3, v1
    v_add_u32 v202, 0, v201
    v_lshrrev_b32 v203, 1, v202
    v_mul_u32_u24 v203, 6272, v203
    v_and_b32 v202, 1, v202
    v_lshl_add_u32 v203, v202, 3, v203
    v_add_u32 v8, v203, v200
    v_add_u32 v8, 30720, v8
    v_and_b32 v202, 1, v201
    v_cmp_eq_u32 vcc, 1, v202
    v_mov_b32 v203, 43264
    v_mov_b32 v204, 62088
    v_cndmask_b32 v203, v203, v204, vcc
    v_add_u32 v9, v203, v200
    v_add_u32 v202, 5, v201
    v_lshrrev_b32 v203, 1, v202
    v_mul_u32_u24 v203, 6272, v203
    v_and_b32 v202, 1, v202
    v_lshl_add_u32 v203, v202, 3, v203
    v_add_u32 v10, v203, v200
    v_add_u32 v10, 30720, v10
    v_and_b32 v202, 1, v201
    v_cmp_eq_u32 vcc, 1, v202
    v_mov_b32 v203, 55816
    v_mov_b32 v204, 62088
    v_cndmask_b32 v203, v203, v204, vcc
    v_add_u32 v11, v203, v200
    v_lshlrev_b32 v200, 2, v3
    v_mov_b32 v201, 0xf149f2ca
    v_add_u32 v202, 0, v200
    v_cmp_gt_u32 vcc, v202, v2
    s_nop 1
    v_cndmask_b32 v12, v201, 0, vcc
    v_cndmask_b32 v16, 0, v201, vcc
    v_add_u32 v202, 1, v200
    v_cmp_gt_u32 vcc, v202, v2
    s_nop 1
    v_cndmask_b32 v13, v201, 0, vcc
    v_cndmask_b32 v17, 0, v201, vcc
    v_add_u32 v202, 2, v200
    v_cmp_gt_u32 vcc, v202, v2
    s_nop 1
    v_cndmask_b32 v14, v201, 0, vcc
    v_cndmask_b32 v18, 0, v201, vcc
    v_add_u32 v202, 3, v200
    v_cmp_gt_u32 vcc, v202, v2
    s_nop 1
    v_cndmask_b32 v15, v201, 0, vcc
    v_cndmask_b32 v19, 0, v201, vcc
    v_mul_u32_u24 v54, 80, v2
    v_lshl_add_u32 v54, v3, 3, v54
    v_add_u32 v54, s95, v54
    s_waitcnt vmcnt(0) lgkmcnt(0)
    s_barrier
    s_cmp_lg_u32 s36, 0
    s_cbranch_scc1 FS_10
    s_lshl_b32 s44, s89, 6
    s_add_u32 s44, s44, 0x0
    v_mov_b32 v220, s42
    v_mov_b32 v221, s43
    v_mov_b32 v222, s98
    v_mov_b32 v223, 0
    v_mov_b32 v224, s44
    s_mov_b64 exec, 1
    buffer_store_dwordx4 v[220:223], v224, s[28:31], 0 offen sc1
    s_mov_b64 exec, -1
FS_10:
    s_cmp_lg_u32 s36, 0
    s_cbranch_scc1 WD_11
    s_mov_b32 s44, 0
PL_12:
    buffer_load_dwordx2 v[222:223], v219, s[28:31], 0 offen offset:0 sc1
    s_waitcnt vmcnt(0)
    v_cmp_eq_u32 s[46:47], s42, v222
    v_cmp_eq_u32 s[48:49], s43, v223
    s_nop 1
    s_and_b64 s[46:47], s[46:47], s[48:49]
    s_mov_b64 s[50:51], s[46:47]
    s_cmp_eq_u64 s[50:51], -1
    s_cbranch_scc1 PD_13
    s_add_u32 s44, s44, 1
    s_cmp_gt_u32 s44, 20000
    s_cbranch_scc0 PL_12
    s_mov_b32 s63, 1
PD_13:
WD_11:
    s_barrier
    s_add_u32 m0, s93, 0
    s_add_u32 s62, s68, s64
    buffer_load_dwordx4 v4, s[28:31], s62 offen sc1 lds
    s_add_u32 m0, s93, 4096
    s_add_u32 s62, s68, s65
    s_add_u32 s62, s62, 4096
    buffer_load_dwordx4 v4, s[28:31], s62 offen sc1 lds
    s_add_u32 m0, s93, 8192
    s_add_u32 s62, s68, s66
    s_add_u32 s62, s62, 34816
    buffer_load_dwordx4 v4, s[28:31], s62 offen sc1 lds
    s_add_u32 m0, s93, 69632
    s_add_u32 s62, s72, 0
    buffer_load_dwordx4 v4, s[28:31], s62 offen sc1 lds
    s_add_u32 m0, s93, 12288
    s_add_u32 s62, s68, s64
    s_add_u32 s62, s62, 65536
    buffer_load_dwordx4 v4, s[28:31], s62 offen sc1 lds
    s_add_u32 m0, s93, 16384
    s_add_u32 s62, s68, s65
    s_add_u32 s62, s62, 69632
    buffer_load_dwordx4 v4, s[28:31], s62 offen sc1 lds
    s_add_u32 m0, s93, 20480
    s_add_u32 s62, s68, s66
    s_add_u32 s62, s62, 100352
    buffer_load_dwordx4 v4, s[28:31], s62 offen sc1 lds
    s_add_u32 m0, s93, 73728
    s_add_u32 s62, s72, 65536
    buffer_load_dwordx4 v4, s[28:31], s62 offen sc1 lds
    s_add_u32 m0, s93, 77824
    s_cmp_ge_u32 s36, 2
    s_cselect_b32 s58, 0x7f000000, 0
    s_add_u32 s62, s72, s58
    s_add_u32 s62, s62, 131072
    buffer_load_dwordx4 v4, s[28:31], s62 offen sc1 lds
    s_add_u32 m0, s93, 30720
    s_add_u32 s62, s69, s64
    buffer_load_dwordx4 v4, s[28:31], s62 offen sc1 lds
    s_add_u32 m0, s93, 34816
    s_add_u32 m0, m0, s71
    s_add_u32 s62, s69, s65
    s_add_u32 s62, s62, 4096
    buffer_load_dwordx4 v4, s[28:31], s62 offen sc1 lds
    s_add_u32 m0, s93, 39040
    s_add_u32 s62, s69, s66
    s_add_u32 s62, s62, 34816
    buffer_load_dwordx4 v4, s[28:31], s62 offen sc1 lds
    s_add_u32 m0, s93, 43264
    s_add_u32 s62, s69, s64
    s_add_u32 s62, s62, 65536
    buffer_load_dwordx4 v4, s[28:31], s62 offen sc1 lds
    s_add_u32 m0, s93, 47360
    s_add_u32 m0, m0, s71
    s_add_u32 s62, s69, s65
    s_add_u32 s62, s62, 69632
    buffer_load_dwordx4 v4, s[28:31], s62 offen sc1 lds
    s_add_u32 m0, s93, 51584
    s_add_u32 s62, s69, s66
    s_add_u32 s62, s62, 100352
    buffer_load_dwordx4 v4, s[28:31], s62 offen sc1 lds
    s_add_u32 m0, s93, 24576
    s_add_u32 s62, s68, s64
    s_add_u32 s62, s62, 131072
    buffer_load_dwordx4 v4, s[28:31], s62 offen sc1 lds
    s_cmp_ge_u32 s36, 2
    s_mov_b32 s58, 28672
    s_cselect_b32 s58, 77824, s58
    s_add_u32 m0, s93, s58
    s_cmp_ge_u32 s36, 2
    s_cselect_b32 s58, 0x7f000000, s65
    s_add_u32 s62, s68, s58
    s_add_u32 s62, s62, 135168
    buffer_load_dwordx4 v4, s[28:31], s62 offen sc1 lds
    s_add_u32 m0, s93, 55808
    s_add_u32 s62, s69, s64
    s_add_u32 s62, s62, 131072
    buffer_load_dwordx4 v4, s[28:31], s62 offen sc1 lds
    s_cmp_ge_u32 s36, 2
    s_mov_b32 s58, 59904
    s_cselect_b32 s58, 77824, s58
    s_add_u32 m0, s93, s58
    s_cmp_ge_u32 s36, 2
    s_cselect_b32 s58, 0x7f000000, s65
    s_add_u32 s62, s69, s58
    s_add_u32 s62, s62, 135168
    buffer_load_dwordx4 v4, s[28:31], s62 offen sc1 lds
    v_lshlrev_b32 v220, 8, v1
    s_lshr_b32 s58, s39, 1
    s_lshr_b32 s59, s58, 1
    s_lshl_b32 s59, s59, 6
    s_and_b32 s58, s58, 1
    s_lshl_b32 s58, s58, 3
    s_add_u32 s59, s59, s58
    s_and_b32 s58, s39, 1
    s_lshl_b32 s58, s58, 5
    s_add_u32 s59, s59, s58
    v_lshrrev_b32 v218, 3, v2
    v_lshlrev_b32 v218, 4, v218
    v_and_b32 v230, 7, v2
    v_add3_u32 v218, v218, v230, s59
    v_lshlrev_b32 v218, 6, v218
    s_cmp_lg_u32 s36, 0
    s_cbranch_scc1 FP_14
    buffer_load_dwordx2 v[222:223], v220, s[28:31], 0 offen offset:0 sc1
    buffer_load_dwordx2 v[224:225], v220, s[28:31], 0 offen offset:64 sc1
    buffer_load_dwordx2 v[226:227], v220, s[28:31], 0 offen offset:128 sc1
    buffer_load_dwordx2 v[228:229], v220, s[28:31], 0 offen offset:192 sc1
    buffer_load_dwordx4 v[232:235], v218, s[28:31], 0 offen sc1
    s_waitcnt vmcnt(15)
    s_branch FP_14_j
FP_14:
    s_waitcnt vmcnt(10)
FP_14_j:
    s_waitcnt lgkmcnt(0)
    s_barrier
    ds_read_b128 v[20:23], v52 offset:0
    ds_read_b128 v[24:27], v52 offset:256
    ds_read_b128 v[28:31], v53 offset:0
    ds_read_b128 v[32:35], v53 offset:256
    ds_read_b128 a[0:3], v5 offset:0
    ds_read_b128 a[4:7], v5 offset:256
    ds_read_b128 a[8:11], v5 offset:512
    ds_read_b128 a[12:15], v5 offset:768
    ds_read_b128 a[16:19], v5 offset:1024
    ds_read_b128 a[20:23], v5 offset:1280
    ds_read_b128 a[24:27], v5 offset:1536
    ds_read_b128 a[28:31], v5 offset:1792
    ds_read_b128 a[32:35], v5 offset:2048
    ds_read_b128 a[36:39], v5 offset:2304
    ds_read_b128 a[40:43], v5 offset:2560
    v_cmp_eq_u32 s[58:59], 3, v3
    v_cmp_eq_u32 s[60:61], 2, v3
    s_waitcnt lgkmcnt(11)
    v_mov_b32 v201, 0x3f80
    v_cndmask_b32 v22, v22, 0, s[60:61]
    v_cndmask_b32 v23, v23, 0, s[60:61]
    v_cndmask_b32 v20, v20, v201, s[58:59]
    v_cndmask_b32 v21, v21, 0, s[58:59]
    v_cndmask_b32 v22, v22, 0, s[58:59]
    v_cndmask_b32 v23, v23, 0, s[58:59]
    v_cndmask_b32 v26, v26, 0, s[60:61]
    v_cndmask_b32 v27, v27, 0, s[60:61]
    v_cndmask_b32 v24, v24, v201, s[58:59]
    v_cndmask_b32 v25, v25, 0, s[58:59]
    v_cndmask_b32 v26, v26, 0, s[58:59]
    v_cndmask_b32 v27, v27, 0, s[58:59]
    v_cndmask_b32 v28, v28, 0, s[60:61]
    v_cndmask_b32 v29, v29, 0, s[60:61]
    v_cndmask_b32 v28, v28, v201, s[58:59]
    v_cndmask_b32 v29, v29, 0, s[58:59]
    v_cndmask_b32 v30, v30, 0, s[58:59]
    v_cndmask_b32 v31, v31, 0, s[58:59]
    v_cndmask_b32 v32, v32, 0, s[60:61]
    v_cndmask_b32 v33, v33, 0, s[60:61]
    v_cndmask_b32 v32, v32, v201, s[58:59]
    v_cndmask_b32 v33, v33, 0, s[58:59]
    v_cndmask_b32 v34, v34, 0, s[58:59]
    v_cndmask_b32 v35, v35, 0, s[58:59]
    s_waitcnt lgkmcnt(8)
    ds_read_b128 a[44:47], v5 offset:2816
    ds_read_b128 a[48:51], v5 offset:3072
    ds_read_b128 a[52:55], v5 offset:3328
    ds_read_b128 a[56:59], v5 offset:3584
    ds_read_b128 a[60:63], v5 offset:3840
    ds_read_b128 a[64:67], v5 offset:4096
    ds_read_b128 a[68:71], v5 offset:4352
    v_lshlrev_b32 v198, 7, v1
    s_and_b32 s73, s39, 1
    s_lshl_b32 s74, s73, 1
    s_and_b32 s58, s40, 1
    s_add_u32 s74, s74, s58
    s_mul_i32 s75, s73, 36864
    s_add_u32 s75, s75, s91
    s_and_b32 s76, s36, 1
    s_lshl_b32 s76, s76, 10
    s_add_u32 s76, s76, 151552
    s_waitcnt lgkmcnt(0)
    v_mfma_f32_16x16x32_bf16 v[56:59], a[0:3], v[20:23], v[12:15]
    v_mfma_f32_16x16x32_bf16 v[60:63], a[4:7], v[20:23], 0
    v_mfma_f32_16x16x32_bf16 v[64:67], a[8:11], v[20:23], 0
    v_mfma_f32_16x16x32_bf16 v[68:71], a[12:15], v[20:23], 0
    v_mfma_f32_16x16x32_bf16 v[72:75], a[16:19], v[20:23], 0
    v_mfma_f32_16x16x32_bf16 v[76:79], a[20:23], v[20:23], 0
    v_mfma_f32_16x16x32_bf16 v[80:83], a[24:27], v[20:23], 0
    v_mfma_f32_16x16x32_bf16 v[84:87], a[28:31], v[20:23], 0
    v_mfma_f32_16x16x32_bf16 v[88:91], a[32:35], v[20:23], 0
    v_mfma_f32_16x16x32_bf16 v[92:95], a[36:39], v[20:23], 0
    v_mfma_f32_16x16x32_bf16 v[96:99], a[40:43], v[20:23], 0
    v_mfma_f32_16x16x32_bf16 v[100:103], a[44:47], v[20:23], 0
    v_mfma_f32_16x16x32_bf16 v[104:107], a[48:51], v[20:23], 0
    v_mfma_f32_16x16x32_bf16 v[108:111], a[52:55], v[20:23], 0
    v_mfma_f32_16x16x32_bf16 v[112:115], a[56:59], v[20:23], 0
    v_mfma_f32_16x16x32_bf16 v[116:119], a[60:63], v[20:23], 0
    v_mfma_f32_16x16x32_bf16 v[120:123], a[64:67], v[20:23], v[16:19]
    v_mfma_f32_16x16x32_bf16 v[124:127], a[4:7], v[24:27], v[12:15]
    v_max3_f32 v208, v56, v57, v58
    v_max3_f32 v209, v59, v60, v61
    v_mfma_f32_16x16x32_bf16 v[128:131], a[8:11], v[24:27], 0
    v_max3_f32 v210, v62, v63, v64
    v_max3_f32 v211, v65, v66, v67
    v_mfma_f32_16x16x32_bf16 v[132:135], a[12:15], v[24:27], 0
    v_max3_f32 v208, v208, v68, v69
    v_max3_f32 v209, v209, v70, v71
    v_mfma_f32_16x16x32_bf16 v[136:139], a[16:19], v[24:27], 0
    v_max3_f32 v210, v210, v72, v73
    v_max3_f32 v211, v211, v74, v75
    v_mfma_f32_16x16x32_bf16 v[140:143], a[20:23], v[24:27], 0
    v_max3_f32 v208, v208, v76, v77
    v_max3_f32 v209, v209, v78, v79
    v_mfma_f32_16x16x32_bf16 v[144:147], a[24:27], v[24:27], 0
    v_max3_f32 v210, v210, v80, v81
    v_max3_f32 v211, v211, v82, v83
    v_mfma_f32_16x16x32_bf16 v[148:151], a[28:31], v[24:27], 0
    v_max3_f32 v208, v208, v84, v85
    v_max3_f32 v209, v209, v86, v87
    v_mfma_f32_16x16x32_bf16 v[152:155], a[32:35], v[24:27], 0
    v_max3_f32 v210, v210, v88, v89
    v_max3_f32 v211, v211, v90, v91
    v_mfma_f32_16x16x32_bf16 v[156:159], a[36:39], v[24:27], 0
    v_max3_f32 v208, v208, v92, v93
    v_max3_f32 v209, v209, v94, v95
    v_mfma_f32_16x16x32_bf16 v[160:163], a[40:43], v[24:27], 0
    v_max3_f32 v210, v210, v96, v97
    v_max3_f32 v211, v211, v98, v99
    v_mfma_f32_16x16x32_bf16 v[164:167], a[44:47], v[24:27], 0
    v_max3_f32 v208, v208, v100, v101
    v_max3_f32 v209, v209, v102, v103
    v_mfma_f32_16x16x32_bf16 v[168:171], a[48:51], v[24:27], 0
    v_max3_f32 v210, v210, v104, v105
    v_max3_f32 v211, v211, v106, v107
    v_mfma_f32_16x16x32_bf16 v[172:175], a[52:55], v[24:27], 0
    v_max3_f32 v208, v208, v108, v109
    v_max3_f32 v209, v209, v110, v111
    v_mfma_f32_16x16x32_bf16 v[176:179], a[56:59], v[24:27], 0
    v_max3_f32 v210, v210, v112, v113
    v_max3_f32 v211, v211, v114, v115
    v_mfma_f32_16x16x32_bf16 v[180:183], a[60:63], v[24:27], 0
    v_max3_f32 v208, v208, v116, v117
    v_max3_f32 v209, v209, v118, v119
    v_mfma_f32_16x16x32_bf16 v[184:187], a[64:67], v[24:27], 0
    v_max3_f32 v210, v210, v120, v121
    v_max3_f32 v211, v211, v122, v123
    v_mfma_f32_16x16x32_bf16 v[188:191], a[68:71], v[24:27], v[16:19]
    v_max3_f32 v208, v208, v209, v210
    v_max_f32 v208, v208, v211
    v_mov_b32 v209, v208
    s_nop 0
    s_nop 0
    v_permlane16_swap_b32 v208, v209
    v_max_f32 v208, v208, v209
    v_mov_b32 v209, v208
    s_nop 0
    s_nop 0
    v_permlane32_swap_b32 v208, v209
    v_max_f32 v212, v208, v209
    s_waitcnt vmcnt(0)
    s_cmp_lg_u32 s36, 0
    s_cbranch_scc1 S2_15
    s_mov_b64 s[50:51], -1
    v_cmp_eq_u32 s[46:47], s42, v222
    v_cmp_eq_u32 s[48:49], s43, v223
    s_nop 0
    s_and_b64 s[50:51], s[50:51], s[46:47]
    s_and_b64 s[50:51], s[50:51], s[48:49]
    v_cmp_eq_u32 s[46:47], s42, v224
    v_cmp_eq_u32 s[48:49], s43, v225
    s_nop 0
    s_and_b64 s[50:51], s[50:51], s[46:47]
    s_and_b64 s[50:51], s[50:51], s[48:49]
    v_cmp_eq_u32 s[46:47], s42, v226
    v_cmp_eq_u32 s[48:49], s43, v227
    s_nop 0
    s_and_b64 s[50:51], s[50:51], s[46:47]
    s_and_b64 s[50:51], s[50:51], s[48:49]
    v_cmp_eq_u32 s[46:47], s42, v228
    v_cmp_eq_u32 s[48:49], s43, v229
    s_nop 0
    s_and_b64 s[50:51], s[50:51], s[46:47]
    s_and_b64 s[50:51], s[50:51], s[48:49]
    s_cmp_eq_u64 s[50:51], -1
    s_cbranch_scc1 S2_15_ok
    s_mov_b32 s44, 0
PL_16:
    buffer_load_dwordx2 v[222:223], v220, s[28:31], 0 offen offset:0 sc1
    buffer_load_dwordx2 v[224:225], v220, s[28:31], 0 offen offset:64 sc1
    buffer_load_dwordx2 v[226:227], v220, s[28:31], 0 offen offset:128 sc1
    buffer_load_dwordx2 v[228:229], v220, s[28:31], 0 offen offset:192 sc1
    s_waitcnt vmcnt(0)
    v_cmp_eq_u32 s[46:47], s42, v222
    v_cmp_eq_u32 s[48:49], s43, v223
    s_nop 1
    s_and_b64 s[46:47], s[46:47], s[48:49]
    s_mov_b64 s[50:51], s[46:47]
    v_cmp_eq_u32 s[46:47], s42, v224
    v_cmp_eq_u32 s[48:49], s43, v225
    s_nop 1
    s_and_b64 s[46:47], s[46:47], s[48:49]
    s_and_b64 s[50:51], s[50:51], s[46:47]
    v_cmp_eq_u32 s[46:47], s42, v226
    v_cmp_eq_u32 s[48:49], s43, v227
    s_nop 1
    s_and_b64 s[46:47], s[46:47], s[48:49]
    s_and_b64 s[50:51], s[50:51], s[46:47]
    v_cmp_eq_u32 s[46:47], s42, v228
    v_cmp_eq_u32 s[48:49], s43, v229
    s_nop 1
    s_and_b64 s[46:47], s[46:47], s[48:49]
    s_and_b64 s[50:51], s[50:51], s[46:47]
    s_cmp_eq_u64 s[50:51], -1
    s_cbranch_scc1 PD_17
    s_add_u32 s44, s44, 1
    s_cmp_gt_u32 s44, 20000
    s_cbranch_scc0 PL_16
    s_mov_b32 s63, 1
PD_17:
    buffer_load_dwordx4 v[232:235], v218, s[28:31], 0 offen sc1
    s_waitcnt vmcnt(0)
S2_15_ok:
    v_cmp_eq_u32 s[46:47], s98, v234
    v_cmp_eq_u32 s[48:49], s42, v232
    s_nop 1
    s_and_b64 s[46:47], s[46:47], s[48:49]
    s_cmp_eq_u64 s[46:47], -1
    s_cselect_b32 s46, 1, 0
    s_cmp_eq_u32 s63, 0
    s_cselect_b32 s46, s46, 0
    v_mov_b32 v230, s46
    v_mov_b32 v231, 68720
    ds_write_b32 v231, v230
    s_waitcnt lgkmcnt(0)
S2_15:
    s_barrier
    v_mov_b32 v231, 68720
    ds_read_b32 v230, v231
    s_waitcnt lgkmcnt(0)
    v_readfirstlane_b32 s99, v230
    v_pk_add_f32 v[56:57], v[56:57], v[212:213] op_sel_hi:[1,0] neg_lo:[0,1] neg_hi:[0,1]
    v_pk_add_f32 v[58:59], v[58:59], v[212:213] op_sel_hi:[1,0] neg_lo:[0,1] neg_hi:[0,1]
    v_exp_f32 v56, v56
    v_exp_f32 v57, v57
    v_exp_f32 v58, v58
    v_exp_f32 v59, v59
    s_waitcnt lgkmcnt(11)
    ds_read_b64_tr_b16 a[144:145], v8 offset:0
    ds_read_b64_tr_b16 a[146:147], v8 offset:256
    ds_read_b64_tr_b16 a[148:149], v9 offset:0
    ds_read_b64_tr_b16 a[150:151], v9 offset:256
    v_pk_add_f32 v[60:61], v[60:61], v[212:213] op_sel_hi:[1,0] neg_lo:[0,1] neg_hi:[0,1]
    v_pk_add_f32 v[62:63], v[62:63], v[212:213] op_sel_hi:[1,0] neg_lo:[0,1] neg_hi:[0,1]
    v_cvt_pk_bf16_f32 v56, v56, v57
    v_cvt_pk_bf16_f32 v57, v58, v59
    s_mul_i32 s100, s36, 17408
    s_add_u32 s101, s100, s90
    s_sub_u32 s101, s101, s93
    s_add_u32 s101, s101, 0x0
    s_add_u32 s100, s100, 0x14000
    s_add_u32 m0, s100, 0x0
    s_add_u32 s62, s101, 0x0
    v_exp_f32 v60, v60
    v_exp_f32 v61, v61
    v_exp_f32 v62, v62
    v_exp_f32 v63, v63
    s_waitcnt lgkmcnt(11)
    ds_read_b64_tr_b16 a[152:153], v8 offset:512
    ds_read_b64_tr_b16 a[154:155], v8 offset:768
    ds_read_b64_tr_b16 a[156:157], v9 offset:512
    ds_read_b64_tr_b16 a[158:159], v9 offset:768
    v_pk_add_f32 v[64:65], v[64:65], v[212:213] op_sel_hi:[1,0] neg_lo:[0,1] neg_hi:[0,1]
    v_pk_add_f32 v[66:67], v[66:67], v[212:213] op_sel_hi:[1,0] neg_lo:[0,1] neg_hi:[0,1]
    v_cvt_pk_bf16_f32 v58, v60, v61
    v_cvt_pk_bf16_f32 v59, v62, v63
    buffer_load_dwordx4 v4, s[28:31], s62 offen offset:0 sc1 lds
    v_exp_f32 v64, v64
    v_exp_f32 v65, v65
    v_exp_f32 v66, v66
    v_exp_f32 v67, v67
    s_waitcnt lgkmcnt(11)
    ds_read_b64_tr_b16 a[160:161], v8 offset:1024
    ds_read_b64_tr_b16 a[162:163], v8 offset:1280
    ds_read_b64_tr_b16 a[164:165], v9 offset:1024
    ds_read_b64_tr_b16 a[166:167], v9 offset:1280
    v_pk_add_f32 v[68:69], v[68:69], v[212:213] op_sel_hi:[1,0] neg_lo:[0,1] neg_hi:[0,1]
    v_pk_add_f32 v[70:71], v[70:71], v[212:213] op_sel_hi:[1,0] neg_lo:[0,1] neg_hi:[0,1]
    v_cvt_pk_bf16_f32 v64, v64, v65
    v_cvt_pk_bf16_f32 v65, v66, v67
    v_exp_f32 v68, v68
    v_exp_f32 v69, v69
    v_exp_f32 v70, v70
    v_exp_f32 v71, v71
    s_waitcnt lgkmcnt(11)
    ds_read_b64_tr_b16 a[168:169], v8 offset:1536
    ds_read_b64_tr_b16 a[170:171], v8 offset:1792
    ds_read_b64_tr_b16 a[172:173], v9 offset:1536
    ds_read_b64_tr_b16 a[174:175], v9 offset:1792
    v_pk_add_f32 v[72:73], v[72:73], v[212:213] op_sel_hi:[1,0] neg_lo:[0,1] neg_hi:[0,1]
    v_pk_add_f32 v[74:75], v[74:75], v[212:213] op_sel_hi:[1,0] neg_lo:[0,1] neg_hi:[0,1]
    v_cvt_pk_bf16_f32 v66, v68, v69
    v_cvt_pk_bf16_f32 v67, v70, v71
    buffer_load_dwordx4 v4, s[28:31], s62 offen offset:1024 sc1 lds
    v_exp_f32 v72, v72
    v_exp_f32 v73, v73
    v_exp_f32 v74, v74
    v_exp_f32 v75, v75
    s_waitcnt lgkmcnt(11)
    ds_read_b64_tr_b16 a[176:177], v8 offset:2048
    ds_read_b64_tr_b16 a[178:179], v8 offset:2304
    ds_read_b64_tr_b16 a[180:181], v9 offset:2048
    ds_read_b64_tr_b16 a[182:183], v9 offset:2304
    v_pk_add_f32 v[76:77], v[76:77], v[212:213] op_sel_hi:[1,0] neg_lo:[0,1] neg_hi:[0,1]
    v_pk_add_f32 v[78:79], v[78:79], v[212:213] op_sel_hi:[1,0] neg_lo:[0,1] neg_hi:[0,1]
    v_cvt_pk_bf16_f32 v72, v72, v73
    v_cvt_pk_bf16_f32 v73, v74, v75
    v_exp_f32 v76, v76
    v_exp_f32 v77, v77
    v_exp_f32 v78, v78
    v_exp_f32 v79, v79
    s_waitcnt lgkmcnt(11)
    ds_read_b64_tr_b16 a[184:185], v8 offset:2560
    ds_read_b64_tr_b16 a[186:187], v8 offset:2816
    ds_read_b64_tr_b16 a[188:189], v9 offset:2560
    ds_read_b64_tr_b16 a[190:191], v9 offset:2816
    v_pk_add_f32 v[80:81], v[80:81], v[212:213] op_sel_hi:[1,0] neg_lo:[0,1] neg_hi:[0,1]
    v_pk_add_f32 v[82:83], v[82:83], v[212:213] op_sel_hi:[1,0] neg_lo:[0,1] neg_hi:[0,1]
    v_cvt_pk_bf16_f32 v74, v76, v77
    v_cvt_pk_bf16_f32 v75, v78, v79
    buffer_load_dwordx4 v4, s[28:31], s62 offen offset:2048 sc1 lds
    v_exp_f32 v80, v80
    v_exp_f32 v81, v81
    v_exp_f32 v82, v82
    v_exp_f32 v83, v83
    s_waitcnt lgkmcnt(11)
    ds_read_b64_tr_b16 a[192:193], v8 offset:3072
    ds_read_b64_tr_b16 a[194:195], v8 offset:3328
    ds_read_b64_tr_b16 a[196:197], v9 offset:3072
    ds_read_b64_tr_b16 a[198:199], v9 offset:3328
    v_pk_add_f32 v[84:85], v[84:85], v[212:213] op_sel_hi:[1,0] neg_lo:[0,1] neg_hi:[0,1]
    v_pk_add_f32 v[86:87], v[86:87], v[212:213] op_sel_hi:[1,0] neg_lo:[0,1] neg_hi:[0,1]
    v_cvt_pk_bf16_f32 v80, v80, v81
    v_cvt_pk_bf16_f32 v81, v82, v83
    v_exp_f32 v84, v84
    v_exp_f32 v85, v85
    v_exp_f32 v86, v86
    v_exp_f32 v87, v87
    s_waitcnt lgkmcnt(11)
    ds_read_b64_tr_b16 a[200:201], v8 offset:3584
    ds_read_b64_tr_b16 a[202:203], v8 offset:3840
    ds_read_b64_tr_b16 a[204:205], v9 offset:3584
    ds_read_b64_tr_b16 a[206:207], v9 offset:3840
    v_pk_add_f32 v[88:89], v[88:89], v[212:213] op_sel_hi:[1,0] neg_lo:[0,1] neg_hi:[0,1]
    v_pk_add_f32 v[90:91], v[90:91], v[212:213] op_sel_hi:[1,0] neg_lo:[0,1] neg_hi:[0,1]
    v_cvt_pk_bf16_f32 v82, v84, v85
    v_cvt_pk_bf16_f32 v83, v86, v87
    buffer_load_dwordx4 v4, s[28:31], s62 offen offset:3072 sc1 lds
    v_exp_f32 v88, v88
    v_exp_f32 v89, v89
    v_exp_f32 v90, v90
    v_exp_f32 v91, v91
    s_waitcnt lgkmcnt(11)
    ds_read_b64_tr_b16 a[208:209], v8 offset:4096
    ds_read_b64_tr_b16 a[210:211], v8 offset:4352
    ds_read_b64_tr_b16 a[212:213], v9 offset:4096
    ds_read_b64_tr_b16 a[214:215], v9 offset:4352
    v_pk_add_f32 v[92:93], v[92:93], v[212:213] op_sel_hi:[1,0] neg_lo:[0,1] neg_hi:[0,1]
    v_pk_add_f32 v[94:95], v[94:95], v[212:213] op_sel_hi:[1,0] neg_lo:[0,1] neg_hi:[0,1]
    v_cvt_pk_bf16_f32 v88, v88, v89
    v_cvt_pk_bf16_f32 v89, v90, v91
    s_add_u32 m0, s100, 0x1000
    s_add_u32 s62, s101, 0x1000
    v_exp_f32 v92, v92
    v_exp_f32 v93, v93
    v_exp_f32 v94, v94
    v_exp_f32 v95, v95
    s_waitcnt lgkmcnt(11)
    ds_read_b128 a[72:75], v6 offset:0
    ds_read_b128 a[76:79], v6 offset:256
    ds_read_b128 a[80:83], v6 offset:512
    ds_read_b128 a[84:87], v6 offset:768
    v_pk_add_f32 v[96:97], v[96:97], v[212:213] op_sel_hi:[1,0] neg_lo:[0,1] neg_hi:[0,1]
    v_pk_add_f32 v[98:99], v[98:99], v[212:213] op_sel_hi:[1,0] neg_lo:[0,1] neg_hi:[0,1]
    v_cvt_pk_bf16_f32 v90, v92, v93
    v_cvt_pk_bf16_f32 v91, v94, v95
    buffer_load_dwordx4 v4, s[28:31], s62 offen offset:0 sc1 lds
    v_exp_f32 v96, v96
    v_exp_f32 v97, v97
    v_exp_f32 v98, v98
    v_exp_f32 v99, v99
    s_waitcnt lgkmcnt(11)
    ds_read_b128 a[88:91], v6 offset:1024
    ds_read_b128 a[92:95], v6 offset:1280
    ds_read_b128 a[96:99], v6 offset:1536
    ds_read_b128 a[100:103], v6 offset:1792
    v_pk_add_f32 v[100:101], v[100:101], v[212:213] op_sel_hi:[1,0] neg_lo:[0,1] neg_hi:[0,1]
    v_pk_add_f32 v[102:103], v[102:103], v[212:213] op_sel_hi:[1,0] neg_lo:[0,1] neg_hi:[0,1]
    v_cvt_pk_bf16_f32 v96, v96, v97
    v_cvt_pk_bf16_f32 v97, v98, v99
    v_exp_f32 v100, v100
    v_exp_f32 v101, v101
    v_exp_f32 v102, v102
    v_exp_f32 v103, v103
    s_waitcnt lgkmcnt(11)
    ds_read_b128 a[104:107], v6 offset:2048
    ds_read_b128 a[108:111], v6 offset:2304
    ds_read_b128 a[112:115], v6 offset:2560
    ds_read_b128 a[116:119], v6 offset:2816
    v_pk_add_f32 v[104:105], v[104:105], v[212:213] op_sel_hi:[1,0] neg_lo:[0,1] neg_hi:[0,1]
    v_pk_add_f32 v[106:107], v[106:107], v[212:213] op_sel_hi:[1,0] neg_lo:[0,1] neg_hi:[0,1]
    v_cvt_pk_bf16_f32 v98, v100, v101
    v_cvt_pk_bf16_f32 v99, v102, v103
    buffer_load_dwordx4 v4, s[28:31], s62 offen offset:1024 sc1 lds
    v_exp_f32 v104, v104
    v_exp_f32 v105, v105
    v_exp_f32 v106, v106
    v_exp_f32 v107, v107
    s_waitcnt lgkmcnt(11)
    ds_read_b128 a[120:123], v6 offset:3072
    ds_read_b128 a[124:127], v6 offset:3328
    ds_read_b128 a[128:131], v6 offset:3584
    ds_read_b128 a[132:135], v6 offset:3840
    v_pk_add_f32 v[108:109], v[108:109], v[212:213] op_sel_hi:[1,0] neg_lo:[0,1] neg_hi:[0,1]
    v_pk_add_f32 v[110:111], v[110:111], v[212:213] op_sel_hi:[1,0] neg_lo:[0,1] neg_hi:[0,1]
    v_cvt_pk_bf16_f32 v104, v104, v105
    v_cvt_pk_bf16_f32 v105, v106, v107
    v_exp_f32 v108, v108
    v_exp_f32 v109, v109
    v_exp_f32 v110, v110
    v_exp_f32 v111, v111
    s_waitcnt lgkmcnt(11)
    ds_read_b128 a[136:139], v6 offset:4096
    ds_read_b128 a[140:143], v6 offset:4352
    v_pk_add_f32 v[112:113], v[112:113], v[212:213] op_sel_hi:[1,0] neg_lo:[0,1] neg_hi:[0,1]
    v_pk_add_f32 v[114:115], v[114:115], v[212:213] op_sel_hi:[1,0] neg_lo:[0,1] neg_hi:[0,1]
    v_cvt_pk_bf16_f32 v106, v108, v109
    v_cvt_pk_bf16_f32 v107, v110, v111
    buffer_load_dwordx4 v4, s[28:31], s62 offen offset:2048 sc1 lds
    v_exp_f32 v112, v112
    v_exp_f32 v113, v113
    v_exp_f32 v114, v114
    v_exp_f32 v115, v115
    v_pk_add_f32 v[116:117], v[116:117], v[212:213] op_sel_hi:[1,0] neg_lo:[0,1] neg_hi:[0,1]
    v_pk_add_f32 v[118:119], v[118:119], v[212:213] op_sel_hi:[1,0] neg_lo:[0,1] neg_hi:[0,1]
    v_cvt_pk_bf16_f32 v112, v112, v113
    v_cvt_pk_bf16_f32 v113, v114, v115
    v_exp_f32 v116, v116
    v_exp_f32 v117, v117
    v_exp_f32 v118, v118
    v_exp_f32 v119, v119
    v_pk_add_f32 v[120:121], v[120:121], v[212:213] op_sel_hi:[1,0] neg_lo:[0,1] neg_hi:[0,1]
    v_pk_add_f32 v[122:123], v[122:123], v[212:213] op_sel_hi:[1,0] neg_lo:[0,1] neg_hi:[0,1]
    v_cvt_pk_bf16_f32 v114, v116, v117
    v_cvt_pk_bf16_f32 v115, v118, v119
    buffer_load_dwordx4 v4, s[28:31], s62 offen offset:3072 sc1 lds
    s_add_u32 m0, s100, 0x2000
    s_add_u32 s62, s101, 0x2000
    v_exp_f32 v120, v120
    v_exp_f32 v121, v121
    v_exp_f32 v122, v122
    v_exp_f32 v123, v123
    v_cvt_pk_bf16_f32 v120, v120, v121
    v_cvt_pk_bf16_f32 v121, v122, v123
    v_mov_b32 v122, 0
    v_mov_b32 v123, 0
    buffer_load_dwordx4 v4, s[28:31], s62 offen offset:0 sc1 lds
    s_waitcnt lgkmcnt(0)
    v_mfma_f32_16x16x32_bf16 v[36:39], a[144:147], v[56:59], 0
    v_max3_f32 v208, v124, v125, v126
    v_max3_f32 v209, v127, v128, v129
    v_mfma_f32_16x16x32_bf16 v[40:43], a[148:151], v[56:59], 0
    v_max3_f32 v210, v130, v131, v132
    v_max3_f32 v211, v133, v134, v135
    v_mfma_f32_16x16x32_bf16 v[36:39], a[152:155], v[64:67], v[36:39]
    v_max3_f32 v208, v208, v136, v137
    v_max3_f32 v209, v209, v138, v139
    v_mfma_f32_16x16x32_bf16 v[40:43], a[156:159], v[64:67], v[40:43]
    v_max3_f32 v210, v210, v140, v141
    v_max3_f32 v211, v211, v142, v143
    v_mfma_f32_16x16x32_bf16 v[36:39], a[160:163], v[72:75], v[36:39]
    v_max3_f32 v208, v208, v144, v145
    v_max3_f32 v209, v209, v146, v147
    v_mfma_f32_16x16x32_bf16 v[40:43], a[164:167], v[72:75], v[40:43]
    v_max3_f32 v210, v210, v148, v149
    v_max3_f32 v211, v211, v150, v151
    v_mfma_f32_16x16x32_bf16 v[36:39], a[168:171], v[80:83], v[36:39]
    v_max3_f32 v208, v208, v152, v153
    v_max3_f32 v209, v209, v154, v155
    v_mfma_f32_16x16x32_bf16 v[40:43], a[172:175], v[80:83], v[40:43]
    v_max3_f32 v210, v210, v156, v157
    v_max3_f32 v211, v211, v158, v159
    v_mfma_f32_16x16x32_bf16 v[36:39], a[176:179], v[88:91], v[36:39]
    v_max3_f32 v208, v208, v160, v161
    v_max3_f32 v209, v209, v162, v163
    v_mfma_f32_16x16x32_bf16 v[40:43], a[180:183], v[88:91], v[40:43]
    v_max3_f32 v210, v210, v164, v165
    v_max3_f32 v211, v211, v166, v167
    v_mfma_f32_16x16x32_bf16 v[36:39], a[184:187], v[96:99], v[36:39]
    v_max3_f32 v208, v208, v168, v169
    v_max3_f32 v209, v209, v170, v171
    v_mfma_f32_16x16x32_bf16 v[40:43], a[188:191], v[96:99], v[40:43]
    v_max3_f32 v210, v210, v172, v173
    v_max3_f32 v211, v211, v174, v175
    v_mfma_f32_16x16x32_bf16 v[36:39], a[192:195], v[104:107], v[36:39]
    v_max3_f32 v208, v208, v176, v177
    v_max3_f32 v209, v209, v178, v179
    v_mfma_f32_16x16x32_bf16 v[40:43], a[196:199], v[104:107], v[40:43]
    v_max3_f32 v210, v210, v180, v181
    v_max3_f32 v211, v211, v182, v183
    v_mfma_f32_16x16x32_bf16 v[36:39], a[200:203], v[112:115], v[36:39]
    v_max3_f32 v208, v208, v184, v185
    v_max3_f32 v209, v209, v186, v187
    v_mfma_f32_16x16x32_bf16 v[40:43], a[204:207], v[112:115], v[40:43]
    v_max3_f32 v210, v210, v188, v189
    v_max3_f32 v211, v211, v190, v191
    v_mfma_f32_16x16x32_bf16 v[36:39], a[208:211], v[120:123], v[36:39]
    v_max3_f32 v208, v208, v209, v210
    v_max_f32 v208, v208, v211
    v_mov_b32 v209, v208
    s_nop 0
    s_nop 0
    v_permlane16_swap_b32 v208, v209
    v_max_f32 v208, v208, v209
    v_mov_b32 v209, v208
    s_nop 0
    s_nop 0
    v_permlane32_swap_b32 v208, v209
    v_max_f32 v212, v208, v209
    v_pk_add_f32 v[124:125], v[124:125], v[212:213] op_sel_hi:[1,0] neg_lo:[0,1] neg_hi:[0,1]
    v_pk_add_f32 v[126:127], v[126:127], v[212:213] op_sel_hi:[1,0] neg_lo:[0,1] neg_hi:[0,1]
    v_mfma_f32_16x16x32_bf16 v[40:43], a[212:215], v[120:123], v[40:43]
    v_exp_f32 v124, v124
    v_exp_f32 v125, v125
    v_exp_f32 v126, v126
    v_exp_f32 v127, v127
    s_waitcnt lgkmcnt(12)
    ds_read_b64_tr_b16 a[0:1], v10 offset:0
    ds_read_b64_tr_b16 a[2:3], v10 offset:256
    ds_read_b64_tr_b16 a[4:5], v11 offset:0
    v_pk_add_f32 v[128:129], v[128:129], v[212:213] op_sel_hi:[1,0] neg_lo:[0,1] neg_hi:[0,1]
    v_pk_add_f32 v[130:131], v[130:131], v[212:213] op_sel_hi:[1,0] neg_lo:[0,1] neg_hi:[0,1]
    v_cvt_pk_bf16_f32 v127, v126, v127
    v_cvt_pk_bf16_f32 v126, v124, v125
    v_mov_b32 v124, 0
    v_mov_b32 v125, 0
    v_mfma_f32_16x16x32_bf16 v[56:59], a[72:75], v[28:31], v[12:15]
    v_exp_f32 v128, v128
    v_exp_f32 v129, v129
    v_exp_f32 v130, v130
    v_exp_f32 v131, v131
    s_waitcnt lgkmcnt(12)
    ds_read_b64_tr_b16 a[6:7], v11 offset:256
    ds_read_b64_tr_b16 a[8:9], v10 offset:512
    ds_read_b64_tr_b16 a[10:11], v10 offset:768
    v_pk_add_f32 v[132:133], v[132:133], v[212:213] op_sel_hi:[1,0] neg_lo:[0,1] neg_hi:[0,1]
    v_pk_add_f32 v[134:135], v[134:135], v[212:213] op_sel_hi:[1,0] neg_lo:[0,1] neg_hi:[0,1]
    v_cvt_pk_bf16_f32 v128, v128, v129
    v_cvt_pk_bf16_f32 v129, v130, v131
    buffer_load_dwordx4 v4, s[28:31], s62 offen offset:1024 sc1 lds
    v_mfma_f32_16x16x32_bf16 v[60:63], a[76:79], v[28:31], 0
    v_exp_f32 v132, v132
    v_exp_f32 v133, v133
    v_exp_f32 v134, v134
    v_exp_f32 v135, v135
    s_waitcnt lgkmcnt(12)
    ds_read_b64_tr_b16 a[12:13], v11 offset:512
    ds_read_b64_tr_b16 a[14:15], v11 offset:768
    ds_read_b64_tr_b16 a[16:17], v10 offset:1024
    v_pk_add_f32 v[136:137], v[136:137], v[212:213] op_sel_hi:[1,0] neg_lo:[0,1] neg_hi:[0,1]
    v_pk_add_f32 v[138:139], v[138:139], v[212:213] op_sel_hi:[1,0] neg_lo:[0,1] neg_hi:[0,1]
    v_cvt_pk_bf16_f32 v130, v132, v133
    v_cvt_pk_bf16_f32 v131, v134, v135
    v_mfma_f32_16x16x32_bf16 v[64:67], a[80:83], v[28:31], 0
    v_exp_f32 v136, v136
    v_exp_f32 v137, v137
    v_exp_f32 v138, v138
    v_exp_f32 v139, v139
    s_waitcnt lgkmcnt(12)
    ds_read_b64_tr_b16 a[18:19], v10 offset:1280
    ds_read_b64_tr_b16 a[20:21], v11 offset:1024
    ds_read_b64_tr_b16 a[22:23], v11 offset:1280
    v_pk_add_f32 v[140:141], v[140:141], v[212:213] op_sel_hi:[1,0] neg_lo:[0,1] neg_hi:[0,1]
    v_pk_add_f32 v[142:143], v[142:143], v[212:213] op_sel_hi:[1,0] neg_lo:[0,1] neg_hi:[0,1]
    v_cvt_pk_bf16_f32 v136, v136, v137
    v_cvt_pk_bf16_f32 v137, v138, v139
    buffer_load_dwordx4 v4, s[28:31], s62 offen offset:2048 sc1 lds
    v_mfma_f32_16x16x32_bf16 v[68:71], a[84:87], v[28:31], 0
    v_exp_f32 v140, v140
    v_exp_f32 v141, v141
    v_exp_f32 v142, v142
    v_exp_f32 v143, v143
    s_waitcnt lgkmcnt(12)
    ds_read_b64_tr_b16 a[24:25], v10 offset:1536
    ds_read_b64_tr_b16 a[26:27], v10 offset:1792
    ds_read_b64_tr_b16 a[28:29], v11 offset:1536
    v_pk_add_f32 v[144:145], v[144:145], v[212:213] op_sel_hi:[1,0] neg_lo:[0,1] neg_hi:[0,1]
    v_pk_add_f32 v[146:147], v[146:147], v[212:213] op_sel_hi:[1,0] neg_lo:[0,1] neg_hi:[0,1]
    v_cvt_pk_bf16_f32 v138, v140, v141
    v_cvt_pk_bf16_f32 v139, v142, v143
    buffer_load_dwordx4 v4, s[28:31], s62 offen offset:3072 sc1 lds
    v_mfma_f32_16x16x32_bf16 v[72:75], a[88:91], v[28:31], 0
    v_exp_f32 v144, v144
    v_exp_f32 v145, v145
    v_exp_f32 v146, v146
    v_exp_f32 v147, v147
    s_waitcnt lgkmcnt(12)
    ds_read_b64_tr_b16 a[30:31], v11 offset:1792
    ds_read_b64_tr_b16 a[32:33], v10 offset:2048
    ds_read_b64_tr_b16 a[34:35], v10 offset:2304
    v_pk_add_f32 v[148:149], v[148:149], v[212:213] op_sel_hi:[1,0] neg_lo:[0,1] neg_hi:[0,1]
    v_pk_add_f32 v[150:151], v[150:151], v[212:213] op_sel_hi:[1,0] neg_lo:[0,1] neg_hi:[0,1]
    v_cvt_pk_bf16_f32 v144, v144, v145
    v_cvt_pk_bf16_f32 v145, v146, v147
    v_mfma_f32_16x16x32_bf16 v[76:79], a[92:95], v[28:31], 0
    s_add_u32 m0, s100, 0x3000
    s_add_u32 s62, s101, 0x3000
    v_exp_f32 v148, v148
    v_exp_f32 v149, v149
    v_exp_f32 v150, v150
    v_exp_f32 v151, v151
    s_waitcnt lgkmcnt(12)
    ds_read_b64_tr_b16 a[36:37], v11 offset:2048
    ds_read_b64_tr_b16 a[38:39], v11 offset:2304
    ds_read_b64_tr_b16 a[40:41], v10 offset:2560
    v_pk_add_f32 v[152:153], v[152:153], v[212:213] op_sel_hi:[1,0] neg_lo:[0,1] neg_hi:[0,1]
    v_pk_add_f32 v[154:155], v[154:155], v[212:213] op_sel_hi:[1,0] neg_lo:[0,1] neg_hi:[0,1]
    v_cvt_pk_bf16_f32 v146, v148, v149
    v_cvt_pk_bf16_f32 v147, v150, v151
    buffer_load_dwordx4 v4, s[28:31], s62 offen offset:0 sc1 lds
    v_mfma_f32_16x16x32_bf16 v[80:83], a[96:99], v[28:31], 0
    v_exp_f32 v152, v152
    v_exp_f32 v153, v153
    v_exp_f32 v154, v154
    v_exp_f32 v155, v155
    s_waitcnt lgkmcnt(12)
    ds_read_b64_tr_b16 a[42:43], v10 offset:2816
    ds_read_b64_tr_b16 a[44:45], v11 offset:2560
    ds_read_b64_tr_b16 a[46:47], v11 offset:2816
    v_pk_add_f32 v[156:157], v[156:157], v[212:213] op_sel_hi:[1,0] neg_lo:[0,1] neg_hi:[0,1]
    v_pk_add_f32 v[158:159], v[158:159], v[212:213] op_sel_hi:[1,0] neg_lo:[0,1] neg_hi:[0,1]
    v_cvt_pk_bf16_f32 v152, v152, v153
    v_cvt_pk_bf16_f32 v153, v154, v155
    buffer_load_dwordx4 v4, s[28:31], s62 offen offset:1024 sc1 lds
    v_mfma_f32_16x16x32_bf16 v[84:87], a[100:103], v[28:31], 0
    v_exp_f32 v156, v156
    v_exp_f32 v157, v157
    v_exp_f32 v158, v158
    v_exp_f32 v159, v159
    s_waitcnt lgkmcnt(12)
    ds_read_b64_tr_b16 a[48:49], v10 offset:3072
    ds_read_b64_tr_b16 a[50:51], v10 offset:3328
    ds_read_b64_tr_b16 a[52:53], v11 offset:3072
    v_pk_add_f32 v[160:161], v[160:161], v[212:213] op_sel_hi:[1,0] neg_lo:[0,1] neg_hi:[0,1]
    v_pk_add_f32 v[162:163], v[162:163], v[212:213] op_sel_hi:[1,0] neg_lo:[0,1] neg_hi:[0,1]
    v_cvt_pk_bf16_f32 v154, v156, v157
    v_cvt_pk_bf16_f32 v155, v158, v159
    v_mfma_f32_16x16x32_bf16 v[88:91], a[104:107], v[28:31], 0
    v_exp_f32 v160, v160
    v_exp_f32 v161, v161
    v_exp_f32 v162, v162
    v_exp_f32 v163, v163
    s_waitcnt lgkmcnt(12)
    ds_read_b64_tr_b16 a[54:55], v11 offset:3328
    ds_read_b64_tr_b16 a[56:57], v10 offset:3584
    ds_read_b64_tr_b16 a[58:59], v10 offset:3840
    v_pk_add_f32 v[164:165], v[164:165], v[212:213] op_sel_hi:[1,0] neg_lo:[0,1] neg_hi:[0,1]
    v_pk_add_f32 v[166:167], v[166:167], v[212:213] op_sel_hi:[1,0] neg_lo:[0,1] neg_hi:[0,1]
    v_cvt_pk_bf16_f32 v160, v160, v161
    v_cvt_pk_bf16_f32 v161, v162, v163
    buffer_load_dwordx4 v4, s[28:31], s62 offen offset:2048 sc1 lds
    v_mfma_f32_16x16x32_bf16 v[92:95], a[108:111], v[28:31], 0
    v_exp_f32 v164, v164
    v_exp_f32 v165, v165
    v_exp_f32 v166, v166
    v_exp_f32 v167, v167
    s_waitcnt lgkmcnt(12)
    ds_read_b64_tr_b16 a[60:61], v11 offset:3584
    ds_read_b64_tr_b16 a[62:63], v11 offset:3840
    ds_read_b64_tr_b16 a[64:65], v10 offset:4096
    v_pk_add_f32 v[168:169], v[168:169], v[212:213] op_sel_hi:[1,0] neg_lo:[0,1] neg_hi:[0,1]
    v_pk_add_f32 v[170:171], v[170:171], v[212:213] op_sel_hi:[1,0] neg_lo:[0,1] neg_hi:[0,1]
    v_cvt_pk_bf16_f32 v162, v164, v165
    v_cvt_pk_bf16_f32 v163, v166, v167
    buffer_load_dwordx4 v4, s[28:31], s62 offen offset:3072 sc1 lds
    v_mfma_f32_16x16x32_bf16 v[96:99], a[112:115], v[28:31], 0
    v_exp_f32 v168, v168
    v_exp_f32 v169, v169
    v_exp_f32 v170, v170
    v_exp_f32 v171, v171
    s_waitcnt lgkmcnt(12)
    ds_read_b64_tr_b16 a[66:67], v10 offset:4352
    ds_read_b64_tr_b16 a[68:69], v11 offset:4096
    ds_read_b64_tr_b16 a[70:71], v11 offset:4352
    v_pk_add_f32 v[172:173], v[172:173], v[212:213] op_sel_hi:[1,0] neg_lo:[0,1] neg_hi:[0,1]
    v_pk_add_f32 v[174:175], v[174:175], v[212:213] op_sel_hi:[1,0] neg_lo:[0,1] neg_hi:[0,1]
    v_cvt_pk_bf16_f32 v168, v168, v169
    v_cvt_pk_bf16_f32 v169, v170, v171
    v_mfma_f32_16x16x32_bf16 v[100:103], a[116:119], v[28:31], 0
    s_add_u32 m0, s100, 0x4000
    s_add_u32 s62, s101, 0x4000
    v_exp_f32 v172, v172
    v_exp_f32 v173, v173
    v_exp_f32 v174, v174
    v_exp_f32 v175, v175
    v_pk_add_f32 v[176:177], v[176:177], v[212:213] op_sel_hi:[1,0] neg_lo:[0,1] neg_hi:[0,1]
    v_pk_add_f32 v[178:179], v[178:179], v[212:213] op_sel_hi:[1,0] neg_lo:[0,1] neg_hi:[0,1]
    v_cvt_pk_bf16_f32 v170, v172, v173
    v_cvt_pk_bf16_f32 v171, v174, v175
    buffer_load_dwordx4 v4, s[28:31], s62 offen offset:0 sc1 lds
    v_mfma_f32_16x16x32_bf16 v[104:107], a[120:123], v[28:31], 0
    s_mov_b32 m0, s76
    s_add_u32 s62, s75, 0xc000
    v_exp_f32 v176, v176
    v_exp_f32 v177, v177
    v_exp_f32 v178, v178
    v_exp_f32 v179, v179
    v_pk_add_f32 v[180:181], v[180:181], v[212:213] op_sel_hi:[1,0] neg_lo:[0,1] neg_hi:[0,1]
    v_pk_add_f32 v[182:183], v[182:183], v[212:213] op_sel_hi:[1,0] neg_lo:[0,1] neg_hi:[0,1]
    v_cvt_pk_bf16_f32 v176, v176, v177
    v_cvt_pk_bf16_f32 v177, v178, v179
    buffer_load_dwordx4 v4, s[28:31], s62 offen sc1 lds
    v_mfma_f32_16x16x32_bf16 v[108:111], a[124:127], v[28:31], 0
    v_exp_f32 v180, v180
    v_exp_f32 v181, v181
    v_exp_f32 v182, v182
    v_exp_f32 v183, v183
    v_pk_add_f32 v[184:185], v[184:185], v[212:213] op_sel_hi:[1,0] neg_lo:[0,1] neg_hi:[0,1]
    v_pk_add_f32 v[186:187], v[186:187], v[212:213] op_sel_hi:[1,0] neg_lo:[0,1] neg_hi:[0,1]
    v_cvt_pk_bf16_f32 v178, v180, v181
    v_cvt_pk_bf16_f32 v179, v182, v183
    v_mfma_f32_16x16x32_bf16 v[112:115], a[128:131], v[28:31], 0
    s_mov_b32 m0, s76
    s_add_u32 s62, s75, 0xd000
    v_exp_f32 v184, v184
    v_exp_f32 v185, v185
    v_exp_f32 v186, v186
    v_exp_f32 v187, v187
    v_pk_add_f32 v[188:189], v[188:189], v[212:213] op_sel_hi:[1,0] neg_lo:[0,1] neg_hi:[0,1]
    v_pk_add_f32 v[190:191], v[190:191], v[212:213] op_sel_hi:[1,0] neg_lo:[0,1] neg_hi:[0,1]
    v_cvt_pk_bf16_f32 v184, v184, v185
    v_cvt_pk_bf16_f32 v185, v186, v187
    buffer_load_dwordx4 v4, s[28:31], s62 offen sc1 lds
    v_mfma_f32_16x16x32_bf16 v[116:119], a[132:135], v[28:31], 0
    s_mov_b32 m0, s76
    s_add_u32 s62, s75, 0xe000
    v_exp_f32 v188, v188
    v_exp_f32 v189, v189
    v_exp_f32 v190, v190
    v_exp_f32 v191, v191
    v_cvt_pk_bf16_f32 v186, v188, v189
    v_cvt_pk_bf16_f32 v187, v190, v191
    buffer_load_dwordx4 v4, s[28:31], s62 offen sc1 lds
    v_mfma_f32_16x16x32_bf16 v[120:123], a[136:139], v[28:31], v[16:19]
    s_waitcnt lgkmcnt(0)
    s_barrier
    v_mov_b32 v214, v40
    v_mov_b32 v215, v40
    s_nop 1
    v_permlane16_swap_b32 v214, v215
    v_rcp_f32 v216, v215
    s_nop 0
    v_pk_mul_f32 v[36:37], v[36:37], v[216:217] op_sel_hi:[1,0]
    v_pk_mul_f32 v[40:41], v[40:41], v[216:217] op_sel_hi:[1,0]
    v_pk_mul_f32 v[38:39], v[38:39], v[216:217] op_sel_hi:[1,0]
    v_pk_mul_f32 v[42:43], v[42:43], v[216:217] op_sel_hi:[1,0]
    v_cvt_pk_bf16_f32 v36, v36, v37
    v_cvt_pk_bf16_f32 v37, v38, v39
    v_cvt_pk_bf16_f32 v40, v40, v41
    v_cvt_pk_bf16_f32 v41, v42, v43
    ds_write_b64 v54, v[36:37] offset:0
    s_mov_b64 exec, 0xffff
    ds_write_b64 v54, v[40:41] offset:32
    s_mov_b64 exec, -1
    v_mfma_f32_16x16x32_bf16 v[44:47], a[144:147], v[124:127], 0
    v_max3_f32 v208, v56, v57, v58
    v_max3_f32 v209, v59, v60, v61
    v_mfma_f32_16x16x32_bf16 v[48:51], a[148:151], v[124:127], 0
    v_max3_f32 v210, v62, v63, v64
    v_max3_f32 v211, v65, v66, v67
    v_mfma_f32_16x16x32_bf16 v[44:47], a[152:155], v[128:131], v[44:47]
    v_max3_f32 v208, v208, v68, v69
    v_max3_f32 v209, v209, v70, v71
    v_mfma_f32_16x16x32_bf16 v[48:51], a[156:159], v[128:131], v[48:51]
    v_max3_f32 v210, v210, v72, v73
    v_max3_f32 v211, v211, v74, v75
    v_mfma_f32_16x16x32_bf16 v[44:47], a[160:163], v[136:139], v[44:47]
    v_max3_f32 v208, v208, v76, v77
    v_max3_f32 v209, v209, v78, v79
    v_mfma_f32_16x16x32_bf16 v[48:51], a[164:167], v[136:139], v[48:51]
    v_max3_f32 v210, v210, v80, v81
    v_max3_f32 v211, v211, v82, v83
    v_mfma_f32_16x16x32_bf16 v[44:47], a[168:171], v[144:147], v[44:47]
    v_max3_f32 v208, v208, v84, v85
    v_max3_f32 v209, v209, v86, v87
    v_mfma_f32_16x16x32_bf16 v[48:51], a[172:175], v[144:147], v[48:51]
    v_max3_f32 v210, v210, v88, v89
    v_max3_f32 v211, v211, v90, v91
    v_mfma_f32_16x16x32_bf16 v[44:47], a[176:179], v[152:155], v[44:47]
    v_max3_f32 v208, v208, v92, v93
    v_max3_f32 v209, v209, v94, v95
    v_mfma_f32_16x16x32_bf16 v[48:51], a[180:183], v[152:155], v[48:51]
    v_max3_f32 v210, v210, v96, v97
    v_max3_f32 v211, v211, v98, v99
    v_mfma_f32_16x16x32_bf16 v[44:47], a[184:187], v[160:163], v[44:47]
    v_max3_f32 v208, v208, v100, v101
    v_max3_f32 v209, v209, v102, v103
    v_mfma_f32_16x16x32_bf16 v[48:51], a[188:191], v[160:163], v[48:51]
    v_max3_f32 v210, v210, v104, v105
    v_max3_f32 v211, v211, v106, v107
    v_mfma_f32_16x16x32_bf16 v[44:47], a[192:195], v[168:171], v[44:47]
    v_max3_f32 v208, v208, v108, v109
    v_max3_f32 v209, v209, v110, v111
    v_mfma_f32_16x16x32_bf16 v[48:51], a[196:199], v[168:171], v[48:51]
    v_max3_f32 v210, v210, v112, v113
    v_max3_f32 v211, v211, v114, v115
    v_mfma_f32_16x16x32_bf16 v[44:47], a[200:203], v[176:179], v[44:47]
    v_max3_f32 v208, v208, v116, v117
    v_max3_f32 v209, v209, v118, v119
    v_mfma_f32_16x16x32_bf16 v[48:51], a[204:207], v[176:179], v[48:51]
    v_max3_f32 v210, v210, v120, v121
    v_max3_f32 v211, v211, v122, v123
    v_mfma_f32_16x16x32_bf16 v[44:47], a[208:211], v[184:187], v[44:47]
    v_max3_f32 v208, v208, v209, v210
    v_max_f32 v208, v208, v211
    v_mov_b32 v209, v208
    s_nop 0
    s_nop 0
    v_permlane16_swap_b32 v208, v209
    v_max_f32 v208, v208, v209
    v_mov_b32 v209, v208
    s_nop 0
    s_nop 0
    v_permlane32_swap_b32 v208, v209
    v_max_f32 v212, v208, v209
    v_pk_add_f32 v[56:57], v[56:57], v[212:213] op_sel_hi:[1,0] neg_lo:[0,1] neg_hi:[0,1]
    v_pk_add_f32 v[58:59], v[58:59], v[212:213] op_sel_hi:[1,0] neg_lo:[0,1] neg_hi:[0,1]
    v_mfma_f32_16x16x32_bf16 v[48:51], a[212:215], v[184:187], v[48:51]
    v_exp_f32 v56, v56
    v_exp_f32 v57, v57
    v_exp_f32 v58, v58
    v_exp_f32 v59, v59
    v_pk_add_f32 v[60:61], v[60:61], v[212:213] op_sel_hi:[1,0] neg_lo:[0,1] neg_hi:[0,1]
    v_pk_add_f32 v[62:63], v[62:63], v[212:213] op_sel_hi:[1,0] neg_lo:[0,1] neg_hi:[0,1]
    v_cvt_pk_bf16_f32 v56, v56, v57
    v_cvt_pk_bf16_f32 v57, v58, v59
    v_mfma_f32_16x16x32_bf16 v[124:127], a[76:79], v[32:35], v[12:15]
    s_mul_i32 s100, s36, 8192
    s_add_u32 s101, s100, s90
    s_sub_u32 s101, s101, s93
    s_add_u32 s101, s101, 0x11000
    s_add_u32 s100, s100, 0x0
    s_add_u32 m0, s100, 0x0
    s_add_u32 s62, s101, 0x0
    v_exp_f32 v60, v60
    v_exp_f32 v61, v61
    v_exp_f32 v62, v62
    v_exp_f32 v63, v63
    v_pk_add_f32 v[64:65], v[64:65], v[212:213] op_sel_hi:[1,0] neg_lo:[0,1] neg_hi:[0,1]
    v_pk_add_f32 v[66:67], v[66:67], v[212:213] op_sel_hi:[1,0] neg_lo:[0,1] neg_hi:[0,1]
    v_cvt_pk_bf16_f32 v58, v60, v61
    v_cvt_pk_bf16_f32 v59, v62, v63
    buffer_load_dwordx4 v4, s[28:31], s62 offen offset:0 sc1 lds
    v_mfma_f32_16x16x32_bf16 v[128:131], a[80:83], v[32:35], 0
    v_exp_f32 v64, v64
    v_exp_f32 v65, v65
    v_exp_f32 v66, v66
    v_exp_f32 v67, v67
    v_pk_add_f32 v[68:69], v[68:69], v[212:213] op_sel_hi:[1,0] neg_lo:[0,1] neg_hi:[0,1]
    v_pk_add_f32 v[70:71], v[70:71], v[212:213] op_sel_hi:[1,0] neg_lo:[0,1] neg_hi:[0,1]
    v_cvt_pk_bf16_f32 v64, v64, v65
    v_cvt_pk_bf16_f32 v65, v66, v67
    buffer_load_dwordx4 v4, s[28:31], s62 offen offset:1024 sc1 lds
    v_mfma_f32_16x16x32_bf16 v[132:135], a[84:87], v[32:35], 0
    v_exp_f32 v68, v68
    v_exp_f32 v69, v69
    v_exp_f32 v70, v70
    v_exp_f32 v71, v71
    v_pk_add_f32 v[72:73], v[72:73], v[212:213] op_sel_hi:[1,0] neg_lo:[0,1] neg_hi:[0,1]
    v_pk_add_f32 v[74:75], v[74:75], v[212:213] op_sel_hi:[1,0] neg_lo:[0,1] neg_hi:[0,1]
    v_cvt_pk_bf16_f32 v66, v68, v69
    v_cvt_pk_bf16_f32 v67, v70, v71
    v_mfma_f32_16x16x32_bf16 v[136:139], a[88:91], v[32:35], 0
    v_exp_f32 v72, v72
    v_exp_f32 v73, v73
    v_exp_f32 v74, v74
    v_exp_f32 v75, v75
    v_pk_add_f32 v[76:77], v[76:77], v[212:213] op_sel_hi:[1,0] neg_lo:[0,1] neg_hi:[0,1]
    v_pk_add_f32 v[78:79], v[78:79], v[212:213] op_sel_hi:[1,0] neg_lo:[0,1] neg_hi:[0,1]
    v_cvt_pk_bf16_f32 v72, v72, v73
    v_cvt_pk_bf16_f32 v73, v74, v75
    buffer_load_dwordx4 v4, s[28:31], s62 offen offset:2048 sc1 lds
    v_mfma_f32_16x16x32_bf16 v[140:143], a[92:95], v[32:35], 0
    v_exp_f32 v76, v76
    v_exp_f32 v77, v77
    v_exp_f32 v78, v78
    v_exp_f32 v79, v79
    v_pk_add_f32 v[80:81], v[80:81], v[212:213] op_sel_hi:[1,0] neg_lo:[0,1] neg_hi:[0,1]
    v_pk_add_f32 v[82:83], v[82:83], v[212:213] op_sel_hi:[1,0] neg_lo:[0,1] neg_hi:[0,1]
    v_cvt_pk_bf16_f32 v74, v76, v77
    v_cvt_pk_bf16_f32 v75, v78, v79
    buffer_load_dwordx4 v4, s[28:31], s62 offen offset:3072 sc1 lds
    v_mfma_f32_16x16x32_bf16 v[144:147], a[96:99], v[32:35], 0
    v_exp_f32 v80, v80
    v_exp_f32 v81, v81
    v_exp_f32 v82, v82
    v_exp_f32 v83, v83
    v_pk_add_f32 v[84:85], v[84:85], v[212:213] op_sel_hi:[1,0] neg_lo:[0,1] neg_hi:[0,1]
    v_pk_add_f32 v[86:87], v[86:87], v[212:213] op_sel_hi:[1,0] neg_lo:[0,1] neg_hi:[0,1]
    v_cvt_pk_bf16_f32 v80, v80, v81
    v_cvt_pk_bf16_f32 v81, v82, v83
    v_mfma_f32_16x16x32_bf16 v[148:151], a[100:103], v[32:35], 0
    s_add_u32 m0, s100, 0x1000
    s_add_u32 s62, s101, 0x1000
    v_exp_f32 v84, v84
    v_exp_f32 v85, v85
    v_exp_f32 v86, v86
    v_exp_f32 v87, v87
    v_pk_add_f32 v[88:89], v[88:89], v[212:213] op_sel_hi:[1,0] neg_lo:[0,1] neg_hi:[0,1]
    v_pk_add_f32 v[90:91], v[90:91], v[212:213] op_sel_hi:[1,0] neg_lo:[0,1] neg_hi:[0,1]
    v_cvt_pk_bf16_f32 v82, v84, v85
    v_cvt_pk_bf16_f32 v83, v86, v87
    buffer_load_dwordx4 v4, s[28:31], s62 offen offset:0 sc1 lds
    v_mfma_f32_16x16x32_bf16 v[152:155], a[104:107], v[32:35], 0
    v_exp_f32 v88, v88
    v_exp_f32 v89, v89
    v_exp_f32 v90, v90
    v_exp_f32 v91, v91
    v_pk_add_f32 v[92:93], v[92:93], v[212:213] op_sel_hi:[1,0] neg_lo:[0,1] neg_hi:[0,1]
    v_pk_add_f32 v[94:95], v[94:95], v[212:213] op_sel_hi:[1,0] neg_lo:[0,1] neg_hi:[0,1]
    v_cvt_pk_bf16_f32 v88, v88, v89
    v_cvt_pk_bf16_f32 v89, v90, v91
    buffer_load_dwordx4 v4, s[28:31], s62 offen offset:1024 sc1 lds
    v_mfma_f32_16x16x32_bf16 v[156:159], a[108:111], v[32:35], 0
    v_exp_f32 v92, v92
    v_exp_f32 v93, v93
    v_exp_f32 v94, v94
    v_exp_f32 v95, v95
    v_pk_add_f32 v[96:97], v[96:97], v[212:213] op_sel_hi:[1,0] neg_lo:[0,1] neg_hi:[0,1]
    v_pk_add_f32 v[98:99], v[98:99], v[212:213] op_sel_hi:[1,0] neg_lo:[0,1] neg_hi:[0,1]
    v_cvt_pk_bf16_f32 v90, v92, v93
    v_cvt_pk_bf16_f32 v91, v94, v95
    buffer_load_dwordx4 v4, s[28:31], s62 offen offset:2048 sc1 lds
    v_mfma_f32_16x16x32_bf16 v[160:163], a[112:115], v[32:35], 0
    v_exp_f32 v96, v96
    v_exp_f32 v97, v97
    v_exp_f32 v98, v98
    v_exp_f32 v99, v99
    v_pk_add_f32 v[100:101], v[100:101], v[212:213] op_sel_hi:[1,0] neg_lo:[0,1] neg_hi:[0,1]
    v_pk_add_f32 v[102:103], v[102:103], v[212:213] op_sel_hi:[1,0] neg_lo:[0,1] neg_hi:[0,1]
    v_cvt_pk_bf16_f32 v96, v96, v97
    v_cvt_pk_bf16_f32 v97, v98, v99
    v_mfma_f32_16x16x32_bf16 v[164:167], a[116:119], v[32:35], 0
    v_exp_f32 v100, v100
    v_exp_f32 v101, v101
    v_exp_f32 v102, v102
    v_exp_f32 v103, v103
    v_pk_add_f32 v[104:105], v[104:105], v[212:213] op_sel_hi:[1,0] neg_lo:[0,1] neg_hi:[0,1]
    v_pk_add_f32 v[106:107], v[106:107], v[212:213] op_sel_hi:[1,0] neg_lo:[0,1] neg_hi:[0,1]
    v_cvt_pk_bf16_f32 v98, v100, v101
    v_cvt_pk_bf16_f32 v99, v102, v103
    buffer_load_dwordx4 v4, s[28:31], s62 offen offset:3072 sc1 lds
    v_mfma_f32_16x16x32_bf16 v[168:171], a[120:123], v[32:35], 0
    s_mov_b32 m0, s76
    s_add_u32 s62, s75, 0xf000
    v_exp_f32 v104, v104
    v_exp_f32 v105, v105
    v_exp_f32 v106, v106
    v_exp_f32 v107, v107
    v_pk_add_f32 v[108:109], v[108:109], v[212:213] op_sel_hi:[1,0] neg_lo:[0,1] neg_hi:[0,1]
    v_pk_add_f32 v[110:111], v[110:111], v[212:213] op_sel_hi:[1,0] neg_lo:[0,1] neg_hi:[0,1]
    v_cvt_pk_bf16_f32 v104, v104, v105
    v_cvt_pk_bf16_f32 v105, v106, v107
    buffer_load_dwordx4 v4, s[28:31], s62 offen sc1 lds
    v_mfma_f32_16x16x32_bf16 v[172:175], a[124:127], v[32:35], 0
    v_exp_f32 v108, v108
    v_exp_f32 v109, v109
    v_exp_f32 v110, v110
    v_exp_f32 v111, v111
    v_pk_add_f32 v[112:113], v[112:113], v[212:213] op_sel_hi:[1,0] neg_lo:[0,1] neg_hi:[0,1]
    v_pk_add_f32 v[114:115], v[114:115], v[212:213] op_sel_hi:[1,0] neg_lo:[0,1] neg_hi:[0,1]
    v_cvt_pk_bf16_f32 v106, v108, v109
    v_cvt_pk_bf16_f32 v107, v110, v111
    v_mfma_f32_16x16x32_bf16 v[176:179], a[128:131], v[32:35], 0
    s_mov_b32 m0, s76
    s_add_u32 s62, s75, 0x10000
    v_exp_f32 v112, v112
    v_exp_f32 v113, v113
    v_exp_f32 v114, v114
    v_exp_f32 v115, v115
    v_pk_add_f32 v[116:117], v[116:117], v[212:213] op_sel_hi:[1,0] neg_lo:[0,1] neg_hi:[0,1]
    v_pk_add_f32 v[118:119], v[118:119], v[212:213] op_sel_hi:[1,0] neg_lo:[0,1] neg_hi:[0,1]
    v_cvt_pk_bf16_f32 v112, v112, v113
    v_cvt_pk_bf16_f32 v113, v114, v115
    buffer_load_dwordx4 v4, s[28:31], s62 offen sc1 lds
    v_mfma_f32_16x16x32_bf16 v[180:183], a[132:135], v[32:35], 0
    s_mov_b32 m0, s76
    s_add_u32 s62, s75, 0x11000
    v_exp_f32 v116, v116
    v_exp_f32 v117, v117
    v_exp_f32 v118, v118
    v_exp_f32 v119, v119
    v_pk_add_f32 v[120:121], v[120:121], v[212:213] op_sel_hi:[1,0] neg_lo:[0,1] neg_hi:[0,1]
    v_pk_add_f32 v[122:123], v[122:123], v[212:213] op_sel_hi:[1,0] neg_lo:[0,1] neg_hi:[0,1]
    v_cvt_pk_bf16_f32 v114, v116, v117
    v_cvt_pk_bf16_f32 v115, v118, v119
    buffer_load_dwordx4 v4, s[28:31], s62 offen sc1 lds
    v_mfma_f32_16x16x32_bf16 v[184:187], a[136:139], v[32:35], 0
    s_mov_b32 m0, s76
    s_add_u32 s62, s75, 0x12000
    v_exp_f32 v120, v120
    v_exp_f32 v121, v121
    v_exp_f32 v122, v122
    v_exp_f32 v123, v123
    v_cvt_pk_bf16_f32 v120, v120, v121
    v_cvt_pk_bf16_f32 v121, v122, v123
    v_mov_b32 v122, 0
    v_mov_b32 v123, 0
    buffer_load_dwordx4 v4, s[28:31], s62 offen sc1 lds
    v_mfma_f32_16x16x32_bf16 v[188:191], a[140:143], v[32:35], v[16:19]
    v_mov_b32 v214, v48
    v_mov_b32 v215, v48
    s_nop 1
    v_permlane16_swap_b32 v214, v215
    v_rcp_f32 v216, v215
    s_nop 0
    v_pk_mul_f32 v[44:45], v[44:45], v[216:217] op_sel_hi:[1,0]
    v_pk_mul_f32 v[48:49], v[48:49], v[216:217] op_sel_hi:[1,0]
    v_pk_mul_f32 v[46:47], v[46:47], v[216:217] op_sel_hi:[1,0]
    v_pk_mul_f32 v[50:51], v[50:51], v[216:217] op_sel_hi:[1,0]
    v_cvt_pk_bf16_f32 v44, v44, v45
    v_cvt_pk_bf16_f32 v45, v46, v47
    v_cvt_pk_bf16_f32 v48, v48, v49
    v_cvt_pk_bf16_f32 v49, v50, v51
    ds_write_b64 v54, v[44:45] offset:1280
    s_mov_b64 exec, 0xffff
    ds_write_b64 v54, v[48:49] offset:1312
    s_mov_b64 exec, -1
    v_mfma_f32_16x16x32_bf16 v[36:39], a[0:3], v[56:59], 0
    v_max3_f32 v208, v124, v125, v126
    v_max3_f32 v209, v127, v128, v129
    v_mfma_f32_16x16x32_bf16 v[40:43], a[4:7], v[56:59], 0
    v_max3_f32 v210, v130, v131, v132
    v_max3_f32 v211, v133, v134, v135
    v_mfma_f32_16x16x32_bf16 v[36:39], a[8:11], v[64:67], v[36:39]
    v_max3_f32 v208, v208, v136, v137
    v_max3_f32 v209, v209, v138, v139
    v_mfma_f32_16x16x32_bf16 v[40:43], a[12:15], v[64:67], v[40:43]
    v_max3_f32 v210, v210, v140, v141
    v_max3_f32 v211, v211, v142, v143
    v_mfma_f32_16x16x32_bf16 v[36:39], a[16:19], v[72:75], v[36:39]
    v_max3_f32 v208, v208, v144, v145
    v_max3_f32 v209, v209, v146, v147
    v_mfma_f32_16x16x32_bf16 v[40:43], a[20:23], v[72:75], v[40:43]
    v_max3_f32 v210, v210, v148, v149
    v_max3_f32 v211, v211, v150, v151
    v_mfma_f32_16x16x32_bf16 v[36:39], a[24:27], v[80:83], v[36:39]
    v_max3_f32 v208, v208, v152, v153
    v_max3_f32 v209, v209, v154, v155
    v_mfma_f32_16x16x32_bf16 v[40:43], a[28:31], v[80:83], v[40:43]
    v_max3_f32 v210, v210, v156, v157
    v_max3_f32 v211, v211, v158, v159
    v_mfma_f32_16x16x32_bf16 v[36:39], a[32:35], v[88:91], v[36:39]
    v_max3_f32 v208, v208, v160, v161
    v_max3_f32 v209, v209, v162, v163
    v_mfma_f32_16x16x32_bf16 v[40:43], a[36:39], v[88:91], v[40:43]
    v_max3_f32 v210, v210, v164, v165
    v_max3_f32 v211, v211, v166, v167
    v_mfma_f32_16x16x32_bf16 v[36:39], a[40:43], v[96:99], v[36:39]
    v_max3_f32 v208, v208, v168, v169
    v_max3_f32 v209, v209, v170, v171
    v_mfma_f32_16x16x32_bf16 v[40:43], a[44:47], v[96:99], v[40:43]
    v_max3_f32 v210, v210, v172, v173
    v_max3_f32 v211, v211, v174, v175
    v_mfma_f32_16x16x32_bf16 v[36:39], a[48:51], v[104:107], v[36:39]
    v_max3_f32 v208, v208, v176, v177
    v_max3_f32 v209, v209, v178, v179
    v_mfma_f32_16x16x32_bf16 v[40:43], a[52:55], v[104:107], v[40:43]
    v_max3_f32 v210, v210, v180, v181
    v_max3_f32 v211, v211, v182, v183
    v_mfma_f32_16x16x32_bf16 v[36:39], a[56:59], v[112:115], v[36:39]
    v_max3_f32 v208, v208, v184, v185
    v_max3_f32 v209, v209, v186, v187
    v_mfma_f32_16x16x32_bf16 v[40:43], a[60:63], v[112:115], v[40:43]
    v_max3_f32 v210, v210, v188, v189
    v_max3_f32 v211, v211, v190, v191
    v_mfma_f32_16x16x32_bf16 v[36:39], a[64:67], v[120:123], v[36:39]
    v_max3_f32 v208, v208, v209, v210
    v_max_f32 v208, v208, v211
    v_mov_b32 v209, v208
    s_nop 0
    s_nop 0
    v_permlane16_swap_b32 v208, v209
    v_max_f32 v208, v208, v209
    v_mov_b32 v209, v208
    s_nop 0
    s_nop 0
    v_permlane32_swap_b32 v208, v209
    v_max_f32 v212, v208, v209
    v_pk_add_f32 v[124:125], v[124:125], v[212:213] op_sel_hi:[1,0] neg_lo:[0,1] neg_hi:[0,1]
    v_pk_add_f32 v[126:127], v[126:127], v[212:213] op_sel_hi:[1,0] neg_lo:[0,1] neg_hi:[0,1]
    v_mfma_f32_16x16x32_bf16 v[40:43], a[68:71], v[120:123], v[40:43]
    v_exp_f32 v124, v124
    v_exp_f32 v125, v125
    v_exp_f32 v126, v126
    v_exp_f32 v127, v127
    v_pk_add_f32 v[128:129], v[128:129], v[212:213] op_sel_hi:[1,0] neg_lo:[0,1] neg_hi:[0,1]
    v_pk_add_f32 v[130:131], v[130:131], v[212:213] op_sel_hi:[1,0] neg_lo:[0,1] neg_hi:[0,1]
    v_cvt_pk_bf16_f32 v127, v126, v127
    v_cvt_pk_bf16_f32 v126, v124, v125
    v_mov_b32 v124, 0
    v_mov_b32 v125, 0
    s_mov_b32 m0, s76
    s_add_u32 s62, s75, 0x13000
    v_exp_f32 v128, v128
    v_exp_f32 v129, v129
    v_exp_f32 v130, v130
    v_exp_f32 v131, v131
    v_pk_add_f32 v[132:133], v[132:133], v[212:213] op_sel_hi:[1,0] neg_lo:[0,1] neg_hi:[0,1]
    v_pk_add_f32 v[134:135], v[134:135], v[212:213] op_sel_hi:[1,0] neg_lo:[0,1] neg_hi:[0,1]
    v_cvt_pk_bf16_f32 v128, v128, v129
    v_cvt_pk_bf16_f32 v129, v130, v131
    buffer_load_dwordx4 v4, s[28:31], s62 offen sc1 lds
    v_exp_f32 v132, v132
    v_exp_f32 v133, v133
    v_exp_f32 v134, v134
    v_exp_f32 v135, v135
    v_pk_add_f32 v[136:137], v[136:137], v[212:213] op_sel_hi:[1,0] neg_lo:[0,1] neg_hi:[0,1]
    v_pk_add_f32 v[138:139], v[138:139], v[212:213] op_sel_hi:[1,0] neg_lo:[0,1] neg_hi:[0,1]
    v_cvt_pk_bf16_f32 v130, v132, v133
    v_cvt_pk_bf16_f32 v131, v134, v135
    s_mov_b32 m0, s76
    s_add_u32 s62, s75, 0x14000
    v_exp_f32 v136, v136
    v_exp_f32 v137, v137
    v_exp_f32 v138, v138
    v_exp_f32 v139, v139
    v_pk_add_f32 v[140:141], v[140:141], v[212:213] op_sel_hi:[1,0] neg_lo:[0,1] neg_hi:[0,1]
    v_pk_add_f32 v[142:143], v[142:143], v[212:213] op_sel_hi:[1,0] neg_lo:[0,1] neg_hi:[0,1]
    v_cvt_pk_bf16_f32 v136, v136, v137
    v_cvt_pk_bf16_f32 v137, v138, v139
    buffer_load_dwordx4 v4, s[28:31], s62 offen sc1 lds
    v_exp_f32 v140, v140
    v_exp_f32 v141, v141
    v_exp_f32 v142, v142
    v_exp_f32 v143, v143
    v_pk_add_f32 v[144:145], v[144:145], v[212:213] op_sel_hi:[1,0] neg_lo:[0,1] neg_hi:[0,1]
    v_pk_add_f32 v[146:147], v[146:147], v[212:213] op_sel_hi:[1,0] neg_lo:[0,1] neg_hi:[0,1]
    v_cvt_pk_bf16_f32 v138, v140, v141
    v_cvt_pk_bf16_f32 v139, v142, v143
    s_mul_i32 s100, s36, 12288
    s_add_u32 s101, s100, s91
    s_sub_u32 s101, s101, s93
    s_add_u32 s101, s101, 0x0
    s_add_u32 s100, s100, 0x8000
    s_add_u32 m0, s100, 0x0
    s_add_u32 s62, s101, 0x0
    v_exp_f32 v144, v144
    v_exp_f32 v145, v145
    v_exp_f32 v146, v146
    v_exp_f32 v147, v147
    v_pk_add_f32 v[148:149], v[148:149], v[212:213] op_sel_hi:[1,0] neg_lo:[0,1] neg_hi:[0,1]
    v_pk_add_f32 v[150:151], v[150:151], v[212:213] op_sel_hi:[1,0] neg_lo:[0,1] neg_hi:[0,1]
    v_cvt_pk_bf16_f32 v144, v144, v145
    v_cvt_pk_bf16_f32 v145, v146, v147
    buffer_load_dwordx4 v4, s[28:31], s62 offen offset:0 sc1 lds
    v_exp_f32 v148, v148
    v_exp_f32 v149, v149
    v_exp_f32 v150, v150
    v_exp_f32 v151, v151
    v_pk_add_f32 v[152:153], v[152:153], v[212:213] op_sel_hi:[1,0] neg_lo:[0,1] neg_hi:[0,1]
    v_pk_add_f32 v[154:155], v[154:155], v[212:213] op_sel_hi:[1,0] neg_lo:[0,1] neg_hi:[0,1]
    v_cvt_pk_bf16_f32 v146, v148, v149
    v_cvt_pk_bf16_f32 v147, v150, v151
    buffer_load_dwordx4 v4, s[28:31], s62 offen offset:1024 sc1 lds
    v_exp_f32 v152, v152
    v_exp_f32 v153, v153
    v_exp_f32 v154, v154
    v_exp_f32 v155, v155
    v_pk_add_f32 v[156:157], v[156:157], v[212:213] op_sel_hi:[1,0] neg_lo:[0,1] neg_hi:[0,1]
    v_pk_add_f32 v[158:159], v[158:159], v[212:213] op_sel_hi:[1,0] neg_lo:[0,1] neg_hi:[0,1]
    v_cvt_pk_bf16_f32 v152, v152, v153
    v_cvt_pk_bf16_f32 v153, v154, v155
    v_exp_f32 v156, v156
    v_exp_f32 v157, v157
    v_exp_f32 v158, v158
    v_exp_f32 v159, v159
    v_pk_add_f32 v[160:161], v[160:161], v[212:213] op_sel_hi:[1,0] neg_lo:[0,1] neg_hi:[0,1]
    v_pk_add_f32 v[162:163], v[162:163], v[212:213] op_sel_hi:[1,0] neg_lo:[0,1] neg_hi:[0,1]
    v_cvt_pk_bf16_f32 v154, v156, v157
    v_cvt_pk_bf16_f32 v155, v158, v159
    buffer_load_dwordx4 v4, s[28:31], s62 offen offset:2048 sc1 lds
    v_exp_f32 v160, v160
    v_exp_f32 v161, v161
    v_exp_f32 v162, v162
    v_exp_f32 v163, v163
    v_pk_add_f32 v[164:165], v[164:165], v[212:213] op_sel_hi:[1,0] neg_lo:[0,1] neg_hi:[0,1]
    v_pk_add_f32 v[166:167], v[166:167], v[212:213] op_sel_hi:[1,0] neg_lo:[0,1] neg_hi:[0,1]
    v_cvt_pk_bf16_f32 v160, v160, v161
    v_cvt_pk_bf16_f32 v161, v162, v163
    v_exp_f32 v164, v164
    v_exp_f32 v165, v165
    v_exp_f32 v166, v166
    v_exp_f32 v167, v167
    v_pk_add_f32 v[168:169], v[168:169], v[212:213] op_sel_hi:[1,0] neg_lo:[0,1] neg_hi:[0,1]
    v_pk_add_f32 v[170:171], v[170:171], v[212:213] op_sel_hi:[1,0] neg_lo:[0,1] neg_hi:[0,1]
    v_cvt_pk_bf16_f32 v162, v164, v165
    v_cvt_pk_bf16_f32 v163, v166, v167
    buffer_load_dwordx4 v4, s[28:31], s62 offen offset:3072 sc1 lds
    s_add_u32 m0, s100, 0x1000
    s_add_u32 s62, s101, 0x1000
    v_exp_f32 v168, v168
    v_exp_f32 v169, v169
    v_exp_f32 v170, v170
    v_exp_f32 v171, v171
    v_pk_add_f32 v[172:173], v[172:173], v[212:213] op_sel_hi:[1,0] neg_lo:[0,1] neg_hi:[0,1]
    v_pk_add_f32 v[174:175], v[174:175], v[212:213] op_sel_hi:[1,0] neg_lo:[0,1] neg_hi:[0,1]
    v_cvt_pk_bf16_f32 v168, v168, v169
    v_cvt_pk_bf16_f32 v169, v170, v171
    buffer_load_dwordx4 v4, s[28:31], s62 offen offset:0 sc1 lds
    v_exp_f32 v172, v172
    v_exp_f32 v173, v173
    v_exp_f32 v174, v174
    v_exp_f32 v175, v175
    v_pk_add_f32 v[176:177], v[176:177], v[212:213] op_sel_hi:[1,0] neg_lo:[0,1] neg_hi:[0,1]
    v_pk_add_f32 v[178:179], v[178:179], v[212:213] op_sel_hi:[1,0] neg_lo:[0,1] neg_hi:[0,1]
    v_cvt_pk_bf16_f32 v170, v172, v173
    v_cvt_pk_bf16_f32 v171, v174, v175
    v_exp_f32 v176, v176
    v_exp_f32 v177, v177
    v_exp_f32 v178, v178
    v_exp_f32 v179, v179
    v_pk_add_f32 v[180:181], v[180:181], v[212:213] op_sel_hi:[1,0] neg_lo:[0,1] neg_hi:[0,1]
    v_pk_add_f32 v[182:183], v[182:183], v[212:213] op_sel_hi:[1,0] neg_lo:[0,1] neg_hi:[0,1]
    v_cvt_pk_bf16_f32 v176, v176, v177
    v_cvt_pk_bf16_f32 v177, v178, v179
    buffer_load_dwordx4 v4, s[28:31], s62 offen offset:1024 sc1 lds
    v_exp_f32 v180, v180
    v_exp_f32 v181, v181
    v_exp_f32 v182, v182
    v_exp_f32 v183, v183
    v_pk_add_f32 v[184:185], v[184:185], v[212:213] op_sel_hi:[1,0] neg_lo:[0,1] neg_hi:[0,1]
    v_pk_add_f32 v[186:187], v[186:187], v[212:213] op_sel_hi:[1,0] neg_lo:[0,1] neg_hi:[0,1]
    v_cvt_pk_bf16_f32 v178, v180, v181
    v_cvt_pk_bf16_f32 v179, v182, v183
    v_exp_f32 v184, v184
    v_exp_f32 v185, v185
    v_exp_f32 v186, v186
    v_exp_f32 v187, v187
    v_pk_add_f32 v[188:189], v[188:189], v[212:213] op_sel_hi:[1,0] neg_lo:[0,1] neg_hi:[0,1]
    v_pk_add_f32 v[190:191], v[190:191], v[212:213] op_sel_hi:[1,0] neg_lo:[0,1] neg_hi:[0,1]
    v_cvt_pk_bf16_f32 v184, v184, v185
    v_cvt_pk_bf16_f32 v185, v186, v187
    buffer_load_dwordx4 v4, s[28:31], s62 offen offset:2048 sc1 lds
    v_exp_f32 v188, v188
    v_exp_f32 v189, v189
    v_exp_f32 v190, v190
    v_exp_f32 v191, v191
    v_cvt_pk_bf16_f32 v186, v188, v189
    v_cvt_pk_bf16_f32 v187, v190, v191
    buffer_load_dwordx4 v4, s[28:31], s62 offen offset:3072 sc1 lds
    v_mov_b32 v214, v40
    v_mov_b32 v215, v40
    s_nop 1
    v_permlane16_swap_b32 v214, v215
    v_rcp_f32 v216, v215
    s_nop 0
    v_pk_mul_f32 v[36:37], v[36:37], v[216:217] op_sel_hi:[1,0]
    v_pk_mul_f32 v[40:41], v[40:41], v[216:217] op_sel_hi:[1,0]
    v_pk_mul_f32 v[38:39], v[38:39], v[216:217] op_sel_hi:[1,0]
    v_pk_mul_f32 v[42:43], v[42:43], v[216:217] op_sel_hi:[1,0]
    v_cvt_pk_bf16_f32 v36, v36, v37
    v_cvt_pk_bf16_f32 v37, v38, v39
    v_cvt_pk_bf16_f32 v40, v40, v41
    v_cvt_pk_bf16_f32 v41, v42, v43
    ds_write_b64 v54, v[36:37] offset:40
    s_mov_b64 exec, 0xffff
    ds_write_b64 v54, v[40:41] offset:72
    s_mov_b64 exec, -1
    v_mfma_f32_16x16x32_bf16 v[44:47], a[0:3], v[124:127], 0
    v_mfma_f32_16x16x32_bf16 v[48:51], a[4:7], v[124:127], 0
    v_mfma_f32_16x16x32_bf16 v[44:47], a[8:11], v[128:131], v[44:47]
    v_mfma_f32_16x16x32_bf16 v[48:51], a[12:15], v[128:131], v[48:51]
    v_mfma_f32_16x16x32_bf16 v[44:47], a[16:19], v[136:139], v[44:47]
    v_mfma_f32_16x16x32_bf16 v[48:51], a[20:23], v[136:139], v[48:51]
    v_mfma_f32_16x16x32_bf16 v[44:47], a[24:27], v[144:147], v[44:47]
    v_mfma_f32_16x16x32_bf16 v[48:51], a[28:31], v[144:147], v[48:51]
    v_mfma_f32_16x16x32_bf16 v[44:47], a[32:35], v[152:155], v[44:47]
    v_mfma_f32_16x16x32_bf16 v[48:51], a[36:39], v[152:155], v[48:51]
    v_mfma_f32_16x16x32_bf16 v[44:47], a[40:43], v[160:163], v[44:47]
    v_mfma_f32_16x16x32_bf16 v[48:51], a[44:47], v[160:163], v[48:51]
    v_mfma_f32_16x16x32_bf16 v[44:47], a[48:51], v[168:171], v[44:47]
    v_mfma_f32_16x16x32_bf16 v[48:51], a[52:55], v[168:171], v[48:51]
    v_mfma_f32_16x16x32_bf16 v[44:47], a[56:59], v[176:179], v[44:47]
    v_mfma_f32_16x16x32_bf16 v[48:51], a[60:63], v[176:179], v[48:51]
    v_mfma_f32_16x16x32_bf16 v[44:47], a[64:67], v[184:187], v[44:47]
    v_mfma_f32_16x16x32_bf16 v[48:51], a[68:71], v[184:187], v[48:51]
    s_nop 7
    v_mov_b32 v214, v48
    v_mov_b32 v215, v48
    s_nop 1
    v_permlane16_swap_b32 v214, v215
    v_rcp_f32 v216, v215
    s_nop 0
    v_pk_mul_f32 v[44:45], v[44:45], v[216:217] op_sel_hi:[1,0]
    v_pk_mul_f32 v[48:49], v[48:49], v[216:217] op_sel_hi:[1,0]
    v_pk_mul_f32 v[46:47], v[46:47], v[216:217] op_sel_hi:[1,0]
    v_pk_mul_f32 v[50:51], v[50:51], v[216:217] op_sel_hi:[1,0]
    v_cvt_pk_bf16_f32 v44, v44, v45
    v_cvt_pk_bf16_f32 v45, v46, v47
    v_cvt_pk_bf16_f32 v48, v48, v49
    v_cvt_pk_bf16_f32 v49, v50, v51
    ds_write_b64 v54, v[44:45] offset:1320
    s_mov_b64 exec, 0xffff
    ds_write_b64 v54, v[48:49] offset:1352
    s_mov_b64 exec, -1
    s_waitcnt lgkmcnt(0)
    ds_read_b128 v[56:59], v236
    ds_read_b128 v[60:63], v236 offset:1280
    ds_read_b128 v[64:67], v237 offset:64
    s_waitcnt lgkmcnt(0)
    buffer_store_dwordx4 v[56:59], v238, s[28:31], s78 offen sc1
    buffer_store_dwordx4 v[60:63], v238, s[28:31], s79 offen sc1
    s_mov_b64 exec, 0xffffffff
    buffer_store_dwordx4 v[64:67], v239, s[28:31], s78 offen sc1
    s_mov_b64 exec, -1
    v_mov_b32 v216, v4
    v_add_u32 v217, 0x10000, v4
    v_add_u32 v218, 0x20000, v4
    v_mov_b32 v32, 0
    v_mov_b32 v33, 0
    v_mov_b32 v34, 0
    v_mov_b32 v35, 0
    v_mov_b32 v36, 0
    v_mov_b32 v37, 0
    v_mov_b32 v38, 0
    v_mov_b32 v39, 0
    v_mov_b32 v40, 0
    v_mov_b32 v41, 0
    v_mov_b32 v42, 0
    v_mov_b32 v43, 0
    v_mov_b32 v44, 0
    v_mov_b32 v45, 0
    v_mov_b32 v46, 0
    v_mov_b32 v47, 0
    v_mov_b32 v48, 0
    v_mov_b32 v49, 0
    v_mov_b32 v50, 0
    v_mov_b32 v51, 0
    s_lshl_b32 s54, s86, 4
    v_add_u32 v200, s54, v2
    v_mul_u32_u24 v200, 1280, v200
    s_mul_i32 s54, s87, 160
    v_lshl_add_u32 v201, v3, 4, v200
    v_add_u32 v20, s54, v201
    v_lshl_add_u32 v201, v3, 3, v200
    v_add_u32 v21, s54, v201
    s_mul_i32 s66, s86, 20480
    s_add_u32 s66, s66, 0xc00000
    s_mul_i32 s55, s87, 10
    v_add_u32 v200, s55, v3
    v_lshrrev_b32 v202, 2, v200
    v_lshlrev_b32 v202, 10, v202
    v_and_b32 v203, 3, v200
    v_lshl_add_u32 v202, v203, 8, v202
    v_lshl_add_u32 v22, v2, 4, v202
    v_add_u32 v200, s55, v3
    v_add_u32 v200, 4, v200
    v_lshrrev_b32 v202, 2, v200
    v_lshlrev_b32 v202, 10, v202
    v_and_b32 v203, 3, v200
    v_lshl_add_u32 v202, v203, 8, v202
    v_lshl_add_u32 v23, v2, 4, v202
    v_lshrrev_b32 v200, 1, v3
    v_add_u32 v200, s55, v200
    v_add_u32 v200, 8, v200
    v_lshrrev_b32 v202, 2, v200
    v_lshlrev_b32 v202, 10, v202
    v_and_b32 v203, 3, v200
    v_lshl_add_u32 v202, v203, 8, v202
    v_lshl_add_u32 v24, v2, 4, v202
    v_and_b32 v200, 1, v3
    v_lshl_add_u32 v24, v200, 3, v24
    s_lshl_b32 s54, s86, 4
    v_add_u32 v200, s54, v2
    v_lshlrev_b32 v18, 6, v200
    s_lshl_b32 s67, s87, 3
    s_add_u32 s67, s67, 0x40000
    s_waitcnt lgkmcnt(0)
    s_barrier
    s_add_u32 m0, s100, 0x2000
    s_add_u32 s62, s101, 0x2000
    buffer_load_dwordx4 v4, s[28:31], s62 offen offset:0 sc1 lds
    buffer_load_dwordx4 v4, s[28:31], s62 offen offset:1024 sc1 lds
    buffer_load_dwordx4 v4, s[28:31], s62 offen offset:2048 sc1 lds
    buffer_load_dwordx4 v4, s[28:31], s62 offen offset:3072 sc1 lds
    s_waitcnt vmcnt(4)
    s_barrier
    s_cmp_eq_u32 s36, 0
    s_cbranch_scc1 H2_20
    s_branch H3_21
H2_20:
    s_lshl_b32 s52, s39, 4
    s_add_u32 s52, s52, s40
    s_lshl_b32 s44, s52, 6
    s_add_u32 s44, s44, 0x4000
    v_mov_b32 v212, s42
    v_mov_b32 v213, s43
    v_mov_b32 v214, s44
    s_mov_b64 exec, 1
    s_cmp_lg_u32 s99, 0
    s_cbranch_scc1 DF_23
    buffer_store_dwordx2 v[212:213], v214, s[28:31], 0 offen sc1
    s_branch DJ_24
DF_23:
    buffer_store_dwordx2 v[212:213], v214, s[28:31], 0 offen
DJ_24:
    s_mov_b64 exec, -1
FS_22:
    s_lshl_b32 s52, s39, 10
    s_add_u32 s52, s52, 0x4000
    v_lshlrev_b32 v212, 6, v2
    v_add_u32 v212, s52, v212
    s_mov_b32 s44, 0
PL_25:
    buffer_load_dwordx2 v[214:215], v212, s[28:31], 0 offen offset:0 sc1
    s_waitcnt vmcnt(0)
    v_cmp_eq_u32 s[46:47], s42, v214
    v_cmp_eq_u32 s[48:49], s43, v215
    s_nop 1
    s_and_b64 s[46:47], s[46:47], s[48:49]
    s_mov_b64 s[50:51], s[46:47]
    s_cmp_eq_u64 s[50:51], -1
    s_cbranch_scc1 PD_26
    s_add_u32 s44, s44, 1
    s_cmp_gt_u32 s44, 20000
    s_cbranch_scc0 PL_25
    s_mov_b32 s63, 1
PD_26:
H3_21:
    s_waitcnt vmcnt(0)
    s_barrier
    s_mul_i32 s54, s86, 20480
    s_add_u32 s54, s54, 0x900000
    buffer_load_dwordx4 a[0:3], v4, s[28:31], s54 offen offset:0 sc1
    buffer_load_dwordx4 a[4:7], v4, s[28:31], s54 offen offset:1024 sc1
    buffer_load_dwordx4 a[8:11], v4, s[28:31], s54 offen offset:2048 sc1
    buffer_load_dwordx4 a[12:15], v4, s[28:31], s54 offen offset:3072 sc1
    s_add_u32 s54, s54, 4096
    buffer_load_dwordx4 a[16:19], v4, s[28:31], s54 offen offset:0 sc1
    buffer_load_dwordx4 a[20:23], v4, s[28:31], s54 offen offset:1024 sc1
    buffer_load_dwordx4 a[24:27], v4, s[28:31], s54 offen offset:2048 sc1
    buffer_load_dwordx4 a[28:31], v4, s[28:31], s54 offen offset:3072 sc1
    s_add_u32 s54, s54, 4096
    buffer_load_dwordx4 a[32:35], v4, s[28:31], s54 offen offset:0 sc1
    buffer_load_dwordx4 a[36:39], v4, s[28:31], s54 offen offset:1024 sc1
    ds_read_b128 a[80:83], v217 offset:16384
    ds_read_b128 a[84:87], v217 offset:17408
    ds_read_b128 a[88:91], v217 offset:18432
    ds_read_b128 a[92:95], v217 offset:19456
    ds_read_b128 a[96:99], v217 offset:20480
    ds_read_b128 a[100:103], v217 offset:21504
    ds_read_b128 a[104:107], v217 offset:22528
    ds_read_b128 a[108:111], v217 offset:23552
    ds_read_b128 a[112:115], v217 offset:24576
    ds_read_b128 a[116:119], v217 offset:25600
    s_waitcnt vmcnt(9) lgkmcnt(5)
    v_mfma_f32_16x16x32_bf16 v[32:35], a[80:83], a[0:3], v[32:35]
    ds_read_b128 a[120:123], v217 offset:26624
    buffer_load_dwordx4 a[40:43], v4, s[28:31], s54 offen offset:2048 sc1
    v_mfma_f32_16x16x32_bf16 v[36:39], a[84:87], a[0:3], v[36:39]
    ds_read_b128 a[124:127], v217 offset:27648
    v_mfma_f32_16x16x32_bf16 v[40:43], a[88:91], a[0:3], v[40:43]
    ds_read_b128 a[128:131], v217 offset:28672
    v_mfma_f32_16x16x32_bf16 v[44:47], a[92:95], a[0:3], v[44:47]
    ds_read_b128 a[132:135], v217 offset:29696
    v_mfma_f32_16x16x32_bf16 v[48:51], a[96:99], a[0:3], v[48:51]
    ds_read_b128 a[136:139], v217 offset:30720
    s_waitcnt vmcnt(9) lgkmcnt(5)
    v_mfma_f32_16x16x32_bf16 v[32:35], a[100:103], a[4:7], v[32:35]
    ds_read_b128 a[80:83], v217 offset:31744
    buffer_load_dwordx4 a[44:47], v4, s[28:31], s54 offen offset:3072 sc1
    v_mfma_f32_16x16x32_bf16 v[36:39], a[104:107], a[4:7], v[36:39]
    ds_read_b128 a[84:87], v217 offset:32768
    v_mfma_f32_16x16x32_bf16 v[40:43], a[108:111], a[4:7], v[40:43]
    ds_read_b128 a[88:91], v217 offset:33792
    v_mfma_f32_16x16x32_bf16 v[44:47], a[112:115], a[4:7], v[44:47]
    ds_read_b128 a[92:95], v217 offset:34816
    v_mfma_f32_16x16x32_bf16 v[48:51], a[116:119], a[4:7], v[48:51]
    ds_read_b128 a[96:99], v217 offset:35840
    s_waitcnt vmcnt(9) lgkmcnt(5)
    s_add_u32 s54, s54, 4096
    v_mfma_f32_16x16x32_bf16 v[32:35], a[120:123], a[8:11], v[32:35]
    ds_read_b128 a[100:103], v217 offset:36864
    buffer_load_dwordx4 a[48:51], v4, s[28:31], s54 offen offset:0 sc1
    v_mfma_f32_16x16x32_bf16 v[36:39], a[124:127], a[8:11], v[36:39]
    ds_read_b128 a[104:107], v217 offset:37888
    v_mfma_f32_16x16x32_bf16 v[40:43], a[128:131], a[8:11], v[40:43]
    ds_read_b128 a[108:111], v217 offset:38912
    v_mfma_f32_16x16x32_bf16 v[44:47], a[132:135], a[8:11], v[44:47]
    ds_read_b128 a[112:115], v217 offset:39936
    v_mfma_f32_16x16x32_bf16 v[48:51], a[136:139], a[8:11], v[48:51]
    ds_read_b128 a[116:119], v217 offset:40960
    s_waitcnt vmcnt(9) lgkmcnt(5)
    v_mfma_f32_16x16x32_bf16 v[32:35], a[80:83], a[12:15], v[32:35]
    ds_read_b128 a[120:123], v217 offset:41984
    buffer_load_dwordx4 a[52:55], v4, s[28:31], s54 offen offset:1024 sc1
    v_mfma_f32_16x16x32_bf16 v[36:39], a[84:87], a[12:15], v[36:39]
    ds_read_b128 a[124:127], v217 offset:43008
    v_mfma_f32_16x16x32_bf16 v[40:43], a[88:91], a[12:15], v[40:43]
    ds_read_b128 a[128:131], v217 offset:44032
    v_mfma_f32_16x16x32_bf16 v[44:47], a[92:95], a[12:15], v[44:47]
    ds_read_b128 a[132:135], v217 offset:45056
    v_mfma_f32_16x16x32_bf16 v[48:51], a[96:99], a[12:15], v[48:51]
    ds_read_b128 a[136:139], v217 offset:46080
    s_waitcnt vmcnt(9) lgkmcnt(5)
    v_mfma_f32_16x16x32_bf16 v[32:35], a[100:103], a[16:19], v[32:35]
    ds_read_b128 a[80:83], v217 offset:47104
    buffer_load_dwordx4 a[56:59], v4, s[28:31], s54 offen offset:2048 sc1
    v_mfma_f32_16x16x32_bf16 v[36:39], a[104:107], a[16:19], v[36:39]
    ds_read_b128 a[84:87], v217 offset:48128
    v_mfma_f32_16x16x32_bf16 v[40:43], a[108:111], a[16:19], v[40:43]
    ds_read_b128 a[88:91], v217 offset:49152
    v_mfma_f32_16x16x32_bf16 v[44:47], a[112:115], a[16:19], v[44:47]
    ds_read_b128 a[92:95], v217 offset:50176
    v_mfma_f32_16x16x32_bf16 v[48:51], a[116:119], a[16:19], v[48:51]
    ds_read_b128 a[96:99], v217 offset:51200
    s_waitcnt vmcnt(9) lgkmcnt(5)
    v_mfma_f32_16x16x32_bf16 v[32:35], a[120:123], a[20:23], v[32:35]
    ds_read_b128 a[100:103], v217 offset:52224
    buffer_load_dwordx4 a[60:63], v4, s[28:31], s54 offen offset:3072 sc1
    v_mfma_f32_16x16x32_bf16 v[36:39], a[124:127], a[20:23], v[36:39]
    ds_read_b128 a[104:107], v217 offset:53248
    v_mfma_f32_16x16x32_bf16 v[40:43], a[128:131], a[20:23], v[40:43]
    ds_read_b128 a[108:111], v217 offset:54272
    v_mfma_f32_16x16x32_bf16 v[44:47], a[132:135], a[20:23], v[44:47]
    ds_read_b128 a[112:115], v217 offset:55296
    v_mfma_f32_16x16x32_bf16 v[48:51], a[136:139], a[20:23], v[48:51]
    ds_read_b128 a[116:119], v217 offset:56320
    s_waitcnt vmcnt(9) lgkmcnt(5)
    s_add_u32 s54, s54, 4096
    v_mfma_f32_16x16x32_bf16 v[32:35], a[80:83], a[24:27], v[32:35]
    ds_read_b128 a[120:123], v217 offset:57344
    buffer_load_dwordx4 a[64:67], v4, s[28:31], s54 offen offset:0 sc1
    v_mfma_f32_16x16x32_bf16 v[36:39], a[84:87], a[24:27], v[36:39]
    ds_read_b128 a[124:127], v217 offset:58368
    v_mfma_f32_16x16x32_bf16 v[40:43], a[88:91], a[24:27], v[40:43]
    ds_read_b128 a[128:131], v217 offset:59392
    v_mfma_f32_16x16x32_bf16 v[44:47], a[92:95], a[24:27], v[44:47]
    ds_read_b128 a[132:135], v217 offset:60416
    v_mfma_f32_16x16x32_bf16 v[48:51], a[96:99], a[24:27], v[48:51]
    ds_read_b128 a[136:139], v217 offset:61440
    s_waitcnt vmcnt(9) lgkmcnt(5)
    v_mfma_f32_16x16x32_bf16 v[32:35], a[100:103], a[28:31], v[32:35]
    ds_read_b128 a[80:83], v217 offset:62464
    buffer_load_dwordx4 a[68:71], v4, s[28:31], s54 offen offset:1024 sc1
    v_mfma_f32_16x16x32_bf16 v[36:39], a[104:107], a[28:31], v[36:39]
    ds_read_b128 a[84:87], v217 offset:63488
    v_mfma_f32_16x16x32_bf16 v[40:43], a[108:111], a[28:31], v[40:43]
    ds_read_b128 a[88:91], v217 offset:64512
    v_mfma_f32_16x16x32_bf16 v[44:47], a[112:115], a[28:31], v[44:47]
    ds_read_b128 a[92:95], v218 offset:0
    v_mfma_f32_16x16x32_bf16 v[48:51], a[116:119], a[28:31], v[48:51]
    ds_read_b128 a[96:99], v218 offset:1024
    s_waitcnt vmcnt(9) lgkmcnt(5)
    v_mfma_f32_16x16x32_bf16 v[32:35], a[120:123], a[32:35], v[32:35]
    ds_read_b128 a[100:103], v218 offset:2048
    buffer_load_dwordx4 a[72:75], v4, s[28:31], s54 offen offset:2048 sc1
    v_mfma_f32_16x16x32_bf16 v[36:39], a[124:127], a[32:35], v[36:39]
    ds_read_b128 a[104:107], v218 offset:3072
    v_mfma_f32_16x16x32_bf16 v[40:43], a[128:131], a[32:35], v[40:43]
    ds_read_b128 a[108:111], v218 offset:4096
    v_mfma_f32_16x16x32_bf16 v[44:47], a[132:135], a[32:35], v[44:47]
    ds_read_b128 a[112:115], v218 offset:5120
    v_mfma_f32_16x16x32_bf16 v[48:51], a[136:139], a[32:35], v[48:51]
    ds_read_b128 a[116:119], v218 offset:6144
    s_waitcnt vmcnt(9) lgkmcnt(5)
    v_mfma_f32_16x16x32_bf16 v[32:35], a[80:83], a[36:39], v[32:35]
    ds_read_b128 a[120:123], v218 offset:7168
    buffer_load_dwordx4 a[76:79], v4, s[28:31], s54 offen offset:3072 sc1
    v_mfma_f32_16x16x32_bf16 v[36:39], a[84:87], a[36:39], v[36:39]
    ds_read_b128 a[124:127], v218 offset:8192
    v_mfma_f32_16x16x32_bf16 v[40:43], a[88:91], a[36:39], v[40:43]
    ds_read_b128 a[128:131], v218 offset:9216
    v_mfma_f32_16x16x32_bf16 v[44:47], a[92:95], a[36:39], v[44:47]
    ds_read_b128 a[132:135], v218 offset:10240
    v_mfma_f32_16x16x32_bf16 v[48:51], a[96:99], a[36:39], v[48:51]
    ds_read_b128 a[136:139], v218 offset:11264
    s_waitcnt vmcnt(9) lgkmcnt(5)
    v_mfma_f32_16x16x32_bf16 v[32:35], a[100:103], a[40:43], v[32:35]
    ds_read_b128 a[80:83], v218 offset:12288
    v_mfma_f32_16x16x32_bf16 v[36:39], a[104:107], a[40:43], v[36:39]
    ds_read_b128 a[84:87], v218 offset:13312
    v_mfma_f32_16x16x32_bf16 v[40:43], a[108:111], a[40:43], v[40:43]
    ds_read_b128 a[88:91], v218 offset:14336
    v_mfma_f32_16x16x32_bf16 v[44:47], a[112:115], a[40:43], v[44:47]
    ds_read_b128 a[92:95], v218 offset:15360
    v_mfma_f32_16x16x32_bf16 v[48:51], a[116:119], a[40:43], v[48:51]
    ds_read_b128 a[96:99], v218 offset:16384
    s_waitcnt vmcnt(8) lgkmcnt(5)
    v_mfma_f32_16x16x32_bf16 v[32:35], a[120:123], a[44:47], v[32:35]
    ds_read_b128 a[100:103], v218 offset:17408
    v_mfma_f32_16x16x32_bf16 v[36:39], a[124:127], a[44:47], v[36:39]
    ds_read_b128 a[104:107], v218 offset:18432
    v_mfma_f32_16x16x32_bf16 v[40:43], a[128:131], a[44:47], v[40:43]
    ds_read_b128 a[108:111], v218 offset:19456
    v_mfma_f32_16x16x32_bf16 v[44:47], a[132:135], a[44:47], v[44:47]
    ds_read_b128 a[112:115], v216 offset:0
    v_mfma_f32_16x16x32_bf16 v[48:51], a[136:139], a[44:47], v[48:51]
    ds_read_b128 a[116:119], v216 offset:1024
    s_waitcnt vmcnt(7) lgkmcnt(5)
    v_mfma_f32_16x16x32_bf16 v[32:35], a[80:83], a[48:51], v[32:35]
    ds_read_b128 a[120:123], v216 offset:2048
    buffer_load_dwordx4 v[8:11], v20, s[4:7], 0 offen
    v_mfma_f32_16x16x32_bf16 v[36:39], a[84:87], a[48:51], v[36:39]
    ds_read_b128 a[124:127], v216 offset:3072
    v_mfma_f32_16x16x32_bf16 v[40:43], a[88:91], a[48:51], v[40:43]
    ds_read_b128 a[128:131], v216 offset:4096
    v_mfma_f32_16x16x32_bf16 v[44:47], a[92:95], a[48:51], v[44:47]
    ds_read_b128 a[132:135], v216 offset:5120
    v_mfma_f32_16x16x32_bf16 v[48:51], a[96:99], a[48:51], v[48:51]
    ds_read_b128 a[136:139], v216 offset:6144
    s_waitcnt vmcnt(7) lgkmcnt(5)
    v_mfma_f32_16x16x32_bf16 v[32:35], a[100:103], a[52:55], v[32:35]
    ds_read_b128 a[80:83], v216 offset:7168
    buffer_load_dwordx4 v[12:15], v20, s[4:7], 0 offen offset:64
    v_mfma_f32_16x16x32_bf16 v[36:39], a[104:107], a[52:55], v[36:39]
    ds_read_b128 a[84:87], v216 offset:8192
    v_mfma_f32_16x16x32_bf16 v[40:43], a[108:111], a[52:55], v[40:43]
    ds_read_b128 a[88:91], v216 offset:9216
    v_mfma_f32_16x16x32_bf16 v[44:47], a[112:115], a[52:55], v[44:47]
    ds_read_b128 a[92:95], v216 offset:10240
    v_mfma_f32_16x16x32_bf16 v[48:51], a[116:119], a[52:55], v[48:51]
    ds_read_b128 a[96:99], v216 offset:11264
    s_waitcnt vmcnt(7) lgkmcnt(5)
    v_mfma_f32_16x16x32_bf16 v[32:35], a[120:123], a[56:59], v[32:35]
    ds_read_b128 a[100:103], v216 offset:12288
    buffer_load_dwordx2 v[16:17], v21, s[4:7], 0 offen offset:128
    v_mfma_f32_16x16x32_bf16 v[36:39], a[124:127], a[56:59], v[36:39]
    ds_read_b128 a[104:107], v216 offset:13312
    v_mfma_f32_16x16x32_bf16 v[40:43], a[128:131], a[56:59], v[40:43]
    ds_read_b128 a[108:111], v216 offset:14336
    v_mfma_f32_16x16x32_bf16 v[44:47], a[132:135], a[56:59], v[44:47]
    ds_read_b128 a[112:115], v216 offset:15360
    v_mfma_f32_16x16x32_bf16 v[48:51], a[136:139], a[56:59], v[48:51]
    ds_read_b128 a[116:119], v216 offset:16384
    s_waitcnt vmcnt(7) lgkmcnt(5)
    v_mfma_f32_16x16x32_bf16 v[32:35], a[80:83], a[60:63], v[32:35]
    ds_read_b128 a[120:123], v216 offset:17408
    v_mfma_f32_16x16x32_bf16 v[36:39], a[84:87], a[60:63], v[36:39]
    ds_read_b128 a[124:127], v216 offset:18432
    v_mfma_f32_16x16x32_bf16 v[40:43], a[88:91], a[60:63], v[40:43]
    ds_read_b128 a[128:131], v216 offset:19456
    v_mfma_f32_16x16x32_bf16 v[44:47], a[92:95], a[60:63], v[44:47]
    ds_read_b128 a[132:135], v216 offset:20480
    v_mfma_f32_16x16x32_bf16 v[48:51], a[96:99], a[60:63], v[48:51]
    ds_read_b128 a[136:139], v216 offset:21504
    s_waitcnt vmcnt(6) lgkmcnt(5)
    v_mfma_f32_16x16x32_bf16 v[32:35], a[100:103], a[64:67], v[32:35]
    ds_read_b128 a[80:83], v216 offset:22528
    v_mfma_f32_16x16x32_bf16 v[36:39], a[104:107], a[64:67], v[36:39]
    ds_read_b128 a[84:87], v216 offset:23552
    v_mfma_f32_16x16x32_bf16 v[40:43], a[108:111], a[64:67], v[40:43]
    ds_read_b128 a[88:91], v216 offset:24576
    v_mfma_f32_16x16x32_bf16 v[44:47], a[112:115], a[64:67], v[44:47]
    ds_read_b128 a[92:95], v216 offset:25600
    v_mfma_f32_16x16x32_bf16 v[48:51], a[116:119], a[64:67], v[48:51]
    ds_read_b128 a[96:99], v216 offset:26624
    s_waitcnt vmcnt(5) lgkmcnt(5)
    v_mfma_f32_16x16x32_bf16 v[32:35], a[120:123], a[68:71], v[32:35]
    ds_read_b128 a[100:103], v216 offset:27648
    v_mfma_f32_16x16x32_bf16 v[36:39], a[124:127], a[68:71], v[36:39]
    ds_read_b128 a[104:107], v216 offset:28672
    v_mfma_f32_16x16x32_bf16 v[40:43], a[128:131], a[68:71], v[40:43]
    ds_read_b128 a[108:111], v216 offset:29696
    v_mfma_f32_16x16x32_bf16 v[44:47], a[132:135], a[68:71], v[44:47]
    ds_read_b128 a[112:115], v216 offset:30720
    v_mfma_f32_16x16x32_bf16 v[48:51], a[136:139], a[68:71], v[48:51]
    ds_read_b128 a[116:119], v216 offset:31744
    s_waitcnt vmcnt(4) lgkmcnt(5)
    v_mfma_f32_16x16x32_bf16 v[32:35], a[80:83], a[72:75], v[32:35]
    v_mfma_f32_16x16x32_bf16 v[36:39], a[84:87], a[72:75], v[36:39]
    v_mfma_f32_16x16x32_bf16 v[40:43], a[88:91], a[72:75], v[40:43]
    v_mfma_f32_16x16x32_bf16 v[44:47], a[92:95], a[72:75], v[44:47]
    v_mfma_f32_16x16x32_bf16 v[48:51], a[96:99], a[72:75], v[48:51]
    s_waitcnt vmcnt(3) lgkmcnt(0)
    v_mfma_f32_16x16x32_bf16 v[32:35], a[100:103], a[76:79], v[32:35]
    v_mfma_f32_16x16x32_bf16 v[36:39], a[104:107], a[76:79], v[36:39]
    v_mfma_f32_16x16x32_bf16 v[40:43], a[108:111], a[76:79], v[40:43]
    v_mfma_f32_16x16x32_bf16 v[44:47], a[112:115], a[76:79], v[44:47]
    v_mfma_f32_16x16x32_bf16 v[48:51], a[116:119], a[76:79], v[48:51]
    v_mov_b32 v204, 0
    v_mov_b32 v205, 0
    v_mov_b32 v206, 0
    v_mov_b32 v207, 0
    s_waitcnt vmcnt(0)
    v_lshlrev_b32 v200, 16, v8
    v_and_b32 v201, 0xffff0000, v8
    v_pk_add_f32 v[32:33], v[32:33], v[200:201]
    v_cvt_pk_bf16_f32 v240, v32, v33
    v_lshlrev_b32 v200, 16, v9
    v_and_b32 v201, 0xffff0000, v9
    v_pk_add_f32 v[34:35], v[34:35], v[200:201]
    v_cvt_pk_bf16_f32 v241, v34, v35
    v_lshlrev_b32 v200, 16, v10
    v_and_b32 v201, 0xffff0000, v10
    v_pk_add_f32 v[36:37], v[36:37], v[200:201]
    v_cvt_pk_bf16_f32 v242, v36, v37
    v_lshlrev_b32 v200, 16, v11
    v_and_b32 v201, 0xffff0000, v11
    v_pk_add_f32 v[38:39], v[38:39], v[200:201]
    v_cvt_pk_bf16_f32 v243, v38, v39
    buffer_store_dwordx4 v[240:243], v22, s[28:31], s66 offen sc1
    v_lshlrev_b32 v200, 16, v12
    v_and_b32 v201, 0xffff0000, v12
    v_pk_add_f32 v[40:41], v[40:41], v[200:201]
    v_cvt_pk_bf16_f32 v244, v40, v41
    v_lshlrev_b32 v200, 16, v13
    v_and_b32 v201, 0xffff0000, v13
    v_pk_add_f32 v[42:43], v[42:43], v[200:201]
    v_cvt_pk_bf16_f32 v245, v42, v43
    v_lshlrev_b32 v200, 16, v14
    v_and_b32 v201, 0xffff0000, v14
    v_pk_add_f32 v[44:45], v[44:45], v[200:201]
    v_cvt_pk_bf16_f32 v246, v44, v45
    v_lshlrev_b32 v200, 16, v15
    v_and_b32 v201, 0xffff0000, v15
    v_pk_add_f32 v[46:47], v[46:47], v[200:201]
    v_cvt_pk_bf16_f32 v247, v46, v47
    buffer_store_dwordx4 v[244:247], v23, s[28:31], s66 offen sc1
    v_lshlrev_b32 v200, 16, v16
    v_and_b32 v201, 0xffff0000, v16
    v_pk_add_f32 v[48:49], v[48:49], v[200:201]
    v_cvt_pk_bf16_f32 v248, v48, v49
    v_lshlrev_b32 v200, 16, v17
    v_and_b32 v201, 0xffff0000, v17
    v_pk_add_f32 v[50:51], v[50:51], v[200:201]
    v_cvt_pk_bf16_f32 v249, v50, v51
    buffer_store_dwordx2 v[248:249], v24, s[28:31], s66 offen sc1
    v_pk_add_f32 v[204:205], v[204:205], v[32:33]
    v_pk_fma_f32 v[206:207], v[32:33], v[32:33], v[206:207]
    v_pk_add_f32 v[204:205], v[204:205], v[34:35]
    v_pk_fma_f32 v[206:207], v[34:35], v[34:35], v[206:207]
    v_pk_add_f32 v[204:205], v[204:205], v[36:37]
    v_pk_fma_f32 v[206:207], v[36:37], v[36:37], v[206:207]
    v_pk_add_f32 v[204:205], v[204:205], v[38:39]
    v_pk_fma_f32 v[206:207], v[38:39], v[38:39], v[206:207]
    v_pk_add_f32 v[204:205], v[204:205], v[40:41]
    v_pk_fma_f32 v[206:207], v[40:41], v[40:41], v[206:207]
    v_pk_add_f32 v[204:205], v[204:205], v[42:43]
    v_pk_fma_f32 v[206:207], v[42:43], v[42:43], v[206:207]
    v_pk_add_f32 v[204:205], v[204:205], v[44:45]
    v_pk_fma_f32 v[206:207], v[44:45], v[44:45], v[206:207]
    v_pk_add_f32 v[204:205], v[204:205], v[46:47]
    v_pk_fma_f32 v[206:207], v[46:47], v[46:47], v[206:207]
    v_pk_add_f32 v[204:205], v[204:205], v[48:49]
    v_pk_fma_f32 v[206:207], v[48:49], v[48:49], v[206:207]
    v_pk_add_f32 v[204:205], v[204:205], v[50:51]
    v_pk_fma_f32 v[206:207], v[50:51], v[50:51], v[206:207]
    v_add_f32 v204, v204, v205
    v_add_f32 v205, v206, v207
    v_mov_b32 v200, v204
    s_nop 1
    v_permlane16_swap_b32 v204, v200
    v_add_f32 v204, v204, v200
    v_mov_b32 v200, v204
    s_nop 1
    v_permlane32_swap_b32 v204, v200
    v_add_f32 v204, v204, v200
    v_mov_b32 v200, v205
    s_nop 1
    v_permlane16_swap_b32 v205, v200
    v_add_f32 v205, v205, v200
    v_mov_b32 v200, v205
    s_nop 1
    v_permlane32_swap_b32 v205, v200
    v_add_f32 v205, v205, v200
    s_mov_b64 exec, 0xffff
    buffer_store_dwordx2 v[204:205], v18, s[28:31], s67 offen sc1
    s_mov_b64 exec, -1
    v_mov_b32 v112, 0x3f803f80
    v_mov_b32 v113, 0x3f803f80
    v_mov_b32 v114, 0x3f803f80
    v_mov_b32 v115, 0x3f803f80
    v_mov_b32 v80, 0
    v_mov_b32 v81, 0
    v_mov_b32 v82, 0
    v_mov_b32 v83, 0
    v_mov_b32 v84, 0
    v_mov_b32 v85, 0
    v_mov_b32 v86, 0
    v_mov_b32 v87, 0
    v_mov_b32 v32, 0
    v_mov_b32 v33, 0
    v_mov_b32 v34, 0
    v_mov_b32 v35, 0
    v_mov_b32 v36, 0
    v_mov_b32 v37, 0
    v_mov_b32 v38, 0
    v_mov_b32 v39, 0
    v_mov_b32 v40, 0
    v_mov_b32 v41, 0
    v_mov_b32 v42, 0
    v_mov_b32 v43, 0
    v_mov_b32 v44, 0
    v_mov_b32 v45, 0
    v_mov_b32 v46, 0
    v_mov_b32 v47, 0
    v_mov_b32 v48, 0
    v_mov_b32 v49, 0
    v_mov_b32 v50, 0
    v_mov_b32 v51, 0
    v_mov_b32 v52, 0
    v_mov_b32 v53, 0
    v_mov_b32 v54, 0
    v_mov_b32 v55, 0
    v_mov_b32 v56, 0
    v_mov_b32 v57, 0
    v_mov_b32 v58, 0
    v_mov_b32 v59, 0
    v_mov_b32 v60, 0
    v_mov_b32 v61, 0
    v_mov_b32 v62, 0
    v_mov_b32 v63, 0
    v_mov_b32 v64, 0
    v_mov_b32 v65, 0
    v_mov_b32 v66, 0
    v_mov_b32 v67, 0
    v_mov_b32 v68, 0
    v_mov_b32 v69, 0
    v_mov_b32 v70, 0
    v_mov_b32 v71, 0
    v_mov_b32 v72, 0
    v_mov_b32 v73, 0
    v_mov_b32 v74, 0
    v_mov_b32 v75, 0
    v_mov_b32 v76, 0
    v_mov_b32 v77, 0
    v_mov_b32 v78, 0
    v_mov_b32 v79, 0
    s_barrier
    s_cmp_eq_u32 s36, 0
    s_cbranch_scc1 H0_27
    s_sub_u32 s49, s91, 1024
    s_add_u32 m0, s94, 0x14000
    s_add_u32 s62, s49, 0xc000
    buffer_load_dwordx4 v4, s[28:31], s62 offen sc1 lds
    s_add_u32 m0, s94, 0x14c00
    s_add_u32 s62, s49, 0xcc00
    buffer_load_dwordx4 v4, s[28:31], s62 offen sc1 lds
    s_add_u32 m0, s94, 0x15800
    s_add_u32 s62, s49, 0xd800
    buffer_load_dwordx4 v4, s[28:31], s62 offen sc1 lds
    s_add_u32 m0, s94, 0x16400
    s_add_u32 s62, s49, 0xe400
    buffer_load_dwordx4 v4, s[28:31], s62 offen sc1 lds
    s_add_u32 m0, s94, 0x17000
    s_add_u32 s62, s49, 0xf000
    buffer_load_dwordx4 v4, s[28:31], s62 offen sc1 lds
    s_add_u32 m0, s94, 0x17c00
    s_add_u32 s62, s49, 0xfc00
    buffer_load_dwordx4 v4, s[28:31], s62 offen sc1 lds
    s_add_u32 m0, s94, 0x18800
    s_add_u32 s62, s49, 0x10800
    buffer_load_dwordx4 v4, s[28:31], s62 offen sc1 lds
    s_add_u32 m0, s94, 0x19400
    s_add_u32 s62, s49, 0x11400
    buffer_load_dwordx4 v4, s[28:31], s62 offen sc1 lds
    s_waitcnt vmcnt(8)
    s_branch H1_28
H0_27:
    s_waitcnt vmcnt(0)
H1_28:
    s_barrier
    s_cmp_eq_u32 s36, 0
    s_cbranch_scc1 H2_29
    s_sub_u32 s49, s91, 1024
    s_add_u32 m0, s94, 0x1a000
    s_add_u32 s62, s49, 0x12000
    buffer_load_dwordx4 v4, s[28:31], s62 offen sc1 lds
    s_add_u32 m0, s94, 0x1ac00
    s_add_u32 s62, s49, 0x12c00
    buffer_load_dwordx4 v4, s[28:31], s62 offen sc1 lds
    s_add_u32 m0, s94, 0x1b800
    s_add_u32 s62, s49, 0x13800
    buffer_load_dwordx4 v4, s[28:31], s62 offen sc1 lds
    s_add_u32 m0, s94, 0x1c400
    s_add_u32 s62, s49, 0x14400
    buffer_load_dwordx4 v4, s[28:31], s62 offen sc1 lds
    s_add_u32 m0, s94, 0x1d000
    s_add_u32 s62, s49, 0x15000
    buffer_load_dwordx4 v4, s[28:31], s62 offen sc1 lds
    s_add_u32 m0, s94, 0x1dc00
    s_add_u32 s62, s49, 0x15c00
    buffer_load_dwordx4 v4, s[28:31], s62 offen sc1 lds
    s_add_u32 m0, s94, 0x1e800
    s_add_u32 s62, s49, 0x16800
    buffer_load_dwordx4 v4, s[28:31], s62 offen sc1 lds
    s_add_u32 m0, s94, 0x1f400
    s_add_u32 s62, s49, 0x17400
    buffer_load_dwordx4 v4, s[28:31], s62 offen sc1 lds
    s_add_u32 m0, s94, 0x20000
    s_add_u32 s62, s49, 0x18000
    buffer_load_dwordx4 v4, s[28:31], s62 offen sc1 lds
    s_add_u32 m0, s94, 0x20c00
    s_add_u32 s62, s49, 0x18c00
    buffer_load_dwordx4 v4, s[28:31], s62 offen sc1 lds
    s_add_u32 m0, s94, 0x21800
    s_add_u32 s62, s49, 0x19800
    buffer_load_dwordx4 v4, s[28:31], s62 offen sc1 lds
    s_add_u32 m0, s94, 0x22400
    s_add_u32 s62, s49, 0x1a400
    buffer_load_dwordx4 v4, s[28:31], s62 offen sc1 lds
    s_add_u32 m0, s94, 0x23000
    s_add_u32 s62, s49, 0x1b000
    buffer_load_dwordx4 v4, s[28:31], s62 offen sc1 lds
    s_add_u32 m0, s94, 0x23c00
    s_add_u32 s62, s49, 0x1bc00
    buffer_load_dwordx4 v4, s[28:31], s62 offen sc1 lds
    s_add_u32 m0, s94, 0x24800
    s_add_u32 s62, s49, 0x1c800
    buffer_load_dwordx4 v4, s[28:31], s62 offen sc1 lds
    s_add_u32 m0, s94, 0x25400
    s_add_u32 s62, s49, 0x1d400
    buffer_load_dwordx4 v4, s[28:31], s62 offen sc1 lds
    s_branch H3_30
H2_29:
    s_lshl_b32 s52, s39, 4
    s_add_u32 s52, s52, s40
    s_lshl_b32 s44, s52, 6
    s_add_u32 s44, s44, 0x8000
    v_mov_b32 v212, s42
    v_mov_b32 v213, s43
    v_mov_b32 v214, s44
    s_mov_b64 exec, 1
    s_cmp_lg_u32 s99, 0
    s_cbranch_scc1 DF_32
    buffer_store_dwordx2 v[212:213], v214, s[28:31], 0 offen sc1
    s_branch DJ_33
DF_32:
    buffer_store_dwordx2 v[212:213], v214, s[28:31], 0 offen
DJ_33:
    s_mov_b64 exec, -1
FS_31:
    s_lshl_b32 s52, s39, 10
    s_add_u32 s52, s52, 0x8000
    v_lshlrev_b32 v212, 6, v2
    v_add_u32 v212, s52, v212
    s_mov_b32 s44, 0
PL_34:
    buffer_load_dwordx2 v[214:215], v212, s[28:31], 0 offen offset:0 sc1
    s_waitcnt vmcnt(0)
    v_cmp_eq_u32 s[46:47], s42, v214
    v_cmp_eq_u32 s[48:49], s43, v215
    s_nop 1
    s_and_b64 s[46:47], s[46:47], s[48:49]
    s_mov_b64 s[50:51], s[46:47]
    s_cmp_eq_u64 s[50:51], -1
    s_cbranch_scc1 PD_35
    s_add_u32 s44, s44, 1
    s_cmp_gt_u32 s44, 20000
    s_cbranch_scc0 PL_34
    s_mov_b32 s63, 1
PD_35:
H3_30:
    s_barrier
    s_lshl_b32 s54, s39, 3
    s_lshl_b32 s55, s36, 1
    s_add_u32 s54, s54, s55
    s_mov_b32 s88, s54
    s_mul_i32 s55, s54, 20480
    s_add_u32 s55, s55, 0xc00000
    s_add_u32 s56, s55, 20480
    buffer_load_dwordx4 a[0:3], v4, s[28:31], s55 offen offset:0 sc1
    buffer_load_dwordx4 a[4:7], v4, s[28:31], s56 offen offset:0 sc1
    buffer_load_dwordx4 a[8:11], v4, s[28:31], s55 offen offset:1024 sc1
    buffer_load_dwordx4 a[12:15], v4, s[28:31], s56 offen offset:1024 sc1
    buffer_load_dwordx4 a[16:19], v4, s[28:31], s55 offen offset:2048 sc1
    buffer_load_dwordx4 a[20:23], v4, s[28:31], s56 offen offset:2048 sc1
    buffer_load_dwordx4 a[24:27], v4, s[28:31], s55 offen offset:3072 sc1
    buffer_load_dwordx4 a[28:31], v4, s[28:31], s56 offen offset:3072 sc1
    s_lshl_b32 s57, s54, 4
    v_add_u32 v200, s57, v2
    v_lshlrev_b32 v200, 6, v200
    v_lshl_add_u32 v200, v3, 4, v200
    v_add_u32 v25, 0x40000, v200
    s_add_u32 s58, s36, 4
    s_cmp_ge_u32 s58, 6
    s_cselect_b32 s57, 6, 0
    s_sub_u32 s58, s58, s57
    v_add_u32 v200, s93, v4
    s_lshl_b32 s57, s58, 10
    v_add_u32 v201, s57, v4
    v_add_u32 v202, 0x10000, v200
    v_add_u32 v203, 0x10000, v201
    v_add_u32 v204, 0x20000, v200
    v_add_u32 v205, 0x20000, v201
    v_mov_b32 v142, v200
    v_mov_b32 v143, v201
    v_mov_b32 v144, v202
    v_mov_b32 v145, v203
    v_mov_b32 v146, v204
    v_mov_b32 v147, v205
    ds_read_b128 a[208:211], v142 offset:32768
    ds_read_b128 a[212:215], v143 offset:32768
    ds_read_b128 a[216:219], v142 offset:38912
    ds_read_b128 a[220:223], v143 offset:38912
    ds_read_b128 a[224:227], v142 offset:45056
    ds_read_b128 a[228:231], v143 offset:45056
    ds_read_b128 a[232:235], v142 offset:51200
    ds_read_b128 a[236:239], v143 offset:51200
    s_waitcnt lgkmcnt(6)
    v_mfma_f32_16x16x32_bf16 v[80:83], a[208:211], v[112:115], v[80:83]
    v_mfma_f32_16x16x32_bf16 v[84:87], a[212:215], v[112:115], v[84:87]
    s_mul_i32 s100, s36, 8192
    s_add_u32 s101, s100, s92
    s_sub_u32 s101, s101, s93
    s_add_u32 s101, s101, 0x0
    s_add_u32 s100, s100, 0x0
    s_add_u32 m0, s100, 0x0
    s_add_u32 s62, s101, 0x0
    buffer_load_dwordx4 v4, s[28:31], s62 offen offset:0 sc1 lds
    ds_read_b128 a[208:211], v142 offset:57344
    ds_read_b128 a[212:215], v143 offset:57344
    s_waitcnt lgkmcnt(6)
    v_mfma_f32_16x16x32_bf16 v[80:83], a[216:219], v[112:115], v[80:83]
    v_mfma_f32_16x16x32_bf16 v[84:87], a[220:223], v[112:115], v[84:87]
    buffer_load_dwordx4 v4, s[28:31], s62 offen offset:1024 sc1 lds
    ds_read_b128 a[216:219], v142 offset:63488
    ds_read_b128 a[220:223], v143 offset:63488
    s_waitcnt lgkmcnt(6)
    v_mfma_f32_16x16x32_bf16 v[80:83], a[224:227], v[112:115], v[80:83]
    v_mfma_f32_16x16x32_bf16 v[84:87], a[228:231], v[112:115], v[84:87]
    buffer_load_dwordx4 v4, s[28:31], s62 offen offset:2048 sc1 lds
    ds_read_b128 a[224:227], v144 offset:4096
    ds_read_b128 a[228:231], v145 offset:4096
    s_waitcnt lgkmcnt(6)
    v_mfma_f32_16x16x32_bf16 v[80:83], a[232:235], v[112:115], v[80:83]
    v_mfma_f32_16x16x32_bf16 v[84:87], a[236:239], v[112:115], v[84:87]
    buffer_load_dwordx4 v4, s[28:31], s62 offen offset:3072 sc1 lds
    ds_read_b128 a[232:235], v144 offset:10240
    ds_read_b128 a[236:239], v145 offset:10240
    s_waitcnt lgkmcnt(6)
    v_mfma_f32_16x16x32_bf16 v[80:83], a[208:211], v[112:115], v[80:83]
    v_mfma_f32_16x16x32_bf16 v[84:87], a[212:215], v[112:115], v[84:87]
    s_add_u32 m0, s100, 0x1000
    s_add_u32 s62, s101, 0x1000
    buffer_load_dwordx4 v4, s[28:31], s62 offen offset:0 sc1 lds
    s_waitcnt lgkmcnt(4)
    v_mfma_f32_16x16x32_bf16 v[80:83], a[216:219], v[112:115], v[80:83]
    v_mfma_f32_16x16x32_bf16 v[84:87], a[220:223], v[112:115], v[84:87]
    buffer_load_dwordx4 v4, s[28:31], s62 offen offset:1024 sc1 lds
    s_waitcnt lgkmcnt(2)
    v_mfma_f32_16x16x32_bf16 v[80:83], a[224:227], v[112:115], v[80:83]
    v_mfma_f32_16x16x32_bf16 v[84:87], a[228:231], v[112:115], v[84:87]
    buffer_load_dwordx4 v4, s[28:31], s62 offen offset:2048 sc1 lds
    s_waitcnt lgkmcnt(0)
    v_mfma_f32_16x16x32_bf16 v[80:83], a[232:235], v[112:115], v[80:83]
    v_mfma_f32_16x16x32_bf16 v[84:87], a[236:239], v[112:115], v[84:87]
    buffer_load_dwordx4 v4, s[28:31], s62 offen offset:3072 sc1 lds
    v_lshlrev_b32 v202, 4, v3
    s_lshl_b32 s57, s36, 6
    s_add_u32 s57, s57, 161792
    v_add_u32 v200, s57, v202
    s_lshl_b32 s57, s58, 6
    s_add_u32 s57, s57, 161792
    v_add_u32 v201, s57, v202
    v_add_u32 v26, 161792, v202
    v_mov_b32 v216, v4
    v_add_u32 v217, 0x10000, v4
    v_add_u32 v218, 0x20000, v4
    v_mov_b32 v140, v200
    v_mov_b32 v141, v201
    ds_read_b128 a[160:163], v216 offset:32768
    ds_read_b128 a[164:167], v216 offset:33792
    ds_read_b128 a[168:171], v216 offset:34816
    ds_read_b128 a[172:175], v216 offset:35840
    ds_read_b128 a[176:179], v216 offset:36864
    ds_read_b128 a[180:183], v216 offset:37888
    s_waitcnt vmcnt(14) lgkmcnt(0)
    s_add_u32 s55, s55, 4096
    v_mfma_f32_16x16x32_bf16 v[32:35], a[160:163], a[0:3], v[32:35]
    ds_read_b128 a[184:187], v216 offset:38912
    buffer_load_dwordx4 a[32:35], v4, s[28:31], s55 offen offset:0 sc1
    v_mfma_f32_16x16x32_bf16 v[36:39], a[160:163], a[4:7], v[36:39]
    v_mfma_f32_16x16x32_bf16 v[40:43], a[164:167], a[0:3], v[40:43]
    ds_read_b128 a[188:191], v216 offset:39936
    s_add_u32 s56, s56, 4096
    v_mfma_f32_16x16x32_bf16 v[44:47], a[164:167], a[4:7], v[44:47]
    buffer_load_dwordx4 a[36:39], v4, s[28:31], s56 offen offset:0 sc1
    v_mfma_f32_16x16x32_bf16 v[48:51], a[168:171], a[0:3], v[48:51]
    ds_read_b128 a[192:195], v216 offset:40960
    v_mfma_f32_16x16x32_bf16 v[52:55], a[168:171], a[4:7], v[52:55]
    v_mfma_f32_16x16x32_bf16 v[56:59], a[172:175], a[0:3], v[56:59]
    ds_read_b128 a[196:199], v216 offset:41984
    v_mfma_f32_16x16x32_bf16 v[60:63], a[172:175], a[4:7], v[60:63]
    v_mfma_f32_16x16x32_bf16 v[64:67], a[176:179], a[0:3], v[64:67]
    ds_read_b128 a[200:203], v216 offset:43008
    v_mfma_f32_16x16x32_bf16 v[68:71], a[176:179], a[4:7], v[68:71]
    v_mfma_f32_16x16x32_bf16 v[72:75], a[180:183], a[0:3], v[72:75]
    ds_read_b128 a[204:207], v216 offset:44032
    v_mfma_f32_16x16x32_bf16 v[76:79], a[180:183], a[4:7], v[76:79]
    s_waitcnt vmcnt(14) lgkmcnt(0)
    v_mfma_f32_16x16x32_bf16 v[32:35], a[184:187], a[8:11], v[32:35]
    ds_read_b128 a[160:163], v216 offset:45056
    buffer_load_dwordx4 a[40:43], v4, s[28:31], s55 offen offset:1024 sc1
    v_mfma_f32_16x16x32_bf16 v[36:39], a[184:187], a[12:15], v[36:39]
    v_mfma_f32_16x16x32_bf16 v[40:43], a[188:191], a[8:11], v[40:43]
    ds_read_b128 a[164:167], v216 offset:46080
    v_mfma_f32_16x16x32_bf16 v[44:47], a[188:191], a[12:15], v[44:47]
    buffer_load_dwordx4 a[44:47], v4, s[28:31], s56 offen offset:1024 sc1
    v_mfma_f32_16x16x32_bf16 v[48:51], a[192:195], a[8:11], v[48:51]
    ds_read_b128 a[168:171], v216 offset:47104
    v_mfma_f32_16x16x32_bf16 v[52:55], a[192:195], a[12:15], v[52:55]
    v_mfma_f32_16x16x32_bf16 v[56:59], a[196:199], a[8:11], v[56:59]
    ds_read_b128 a[172:175], v216 offset:48128
    v_mfma_f32_16x16x32_bf16 v[60:63], a[196:199], a[12:15], v[60:63]
    v_mfma_f32_16x16x32_bf16 v[64:67], a[200:203], a[8:11], v[64:67]
    ds_read_b128 a[176:179], v216 offset:49152
    v_mfma_f32_16x16x32_bf16 v[68:71], a[200:203], a[12:15], v[68:71]
    v_mfma_f32_16x16x32_bf16 v[72:75], a[204:207], a[8:11], v[72:75]
    ds_read_b128 a[180:183], v216 offset:50176
    v_mfma_f32_16x16x32_bf16 v[76:79], a[204:207], a[12:15], v[76:79]
    s_waitcnt vmcnt(14) lgkmcnt(0)
    v_mfma_f32_16x16x32_bf16 v[32:35], a[160:163], a[16:19], v[32:35]
    ds_read_b128 a[184:187], v216 offset:51200
    buffer_load_dwordx4 a[48:51], v4, s[28:31], s55 offen offset:2048 sc1
    v_mfma_f32_16x16x32_bf16 v[36:39], a[160:163], a[20:23], v[36:39]
    v_mfma_f32_16x16x32_bf16 v[40:43], a[164:167], a[16:19], v[40:43]
    ds_read_b128 a[188:191], v216 offset:52224
    v_mfma_f32_16x16x32_bf16 v[44:47], a[164:167], a[20:23], v[44:47]
    buffer_load_dwordx4 a[52:55], v4, s[28:31], s56 offen offset:2048 sc1
    v_mfma_f32_16x16x32_bf16 v[48:51], a[168:171], a[16:19], v[48:51]
    ds_read_b128 a[192:195], v216 offset:53248
    v_mfma_f32_16x16x32_bf16 v[52:55], a[168:171], a[20:23], v[52:55]
    v_mfma_f32_16x16x32_bf16 v[56:59], a[172:175], a[16:19], v[56:59]
    ds_read_b128 a[196:199], v216 offset:54272
    v_mfma_f32_16x16x32_bf16 v[60:63], a[172:175], a[20:23], v[60:63]
    v_mfma_f32_16x16x32_bf16 v[64:67], a[176:179], a[16:19], v[64:67]
    ds_read_b128 a[200:203], v216 offset:55296
    v_mfma_f32_16x16x32_bf16 v[68:71], a[176:179], a[20:23], v[68:71]
    v_mfma_f32_16x16x32_bf16 v[72:75], a[180:183], a[16:19], v[72:75]
    ds_read_b128 a[204:207], v216 offset:56320
    v_mfma_f32_16x16x32_bf16 v[76:79], a[180:183], a[20:23], v[76:79]
    s_waitcnt vmcnt(14) lgkmcnt(0)
    v_mfma_f32_16x16x32_bf16 v[32:35], a[184:187], a[24:27], v[32:35]
    ds_read_b128 a[160:163], v216 offset:57344
    buffer_load_dwordx4 a[56:59], v4, s[28:31], s55 offen offset:3072 sc1
    v_mfma_f32_16x16x32_bf16 v[36:39], a[184:187], a[28:31], v[36:39]
    v_mfma_f32_16x16x32_bf16 v[40:43], a[188:191], a[24:27], v[40:43]
    ds_read_b128 a[164:167], v216 offset:58368
    v_mfma_f32_16x16x32_bf16 v[44:47], a[188:191], a[28:31], v[44:47]
    buffer_load_dwordx4 a[60:63], v4, s[28:31], s56 offen offset:3072 sc1
    v_mfma_f32_16x16x32_bf16 v[48:51], a[192:195], a[24:27], v[48:51]
    ds_read_b128 a[168:171], v216 offset:59392
    v_mfma_f32_16x16x32_bf16 v[52:55], a[192:195], a[28:31], v[52:55]
    v_mfma_f32_16x16x32_bf16 v[56:59], a[196:199], a[24:27], v[56:59]
    ds_read_b128 a[172:175], v216 offset:60416
    v_mfma_f32_16x16x32_bf16 v[60:63], a[196:199], a[28:31], v[60:63]
    v_mfma_f32_16x16x32_bf16 v[64:67], a[200:203], a[24:27], v[64:67]
    ds_read_b128 a[176:179], v216 offset:61440
    v_mfma_f32_16x16x32_bf16 v[68:71], a[200:203], a[28:31], v[68:71]
    v_mfma_f32_16x16x32_bf16 v[72:75], a[204:207], a[24:27], v[72:75]
    ds_read_b128 a[180:183], v216 offset:62464
    v_mfma_f32_16x16x32_bf16 v[76:79], a[204:207], a[28:31], v[76:79]
    s_waitcnt vmcnt(6) lgkmcnt(0)
    s_add_u32 s55, s55, 4096
    v_mfma_f32_16x16x32_bf16 v[32:35], a[160:163], a[32:35], v[32:35]
    ds_read_b128 a[184:187], v216 offset:63488
    buffer_load_dwordx4 a[64:67], v4, s[28:31], s55 offen offset:0 sc1
    v_mfma_f32_16x16x32_bf16 v[36:39], a[160:163], a[36:39], v[36:39]
    v_mfma_f32_16x16x32_bf16 v[40:43], a[164:167], a[32:35], v[40:43]
    ds_read_b128 a[188:191], v216 offset:64512
    s_add_u32 s56, s56, 4096
    v_mfma_f32_16x16x32_bf16 v[44:47], a[164:167], a[36:39], v[44:47]
    buffer_load_dwordx4 a[68:71], v4, s[28:31], s56 offen offset:0 sc1
    v_mfma_f32_16x16x32_bf16 v[48:51], a[168:171], a[32:35], v[48:51]
    ds_read_b128 a[192:195], v217 offset:0
    v_mfma_f32_16x16x32_bf16 v[52:55], a[168:171], a[36:39], v[52:55]
    v_mfma_f32_16x16x32_bf16 v[56:59], a[172:175], a[32:35], v[56:59]
    ds_read_b128 a[196:199], v217 offset:1024
    v_mfma_f32_16x16x32_bf16 v[60:63], a[172:175], a[36:39], v[60:63]
    v_mfma_f32_16x16x32_bf16 v[64:67], a[176:179], a[32:35], v[64:67]
    ds_read_b128 a[200:203], v217 offset:2048
    v_mfma_f32_16x16x32_bf16 v[68:71], a[176:179], a[36:39], v[68:71]
    v_mfma_f32_16x16x32_bf16 v[72:75], a[180:183], a[32:35], v[72:75]
    ds_read_b128 a[204:207], v217 offset:3072
    v_mfma_f32_16x16x32_bf16 v[76:79], a[180:183], a[36:39], v[76:79]
    s_waitcnt vmcnt(6) lgkmcnt(0)
    v_mfma_f32_16x16x32_bf16 v[32:35], a[184:187], a[40:43], v[32:35]
    ds_read_b128 a[160:163], v217 offset:4096
    buffer_load_dwordx4 a[72:75], v4, s[28:31], s55 offen offset:1024 sc1
    v_mfma_f32_16x16x32_bf16 v[36:39], a[184:187], a[44:47], v[36:39]
    v_mfma_f32_16x16x32_bf16 v[40:43], a[188:191], a[40:43], v[40:43]
    ds_read_b128 a[164:167], v217 offset:5120
    v_mfma_f32_16x16x32_bf16 v[44:47], a[188:191], a[44:47], v[44:47]
    buffer_load_dwordx4 a[76:79], v4, s[28:31], s56 offen offset:1024 sc1
    v_mfma_f32_16x16x32_bf16 v[48:51], a[192:195], a[40:43], v[48:51]
    ds_read_b128 a[168:171], v217 offset:6144
    v_mfma_f32_16x16x32_bf16 v[52:55], a[192:195], a[44:47], v[52:55]
    v_mfma_f32_16x16x32_bf16 v[56:59], a[196:199], a[40:43], v[56:59]
    ds_read_b128 a[172:175], v217 offset:7168
    v_mfma_f32_16x16x32_bf16 v[60:63], a[196:199], a[44:47], v[60:63]
    v_mfma_f32_16x16x32_bf16 v[64:67], a[200:203], a[40:43], v[64:67]
    ds_read_b128 a[176:179], v217 offset:8192
    v_mfma_f32_16x16x32_bf16 v[68:71], a[200:203], a[44:47], v[68:71]
    v_mfma_f32_16x16x32_bf16 v[72:75], a[204:207], a[40:43], v[72:75]
    ds_read_b128 a[180:183], v217 offset:9216
    v_mfma_f32_16x16x32_bf16 v[76:79], a[204:207], a[44:47], v[76:79]
    s_waitcnt vmcnt(6) lgkmcnt(0)
    v_mfma_f32_16x16x32_bf16 v[32:35], a[160:163], a[48:51], v[32:35]
    ds_read_b128 a[184:187], v217 offset:10240
    buffer_load_dwordx4 a[80:83], v4, s[28:31], s55 offen offset:2048 sc1
    v_mfma_f32_16x16x32_bf16 v[36:39], a[160:163], a[52:55], v[36:39]
    v_mfma_f32_16x16x32_bf16 v[40:43], a[164:167], a[48:51], v[40:43]
    ds_read_b128 a[188:191], v217 offset:11264
    v_mfma_f32_16x16x32_bf16 v[44:47], a[164:167], a[52:55], v[44:47]
    buffer_load_dwordx4 a[84:87], v4, s[28:31], s56 offen offset:2048 sc1
    v_mfma_f32_16x16x32_bf16 v[48:51], a[168:171], a[48:51], v[48:51]
    ds_read_b128 a[192:195], v217 offset:12288
    v_mfma_f32_16x16x32_bf16 v[52:55], a[168:171], a[52:55], v[52:55]
    v_mfma_f32_16x16x32_bf16 v[56:59], a[172:175], a[48:51], v[56:59]
    ds_read_b128 a[196:199], v217 offset:13312
    v_mfma_f32_16x16x32_bf16 v[60:63], a[172:175], a[52:55], v[60:63]
    v_mfma_f32_16x16x32_bf16 v[64:67], a[176:179], a[48:51], v[64:67]
    ds_read_b128 a[200:203], v217 offset:14336
    v_mfma_f32_16x16x32_bf16 v[68:71], a[176:179], a[52:55], v[68:71]
    v_mfma_f32_16x16x32_bf16 v[72:75], a[180:183], a[48:51], v[72:75]
    ds_read_b128 a[204:207], v217 offset:15360
    v_mfma_f32_16x16x32_bf16 v[76:79], a[180:183], a[52:55], v[76:79]
    s_waitcnt vmcnt(30)
    s_barrier
    s_waitcnt vmcnt(6) lgkmcnt(0)
    v_mfma_f32_16x16x32_bf16 v[32:35], a[184:187], a[56:59], v[32:35]
    ds_read_b128 a[160:163], v217 offset:16384
    buffer_load_dwordx4 a[88:91], v4, s[28:31], s55 offen offset:3072 sc1
    v_mfma_f32_16x16x32_bf16 v[36:39], a[184:187], a[60:63], v[36:39]
    v_mfma_f32_16x16x32_bf16 v[40:43], a[188:191], a[56:59], v[40:43]
    ds_read_b128 a[164:167], v217 offset:17408
    v_mfma_f32_16x16x32_bf16 v[44:47], a[188:191], a[60:63], v[44:47]
    buffer_load_dwordx4 a[92:95], v4, s[28:31], s56 offen offset:3072 sc1
    v_mfma_f32_16x16x32_bf16 v[48:51], a[192:195], a[56:59], v[48:51]
    ds_read_b128 a[168:171], v217 offset:18432
    v_mfma_f32_16x16x32_bf16 v[52:55], a[192:195], a[60:63], v[52:55]
    v_mfma_f32_16x16x32_bf16 v[56:59], a[196:199], a[56:59], v[56:59]
    ds_read_b128 a[172:175], v217 offset:19456
    v_mfma_f32_16x16x32_bf16 v[60:63], a[196:199], a[60:63], v[60:63]
    v_mfma_f32_16x16x32_bf16 v[64:67], a[200:203], a[56:59], v[64:67]
    ds_read_b128 a[176:179], v217 offset:20480
    v_mfma_f32_16x16x32_bf16 v[68:71], a[200:203], a[60:63], v[68:71]
    v_mfma_f32_16x16x32_bf16 v[72:75], a[204:207], a[56:59], v[72:75]
    ds_read_b128 a[180:183], v217 offset:21504
    v_mfma_f32_16x16x32_bf16 v[76:79], a[204:207], a[60:63], v[76:79]
    s_waitcnt lgkmcnt(0)
    ds_read_b128 a[208:211], v144 offset:16384
    ds_read_b128 a[212:215], v145 offset:16384
    ds_read_b128 a[216:219], v144 offset:22528
    ds_read_b128 a[220:223], v145 offset:22528
    ds_read_b128 a[224:227], v144 offset:28672
    ds_read_b128 a[228:231], v145 offset:28672
    ds_read_b128 a[232:235], v144 offset:34816
    ds_read_b128 a[236:239], v145 offset:34816
    s_waitcnt lgkmcnt(6)
    v_mfma_f32_16x16x32_bf16 v[80:83], a[208:211], v[112:115], v[80:83]
    v_mfma_f32_16x16x32_bf16 v[84:87], a[212:215], v[112:115], v[84:87]
    ds_read_b128 a[208:211], v144 offset:40960
    ds_read_b128 a[212:215], v145 offset:40960
    s_waitcnt lgkmcnt(6)
    v_mfma_f32_16x16x32_bf16 v[80:83], a[216:219], v[112:115], v[80:83]
    v_mfma_f32_16x16x32_bf16 v[84:87], a[220:223], v[112:115], v[84:87]
    ds_read_b128 a[216:219], v144 offset:47104
    ds_read_b128 a[220:223], v145 offset:47104
    s_waitcnt lgkmcnt(6)
    v_mfma_f32_16x16x32_bf16 v[80:83], a[224:227], v[112:115], v[80:83]
    v_mfma_f32_16x16x32_bf16 v[84:87], a[228:231], v[112:115], v[84:87]
    ds_read_b128 a[224:227], v144 offset:53248
    ds_read_b128 a[228:231], v145 offset:53248
    s_waitcnt lgkmcnt(6)
    v_mfma_f32_16x16x32_bf16 v[80:83], a[232:235], v[112:115], v[80:83]
    v_mfma_f32_16x16x32_bf16 v[84:87], a[236:239], v[112:115], v[84:87]
    ds_read_b128 a[232:235], v144 offset:59392
    ds_read_b128 a[236:239], v145 offset:59392
    s_waitcnt lgkmcnt(6)
    v_mfma_f32_16x16x32_bf16 v[80:83], a[208:211], v[112:115], v[80:83]
    v_mfma_f32_16x16x32_bf16 v[84:87], a[212:215], v[112:115], v[84:87]
    ds_read_b128 a[208:211], v146 offset:0
    ds_read_b128 a[212:215], v147 offset:0
    s_waitcnt lgkmcnt(6)
    v_mfma_f32_16x16x32_bf16 v[80:83], a[216:219], v[112:115], v[80:83]
    v_mfma_f32_16x16x32_bf16 v[84:87], a[220:223], v[112:115], v[84:87]
    ds_read_b128 a[216:219], v146 offset:6144
    ds_read_b128 a[220:223], v147 offset:6144
    s_waitcnt lgkmcnt(6)
    v_mfma_f32_16x16x32_bf16 v[80:83], a[224:227], v[112:115], v[80:83]
    v_mfma_f32_16x16x32_bf16 v[84:87], a[228:231], v[112:115], v[84:87]
    ds_read_b128 a[224:227], v146 offset:12288
    ds_read_b128 a[228:231], v147 offset:12288
    s_waitcnt lgkmcnt(6)
    v_mfma_f32_16x16x32_bf16 v[80:83], a[232:235], v[112:115], v[80:83]
    v_mfma_f32_16x16x32_bf16 v[84:87], a[236:239], v[112:115], v[84:87]
    ds_read_b128 a[232:235], v146 offset:18432
    ds_read_b128 a[236:239], v147 offset:18432
    s_waitcnt lgkmcnt(6)
    v_mfma_f32_16x16x32_bf16 v[80:83], a[208:211], v[112:115], v[80:83]
    v_mfma_f32_16x16x32_bf16 v[84:87], a[212:215], v[112:115], v[84:87]
    s_waitcnt lgkmcnt(4)
    v_mfma_f32_16x16x32_bf16 v[80:83], a[216:219], v[112:115], v[80:83]
    v_mfma_f32_16x16x32_bf16 v[84:87], a[220:223], v[112:115], v[84:87]
    s_waitcnt lgkmcnt(2)
    v_mfma_f32_16x16x32_bf16 v[80:83], a[224:227], v[112:115], v[80:83]
    v_mfma_f32_16x16x32_bf16 v[84:87], a[228:231], v[112:115], v[84:87]
    s_waitcnt lgkmcnt(0)
    v_mfma_f32_16x16x32_bf16 v[80:83], a[232:235], v[112:115], v[80:83]
    v_mfma_f32_16x16x32_bf16 v[84:87], a[236:239], v[112:115], v[84:87]
    v_cmp_eq_u32 vcc, 0, v2
    s_nop 1
    s_and_saveexec_b64 s[58:59], vcc
    s_nop 2
    ds_write_b128 v140, v[80:83]
    ds_write_b128 v141, v[84:87]
    s_mov_b64 exec, s[58:59]
    s_waitcnt vmcnt(6) lgkmcnt(0)
    s_add_u32 s55, s55, 4096
    v_mfma_f32_16x16x32_bf16 v[32:35], a[160:163], a[64:67], v[32:35]
    ds_read_b128 a[184:187], v217 offset:22528
    buffer_load_dwordx4 a[96:99], v4, s[28:31], s55 offen offset:0 sc1
    v_mfma_f32_16x16x32_bf16 v[36:39], a[160:163], a[68:71], v[36:39]
    v_mfma_f32_16x16x32_bf16 v[40:43], a[164:167], a[64:67], v[40:43]
    ds_read_b128 a[188:191], v217 offset:23552
    s_add_u32 s56, s56, 4096
    v_mfma_f32_16x16x32_bf16 v[44:47], a[164:167], a[68:71], v[44:47]
    buffer_load_dwordx4 a[100:103], v4, s[28:31], s56 offen offset:0 sc1
    v_mfma_f32_16x16x32_bf16 v[48:51], a[168:171], a[64:67], v[48:51]
    ds_read_b128 a[192:195], v217 offset:24576
    v_mfma_f32_16x16x32_bf16 v[52:55], a[168:171], a[68:71], v[52:55]
    v_mfma_f32_16x16x32_bf16 v[56:59], a[172:175], a[64:67], v[56:59]
    ds_read_b128 a[196:199], v217 offset:25600
    v_mfma_f32_16x16x32_bf16 v[60:63], a[172:175], a[68:71], v[60:63]
    v_mfma_f32_16x16x32_bf16 v[64:67], a[176:179], a[64:67], v[64:67]
    ds_read_b128 a[200:203], v217 offset:26624
    v_mfma_f32_16x16x32_bf16 v[68:71], a[176:179], a[68:71], v[68:71]
    v_mfma_f32_16x16x32_bf16 v[72:75], a[180:183], a[64:67], v[72:75]
    ds_read_b128 a[204:207], v217 offset:27648
    v_mfma_f32_16x16x32_bf16 v[76:79], a[180:183], a[68:71], v[76:79]
    s_waitcnt vmcnt(6) lgkmcnt(0)
    v_mfma_f32_16x16x32_bf16 v[32:35], a[184:187], a[72:75], v[32:35]
    ds_read_b128 a[160:163], v217 offset:28672
    buffer_load_dwordx4 a[104:107], v4, s[28:31], s55 offen offset:1024 sc1
    v_mfma_f32_16x16x32_bf16 v[36:39], a[184:187], a[76:79], v[36:39]
    v_mfma_f32_16x16x32_bf16 v[40:43], a[188:191], a[72:75], v[40:43]
    ds_read_b128 a[164:167], v217 offset:29696
    v_mfma_f32_16x16x32_bf16 v[44:47], a[188:191], a[76:79], v[44:47]
    buffer_load_dwordx4 a[108:111], v4, s[28:31], s56 offen offset:1024 sc1
    v_mfma_f32_16x16x32_bf16 v[48:51], a[192:195], a[72:75], v[48:51]
    ds_read_b128 a[168:171], v217 offset:30720
    v_mfma_f32_16x16x32_bf16 v[52:55], a[192:195], a[76:79], v[52:55]
    v_mfma_f32_16x16x32_bf16 v[56:59], a[196:199], a[72:75], v[56:59]
    ds_read_b128 a[172:175], v217 offset:31744
    v_mfma_f32_16x16x32_bf16 v[60:63], a[196:199], a[76:79], v[60:63]
    v_mfma_f32_16x16x32_bf16 v[64:67], a[200:203], a[72:75], v[64:67]
    ds_read_b128 a[176:179], v217 offset:32768
    v_mfma_f32_16x16x32_bf16 v[68:71], a[200:203], a[76:79], v[68:71]
    v_mfma_f32_16x16x32_bf16 v[72:75], a[204:207], a[72:75], v[72:75]
    ds_read_b128 a[180:183], v217 offset:33792
    v_mfma_f32_16x16x32_bf16 v[76:79], a[204:207], a[76:79], v[76:79]
    s_barrier
    ds_read_b128 v[88:91], v26 offset:0
    ds_read_b128 v[92:95], v26 offset:64
    ds_read_b128 v[96:99], v26 offset:128
    ds_read_b128 v[100:103], v26 offset:192
    ds_read_b128 v[104:107], v26 offset:256
    ds_read_b128 v[108:111], v26 offset:320
    s_waitcnt vmcnt(6) lgkmcnt(0)
    v_mfma_f32_16x16x32_bf16 v[32:35], a[160:163], a[80:83], v[32:35]
    ds_read_b128 a[184:187], v217 offset:34816
    buffer_load_dwordx4 a[112:115], v4, s[28:31], s55 offen offset:2048 sc1
    v_mfma_f32_16x16x32_bf16 v[36:39], a[160:163], a[84:87], v[36:39]
    v_mfma_f32_16x16x32_bf16 v[40:43], a[164:167], a[80:83], v[40:43]
    ds_read_b128 a[188:191], v217 offset:35840
    v_mfma_f32_16x16x32_bf16 v[44:47], a[164:167], a[84:87], v[44:47]
    buffer_load_dwordx4 a[116:119], v4, s[28:31], s56 offen offset:2048 sc1
    v_mfma_f32_16x16x32_bf16 v[48:51], a[168:171], a[80:83], v[48:51]
    ds_read_b128 a[192:195], v217 offset:36864
    v_mfma_f32_16x16x32_bf16 v[52:55], a[168:171], a[84:87], v[52:55]
    s_mul_i32 s100, s36, 12288
    s_add_u32 s101, s100, s92
    s_sub_u32 s101, s101, s93
    s_add_u32 s101, s101, 0x8000
    s_add_u32 s100, s100, 0x8000
    s_add_u32 m0, s100, 0x0
    s_add_u32 s62, s101, 0x0
    v_mfma_f32_16x16x32_bf16 v[56:59], a[172:175], a[80:83], v[56:59]
    ds_read_b128 a[196:199], v217 offset:37888
    buffer_load_dwordx4 v4, s[28:31], s62 offen offset:0 sc1 lds
    v_mfma_f32_16x16x32_bf16 v[60:63], a[172:175], a[84:87], v[60:63]
    v_mfma_f32_16x16x32_bf16 v[64:67], a[176:179], a[80:83], v[64:67]
    ds_read_b128 a[200:203], v217 offset:38912
    v_mfma_f32_16x16x32_bf16 v[68:71], a[176:179], a[84:87], v[68:71]
    v_mfma_f32_16x16x32_bf16 v[72:75], a[180:183], a[80:83], v[72:75]
    ds_read_b128 a[204:207], v217 offset:39936
    v_mfma_f32_16x16x32_bf16 v[76:79], a[180:183], a[84:87], v[76:79]
    s_waitcnt vmcnt(7) lgkmcnt(0)
    v_mfma_f32_16x16x32_bf16 v[32:35], a[184:187], a[88:91], v[32:35]
    ds_read_b128 a[160:163], v217 offset:40960
    buffer_load_dwordx4 a[120:123], v4, s[28:31], s55 offen offset:3072 sc1
    v_mfma_f32_16x16x32_bf16 v[36:39], a[184:187], a[92:95], v[36:39]
    v_mfma_f32_16x16x32_bf16 v[40:43], a[188:191], a[88:91], v[40:43]
    ds_read_b128 a[164:167], v217 offset:41984
    v_mfma_f32_16x16x32_bf16 v[44:47], a[188:191], a[92:95], v[44:47]
    buffer_load_dwordx4 a[124:127], v4, s[28:31], s56 offen offset:3072 sc1
    v_mfma_f32_16x16x32_bf16 v[48:51], a[192:195], a[88:91], v[48:51]
    ds_read_b128 a[168:171], v217 offset:43008
    v_mfma_f32_16x16x32_bf16 v[52:55], a[192:195], a[92:95], v[52:55]
    v_mfma_f32_16x16x32_bf16 v[56:59], a[196:199], a[88:91], v[56:59]
    ds_read_b128 a[172:175], v217 offset:44032
    buffer_load_dwordx4 v[116:119], v25, s[28:31], 0 offen offset:0 sc1
    v_mfma_f32_16x16x32_bf16 v[60:63], a[196:199], a[92:95], v[60:63]
    v_mfma_f32_16x16x32_bf16 v[64:67], a[200:203], a[88:91], v[64:67]
    ds_read_b128 a[176:179], v217 offset:45056
    v_mfma_f32_16x16x32_bf16 v[68:71], a[200:203], a[92:95], v[68:71]
    buffer_load_dwordx4 v[120:123], v25, s[28:31], 0 offen offset:1024 sc1
    v_mfma_f32_16x16x32_bf16 v[72:75], a[204:207], a[88:91], v[72:75]
    ds_read_b128 a[180:183], v217 offset:46080
    v_mfma_f32_16x16x32_bf16 v[76:79], a[204:207], a[92:95], v[76:79]
    buffer_load_dwordx4 v4, s[28:31], s62 offen offset:1024 sc1 lds
    buffer_load_dwordx4 v4, s[28:31], s62 offen offset:2048 sc1 lds
    s_waitcnt vmcnt(11) lgkmcnt(0)
    s_add_u32 s55, s55, 4096
    v_mfma_f32_16x16x32_bf16 v[32:35], a[160:163], a[96:99], v[32:35]
    ds_read_b128 a[184:187], v217 offset:47104
    buffer_load_dwordx4 a[128:131], v4, s[28:31], s55 offen offset:0 sc1
    v_mfma_f32_16x16x32_bf16 v[36:39], a[160:163], a[100:103], v[36:39]
    v_mfma_f32_16x16x32_bf16 v[40:43], a[164:167], a[96:99], v[40:43]
    ds_read_b128 a[188:191], v217 offset:48128
    s_add_u32 s56, s56, 4096
    v_mfma_f32_16x16x32_bf16 v[44:47], a[164:167], a[100:103], v[44:47]
    buffer_load_dwordx4 a[132:135], v4, s[28:31], s56 offen offset:0 sc1
    v_mfma_f32_16x16x32_bf16 v[48:51], a[168:171], a[96:99], v[48:51]
    ds_read_b128 a[192:195], v217 offset:49152
    v_mfma_f32_16x16x32_bf16 v[52:55], a[168:171], a[100:103], v[52:55]
    v_mfma_f32_16x16x32_bf16 v[56:59], a[172:175], a[96:99], v[56:59]
    ds_read_b128 a[196:199], v217 offset:50176
    buffer_load_dwordx4 v4, s[28:31], s62 offen offset:3072 sc1 lds
    v_mfma_f32_16x16x32_bf16 v[60:63], a[172:175], a[100:103], v[60:63]
    v_mfma_f32_16x16x32_bf16 v[64:67], a[176:179], a[96:99], v[64:67]
    ds_read_b128 a[200:203], v217 offset:51200
    v_mfma_f32_16x16x32_bf16 v[68:71], a[176:179], a[100:103], v[68:71]
    v_mfma_f32_16x16x32_bf16 v[72:75], a[180:183], a[96:99], v[72:75]
    ds_read_b128 a[204:207], v217 offset:52224
    v_mfma_f32_16x16x32_bf16 v[76:79], a[180:183], a[100:103], v[76:79]
    s_waitcnt vmcnt(12) lgkmcnt(0)
    v_mfma_f32_16x16x32_bf16 v[32:35], a[184:187], a[104:107], v[32:35]
    ds_read_b128 a[160:163], v217 offset:53248
    buffer_load_dwordx4 a[136:139], v4, s[28:31], s55 offen offset:1024 sc1
    v_mfma_f32_16x16x32_bf16 v[36:39], a[184:187], a[108:111], v[36:39]
    v_mfma_f32_16x16x32_bf16 v[40:43], a[188:191], a[104:107], v[40:43]
    ds_read_b128 a[164:167], v217 offset:54272
    v_mfma_f32_16x16x32_bf16 v[44:47], a[188:191], a[108:111], v[44:47]
    buffer_load_dwordx4 a[140:143], v4, s[28:31], s56 offen offset:1024 sc1
    v_mfma_f32_16x16x32_bf16 v[48:51], a[192:195], a[104:107], v[48:51]
    ds_read_b128 a[168:171], v217 offset:55296
    v_mfma_f32_16x16x32_bf16 v[52:55], a[192:195], a[108:111], v[52:55]
    s_add_u32 m0, s100, 0x1000
    s_add_u32 s62, s101, 0x1000
    v_mfma_f32_16x16x32_bf16 v[56:59], a[196:199], a[104:107], v[56:59]
    ds_read_b128 a[172:175], v217 offset:56320
    buffer_load_dwordx4 v4, s[28:31], s62 offen offset:0 sc1 lds
    v_mfma_f32_16x16x32_bf16 v[60:63], a[196:199], a[108:111], v[60:63]
    v_mfma_f32_16x16x32_bf16 v[64:67], a[200:203], a[104:107], v[64:67]
    ds_read_b128 a[176:179], v217 offset:57344
    v_mfma_f32_16x16x32_bf16 v[68:71], a[200:203], a[108:111], v[68:71]
    buffer_load_dwordx4 v4, s[28:31], s62 offen offset:1024 sc1 lds
    v_mfma_f32_16x16x32_bf16 v[72:75], a[204:207], a[104:107], v[72:75]
    ds_read_b128 a[180:183], v217 offset:58368
    v_mfma_f32_16x16x32_bf16 v[76:79], a[204:207], a[108:111], v[76:79]
    s_waitcnt vmcnt(14) lgkmcnt(0)
    v_mfma_f32_16x16x32_bf16 v[32:35], a[160:163], a[112:115], v[32:35]
    ds_read_b128 a[184:187], v217 offset:59392
    buffer_load_dwordx4 a[144:147], v4, s[28:31], s55 offen offset:2048 sc1
    v_mfma_f32_16x16x32_bf16 v[36:39], a[160:163], a[116:119], v[36:39]
    v_mfma_f32_16x16x32_bf16 v[40:43], a[164:167], a[112:115], v[40:43]
    ds_read_b128 a[188:191], v217 offset:60416
    v_mfma_f32_16x16x32_bf16 v[44:47], a[164:167], a[116:119], v[44:47]
    buffer_load_dwordx4 a[148:151], v4, s[28:31], s56 offen offset:2048 sc1
    v_mfma_f32_16x16x32_bf16 v[48:51], a[168:171], a[112:115], v[48:51]
    ds_read_b128 a[192:195], v217 offset:61440
    v_mfma_f32_16x16x32_bf16 v[52:55], a[168:171], a[116:119], v[52:55]
    v_mfma_f32_16x16x32_bf16 v[56:59], a[172:175], a[112:115], v[56:59]
    ds_read_b128 a[196:199], v217 offset:62464
    buffer_load_dwordx4 v4, s[28:31], s62 offen offset:2048 sc1 lds
    v_mfma_f32_16x16x32_bf16 v[60:63], a[172:175], a[116:119], v[60:63]
    v_mfma_f32_16x16x32_bf16 v[64:67], a[176:179], a[112:115], v[64:67]
    ds_read_b128 a[200:203], v217 offset:63488
    v_mfma_f32_16x16x32_bf16 v[68:71], a[176:179], a[116:119], v[68:71]
    v_mfma_f32_16x16x32_bf16 v[72:75], a[180:183], a[112:115], v[72:75]
    ds_read_b128 a[204:207], v217 offset:64512
    v_mfma_f32_16x16x32_bf16 v[76:79], a[180:183], a[116:119], v[76:79]
    s_waitcnt vmcnt(14) lgkmcnt(0)
    v_mfma_f32_16x16x32_bf16 v[32:35], a[184:187], a[120:123], v[32:35]
    ds_read_b128 a[160:163], v218 offset:0
    buffer_load_dwordx4 a[152:155], v4, s[28:31], s55 offen offset:3072 sc1
    v_mfma_f32_16x16x32_bf16 v[36:39], a[184:187], a[124:127], v[36:39]
    v_mfma_f32_16x16x32_bf16 v[40:43], a[188:191], a[120:123], v[40:43]
    ds_read_b128 a[164:167], v218 offset:1024
    v_mfma_f32_16x16x32_bf16 v[44:47], a[188:191], a[124:127], v[44:47]
    buffer_load_dwordx4 a[156:159], v4, s[28:31], s56 offen offset:3072 sc1
    v_mfma_f32_16x16x32_bf16 v[48:51], a[192:195], a[120:123], v[48:51]
    ds_read_b128 a[168:171], v218 offset:2048
    v_mfma_f32_16x16x32_bf16 v[52:55], a[192:195], a[124:127], v[52:55]
    v_mfma_f32_16x16x32_bf16 v[56:59], a[196:199], a[120:123], v[56:59]
    ds_read_b128 a[172:175], v218 offset:3072
    buffer_load_dwordx4 v4, s[28:31], s62 offen offset:3072 sc1 lds
    v_mfma_f32_16x16x32_bf16 v[60:63], a[196:199], a[124:127], v[60:63]
    v_mfma_f32_16x16x32_bf16 v[64:67], a[200:203], a[120:123], v[64:67]
    ds_read_b128 a[176:179], v218 offset:4096
    s_add_u32 m0, s100, 0x2000
    s_add_u32 s62, s101, 0x2000
    v_mfma_f32_16x16x32_bf16 v[68:71], a[200:203], a[124:127], v[68:71]
    buffer_load_dwordx4 v4, s[28:31], s62 offen offset:0 sc1 lds
    v_mfma_f32_16x16x32_bf16 v[72:75], a[204:207], a[120:123], v[72:75]
    ds_read_b128 a[180:183], v218 offset:5120
    v_mfma_f32_16x16x32_bf16 v[76:79], a[204:207], a[124:127], v[76:79]
    s_waitcnt vmcnt(12) lgkmcnt(0)
    s_waitcnt vmcnt(16)
    v_mfma_f32_16x16x32_bf16 v[32:35], a[160:163], a[128:131], v[32:35]
    ds_read_b128 a[184:187], v218 offset:6144
    buffer_load_dwordx4 v4, s[28:31], s62 offen offset:1024 sc1 lds
    v_add_f32 v116, v116, v118
    v_add_f32 v117, v117, v119
    v_mfma_f32_16x16x32_bf16 v[36:39], a[160:163], a[132:135], v[36:39]
    v_mov_b32 v208, v116
    s_nop 1
    v_permlane16_swap_b32 v116, v208
    v_mfma_f32_16x16x32_bf16 v[40:43], a[164:167], a[128:131], v[40:43]
    ds_read_b128 a[188:191], v218 offset:7168
    v_add_f32 v116, v116, v208
    v_mov_b32 v208, v116
    v_mfma_f32_16x16x32_bf16 v[44:47], a[164:167], a[132:135], v[44:47]
    buffer_load_dwordx4 v4, s[28:31], s62 offen offset:2048 sc1 lds
    v_permlane32_swap_b32 v116, v208
    v_add_f32 v116, v116, v208
    v_mfma_f32_16x16x32_bf16 v[48:51], a[168:171], a[128:131], v[48:51]
    ds_read_b128 a[192:195], v218 offset:8192
    v_mov_b32 v209, v117
    s_nop 1
    v_permlane16_swap_b32 v117, v209
    v_mfma_f32_16x16x32_bf16 v[52:55], a[168:171], a[132:135], v[52:55]
    v_add_f32 v117, v117, v209
    v_mov_b32 v209, v117
    v_mfma_f32_16x16x32_bf16 v[56:59], a[172:175], a[128:131], v[56:59]
    ds_read_b128 a[196:199], v218 offset:9216
    v_permlane32_swap_b32 v117, v209
    v_add_f32 v117, v117, v209
    v_mfma_f32_16x16x32_bf16 v[60:63], a[172:175], a[132:135], v[60:63]
    v_mul_f32 v204, 0xbacccccd, v116
    v_mul_f32 v117, 0x3acccccd, v117
    v_mfma_f32_16x16x32_bf16 v[64:67], a[176:179], a[128:131], v[64:67]
    ds_read_b128 a[200:203], v218 offset:10240
    v_fma_f32 v117, -v204, v204, v117
    v_max_f32 v117, 0, v117
    v_mfma_f32_16x16x32_bf16 v[68:71], a[176:179], a[132:135], v[68:71]
    v_add_f32 v117, 0x3727c5ac, v117
    v_rsq_f32 v205, v117
    v_mfma_f32_16x16x32_bf16 v[72:75], a[180:183], a[128:131], v[72:75]
    ds_read_b128 a[204:207], v218 offset:11264
    v_mfma_f32_16x16x32_bf16 v[76:79], a[180:183], a[132:135], v[76:79]
    s_waitcnt vmcnt(11) lgkmcnt(0)
    v_mfma_f32_16x16x32_bf16 v[32:35], a[184:187], a[136:139], v[32:35]
    ds_read_b128 a[160:163], v218 offset:12288
    buffer_load_dwordx4 v4, s[28:31], s62 offen offset:3072 sc1 lds
    v_add_f32 v120, v120, v122
    v_add_f32 v121, v121, v123
    v_mfma_f32_16x16x32_bf16 v[36:39], a[184:187], a[140:143], v[36:39]
    v_mov_b32 v208, v120
    s_nop 1
    v_permlane16_swap_b32 v120, v208
    v_mfma_f32_16x16x32_bf16 v[40:43], a[188:191], a[136:139], v[40:43]
    ds_read_b128 a[164:167], v218 offset:13312
    v_add_f32 v120, v120, v208
    v_mov_b32 v208, v120
    v_mfma_f32_16x16x32_bf16 v[44:47], a[188:191], a[140:143], v[44:47]
    s_nop 0
    v_permlane32_swap_b32 v120, v208
    v_add_f32 v120, v120, v208
    v_mfma_f32_16x16x32_bf16 v[48:51], a[192:195], a[136:139], v[48:51]
    ds_read_b128 a[168:171], v218 offset:14336
    v_mov_b32 v209, v121
    s_nop 1
    v_permlane16_swap_b32 v121, v209
    v_mfma_f32_16x16x32_bf16 v[52:55], a[192:195], a[140:143], v[52:55]
    v_add_f32 v121, v121, v209
    v_mov_b32 v209, v121
    v_mfma_f32_16x16x32_bf16 v[56:59], a[196:199], a[136:139], v[56:59]
    ds_read_b128 a[172:175], v218 offset:15360
    v_permlane32_swap_b32 v121, v209
    v_add_f32 v121, v121, v209
    v_mfma_f32_16x16x32_bf16 v[60:63], a[196:199], a[140:143], v[60:63]
    v_mul_f32 v206, 0xbacccccd, v120
    v_mul_f32 v121, 0x3acccccd, v121
    v_mfma_f32_16x16x32_bf16 v[64:67], a[200:203], a[136:139], v[64:67]
    ds_read_b128 a[176:179], v218 offset:16384
    v_fma_f32 v121, -v206, v206, v121
    v_max_f32 v121, 0, v121
    v_mfma_f32_16x16x32_bf16 v[68:71], a[200:203], a[140:143], v[68:71]
    v_add_f32 v121, 0x3727c5ac, v121
    v_rsq_f32 v207, v121
    v_mfma_f32_16x16x32_bf16 v[72:75], a[204:207], a[136:139], v[72:75]
    ds_read_b128 a[180:183], v218 offset:17408
    v_mfma_f32_16x16x32_bf16 v[76:79], a[204:207], a[140:143], v[76:79]
    s_waitcnt vmcnt(8) lgkmcnt(0)
    v_mfma_f32_16x16x32_bf16 v[32:35], a[160:163], a[144:147], v[32:35]
    ds_read_b128 a[184:187], v218 offset:18432
    s_mul_i32 s64, s88, 49152
    s_mul_i32 s65, s40, 3072
    v_mfma_f32_16x16x32_bf16 v[36:39], a[160:163], a[148:151], v[36:39]
    s_add_u32 s64, s64, s65
    s_add_u32 s64, s64, 0xf00000
    v_mfma_f32_16x16x32_bf16 v[40:43], a[164:167], a[144:147], v[40:43]
    ds_read_b128 a[188:191], v218 offset:19456
    s_add_u32 s65, s64, 49152
    s_mov_b32 s56, 0xbfb8aa3b
    v_mfma_f32_16x16x32_bf16 v[44:47], a[164:167], a[148:151], v[44:47]
    s_mov_b32 s57, s56
    v_mfma_f32_16x16x32_bf16 v[48:51], a[168:171], a[144:147], v[48:51]
    ds_read_b128 a[192:195], v218 offset:20480
    v_mfma_f32_16x16x32_bf16 v[52:55], a[168:171], a[148:151], v[52:55]
    v_mfma_f32_16x16x32_bf16 v[56:59], a[172:175], a[144:147], v[56:59]
    ds_read_b128 a[196:199], v218 offset:21504
    v_mfma_f32_16x16x32_bf16 v[60:63], a[172:175], a[148:151], v[60:63]
    v_mfma_f32_16x16x32_bf16 v[64:67], a[176:179], a[144:147], v[64:67]
    ds_read_b128 a[200:203], v218 offset:22528
    v_mfma_f32_16x16x32_bf16 v[68:71], a[176:179], a[148:151], v[68:71]
    v_mfma_f32_16x16x32_bf16 v[72:75], a[180:183], a[144:147], v[72:75]
    ds_read_b128 a[204:207], v218 offset:23552
    v_mfma_f32_16x16x32_bf16 v[76:79], a[180:183], a[148:151], v[76:79]
    s_waitcnt vmcnt(5) lgkmcnt(0)
    v_mfma_f32_16x16x32_bf16 v[32:35], a[184:187], a[152:155], v[32:35]
    v_mfma_f32_16x16x32_bf16 v[36:39], a[184:187], a[156:159], v[36:39]
    v_mfma_f32_16x16x32_bf16 v[40:43], a[188:191], a[152:155], v[40:43]
    v_mfma_f32_16x16x32_bf16 v[44:47], a[188:191], a[156:159], v[44:47]
    v_mfma_f32_16x16x32_bf16 v[48:51], a[192:195], a[152:155], v[48:51]
    v_mfma_f32_16x16x32_bf16 v[52:55], a[192:195], a[156:159], v[52:55]
    v_mfma_f32_16x16x32_bf16 v[56:59], a[196:199], a[152:155], v[56:59]
    v_mfma_f32_16x16x32_bf16 v[60:63], a[196:199], a[156:159], v[60:63]
    v_mfma_f32_16x16x32_bf16 v[64:67], a[200:203], a[152:155], v[64:67]
    v_mfma_f32_16x16x32_bf16 v[68:71], a[200:203], a[156:159], v[68:71]
    v_mfma_f32_16x16x32_bf16 v[72:75], a[204:207], a[152:155], v[72:75]
    v_mfma_f32_16x16x32_bf16 v[76:79], a[204:207], a[156:159], v[76:79]
    s_barrier
    v_pk_fma_f32 v[32:33], v[88:89], v[204:205], v[32:33] op_sel_hi:[1,0,1]
    v_pk_fma_f32 v[34:35], v[90:91], v[204:205], v[34:35] op_sel_hi:[1,0,1]
    v_pk_fma_f32 v[40:41], v[92:93], v[204:205], v[40:41] op_sel_hi:[1,0,1]
    v_pk_fma_f32 v[42:43], v[94:95], v[204:205], v[42:43] op_sel_hi:[1,0,1]
    v_pk_mul_f32 v[32:33], v[32:33], v[204:205] op_sel:[0,1] op_sel_hi:[1,1]
    v_pk_mul_f32 v[34:35], v[34:35], v[204:205] op_sel:[0,1] op_sel_hi:[1,1]
    v_pk_mul_f32 v[40:41], v[40:41], v[204:205] op_sel:[0,1] op_sel_hi:[1,1]
    v_pk_mul_f32 v[42:43], v[42:43], v[204:205] op_sel:[0,1] op_sel_hi:[1,1]
    v_pk_mul_f32 v[208:209], v[32:33], s[56:57]
    v_pk_mul_f32 v[210:211], v[34:35], s[56:57]
    v_pk_mul_f32 v[212:213], v[40:41], s[56:57]
    v_pk_mul_f32 v[214:215], v[42:43], s[56:57]
    v_exp_f32 v208, v208
    v_exp_f32 v209, v209
    v_exp_f32 v210, v210
    v_exp_f32 v211, v211
    v_exp_f32 v212, v212
    v_exp_f32 v213, v213
    v_exp_f32 v214, v214
    v_exp_f32 v215, v215
    v_pk_add_f32 v[208:209], v[208:209], 1.0 op_sel_hi:[1,0]
    v_pk_add_f32 v[210:211], v[210:211], 1.0 op_sel_hi:[1,0]
    v_pk_add_f32 v[212:213], v[212:213], 1.0 op_sel_hi:[1,0]
    v_pk_add_f32 v[214:215], v[214:215], 1.0 op_sel_hi:[1,0]
    v_rcp_f32 v208, v208
    v_rcp_f32 v209, v209
    v_rcp_f32 v210, v210
    v_rcp_f32 v211, v211
    v_rcp_f32 v212, v212
    v_rcp_f32 v213, v213
    v_rcp_f32 v214, v214
    v_rcp_f32 v215, v215
    v_pk_mul_f32 v[32:33], v[32:33], v[208:209]
    v_pk_mul_f32 v[34:35], v[34:35], v[210:211]
    v_pk_mul_f32 v[40:41], v[40:41], v[212:213]
    v_pk_mul_f32 v[42:43], v[42:43], v[214:215]
    v_cvt_pk_bf16_f32 v124, v32, v33
    v_cvt_pk_bf16_f32 v125, v34, v35
    v_cvt_pk_bf16_f32 v126, v40, v41
    v_cvt_pk_bf16_f32 v127, v42, v43
    s_mul_i32 s100, s36, 20480
    s_add_u32 s101, s100, s92
    s_sub_u32 s101, s101, s93
    s_add_u32 s101, s101, 0x14000
    s_add_u32 s100, s100, 0x14000
    s_add_u32 m0, s100, 0x0
    s_add_u32 s62, s101, 0x0
    buffer_load_dwordx4 v4, s[28:31], s62 offen offset:0 sc1 lds
    buffer_load_dwordx4 v4, s[28:31], s62 offen offset:1024 sc1 lds
    buffer_store_dwordx4 v[124:127], v4, s[28:31], s64 offen offset:0 sc1
    v_pk_fma_f32 v[48:49], v[96:97], v[204:205], v[48:49] op_sel_hi:[1,0,1]
    v_pk_fma_f32 v[50:51], v[98:99], v[204:205], v[50:51] op_sel_hi:[1,0,1]
    v_pk_fma_f32 v[56:57], v[100:101], v[204:205], v[56:57] op_sel_hi:[1,0,1]
    v_pk_fma_f32 v[58:59], v[102:103], v[204:205], v[58:59] op_sel_hi:[1,0,1]
    v_pk_mul_f32 v[48:49], v[48:49], v[204:205] op_sel:[0,1] op_sel_hi:[1,1]
    v_pk_mul_f32 v[50:51], v[50:51], v[204:205] op_sel:[0,1] op_sel_hi:[1,1]
    v_pk_mul_f32 v[56:57], v[56:57], v[204:205] op_sel:[0,1] op_sel_hi:[1,1]
    v_pk_mul_f32 v[58:59], v[58:59], v[204:205] op_sel:[0,1] op_sel_hi:[1,1]
    v_pk_mul_f32 v[208:209], v[48:49], s[56:57]
    v_pk_mul_f32 v[210:211], v[50:51], s[56:57]
    v_pk_mul_f32 v[212:213], v[56:57], s[56:57]
    v_pk_mul_f32 v[214:215], v[58:59], s[56:57]
    v_exp_f32 v208, v208
    v_exp_f32 v209, v209
    v_exp_f32 v210, v210
    v_exp_f32 v211, v211
    v_exp_f32 v212, v212
    v_exp_f32 v213, v213
    v_exp_f32 v214, v214
    v_exp_f32 v215, v215
    v_pk_add_f32 v[208:209], v[208:209], 1.0 op_sel_hi:[1,0]
    v_pk_add_f32 v[210:211], v[210:211], 1.0 op_sel_hi:[1,0]
    v_pk_add_f32 v[212:213], v[212:213], 1.0 op_sel_hi:[1,0]
    v_pk_add_f32 v[214:215], v[214:215], 1.0 op_sel_hi:[1,0]
    v_rcp_f32 v208, v208
    v_rcp_f32 v209, v209
    v_rcp_f32 v210, v210
    v_rcp_f32 v211, v211
    v_rcp_f32 v212, v212
    v_rcp_f32 v213, v213
    v_rcp_f32 v214, v214
    v_rcp_f32 v215, v215
    v_pk_mul_f32 v[48:49], v[48:49], v[208:209]
    v_pk_mul_f32 v[50:51], v[50:51], v[210:211]
    v_pk_mul_f32 v[56:57], v[56:57], v[212:213]
    v_pk_mul_f32 v[58:59], v[58:59], v[214:215]
    v_cvt_pk_bf16_f32 v128, v48, v49
    v_cvt_pk_bf16_f32 v129, v50, v51
    v_cvt_pk_bf16_f32 v130, v56, v57
    v_cvt_pk_bf16_f32 v131, v58, v59
    buffer_load_dwordx4 v4, s[28:31], s62 offen offset:2048 sc1 lds
    buffer_load_dwordx4 v4, s[28:31], s62 offen offset:3072 sc1 lds
    buffer_store_dwordx4 v[128:131], v4, s[28:31], s64 offen offset:1024 sc1
    v_pk_fma_f32 v[64:65], v[104:105], v[204:205], v[64:65] op_sel_hi:[1,0,1]
    v_pk_fma_f32 v[66:67], v[106:107], v[204:205], v[66:67] op_sel_hi:[1,0,1]
    v_pk_fma_f32 v[72:73], v[108:109], v[204:205], v[72:73] op_sel_hi:[1,0,1]
    v_pk_fma_f32 v[74:75], v[110:111], v[204:205], v[74:75] op_sel_hi:[1,0,1]
    v_pk_mul_f32 v[64:65], v[64:65], v[204:205] op_sel:[0,1] op_sel_hi:[1,1]
    v_pk_mul_f32 v[66:67], v[66:67], v[204:205] op_sel:[0,1] op_sel_hi:[1,1]
    v_pk_mul_f32 v[72:73], v[72:73], v[204:205] op_sel:[0,1] op_sel_hi:[1,1]
    v_pk_mul_f32 v[74:75], v[74:75], v[204:205] op_sel:[0,1] op_sel_hi:[1,1]
    v_pk_mul_f32 v[208:209], v[64:65], s[56:57]
    v_pk_mul_f32 v[210:211], v[66:67], s[56:57]
    v_pk_mul_f32 v[212:213], v[72:73], s[56:57]
    v_pk_mul_f32 v[214:215], v[74:75], s[56:57]
    v_exp_f32 v208, v208
    v_exp_f32 v209, v209
    v_exp_f32 v210, v210
    v_exp_f32 v211, v211
    v_exp_f32 v212, v212
    v_exp_f32 v213, v213
    v_exp_f32 v214, v214
    v_exp_f32 v215, v215
    v_pk_add_f32 v[208:209], v[208:209], 1.0 op_sel_hi:[1,0]
    v_pk_add_f32 v[210:211], v[210:211], 1.0 op_sel_hi:[1,0]
    v_pk_add_f32 v[212:213], v[212:213], 1.0 op_sel_hi:[1,0]
    v_pk_add_f32 v[214:215], v[214:215], 1.0 op_sel_hi:[1,0]
    v_rcp_f32 v208, v208
    v_rcp_f32 v209, v209
    v_rcp_f32 v210, v210
    v_rcp_f32 v211, v211
    v_rcp_f32 v212, v212
    v_rcp_f32 v213, v213
    v_rcp_f32 v214, v214
    v_rcp_f32 v215, v215
    v_pk_mul_f32 v[64:65], v[64:65], v[208:209]
    v_pk_mul_f32 v[66:67], v[66:67], v[210:211]
    v_pk_mul_f32 v[72:73], v[72:73], v[212:213]
    v_pk_mul_f32 v[74:75], v[74:75], v[214:215]
    v_cvt_pk_bf16_f32 v132, v64, v65
    v_cvt_pk_bf16_f32 v133, v66, v67
    v_cvt_pk_bf16_f32 v134, v72, v73
    v_cvt_pk_bf16_f32 v135, v74, v75
    s_add_u32 m0, s100, 0x1000
    s_add_u32 s62, s101, 0x1000
    buffer_load_dwordx4 v4, s[28:31], s62 offen offset:0 sc1 lds
    buffer_load_dwordx4 v4, s[28:31], s62 offen offset:1024 sc1 lds
    buffer_store_dwordx4 v[132:135], v4, s[28:31], s64 offen offset:2048 sc1
    v_pk_fma_f32 v[36:37], v[88:89], v[206:207], v[36:37] op_sel_hi:[1,0,1]
    v_pk_fma_f32 v[38:39], v[90:91], v[206:207], v[38:39] op_sel_hi:[1,0,1]
    v_pk_fma_f32 v[44:45], v[92:93], v[206:207], v[44:45] op_sel_hi:[1,0,1]
    v_pk_fma_f32 v[46:47], v[94:95], v[206:207], v[46:47] op_sel_hi:[1,0,1]
    v_pk_mul_f32 v[36:37], v[36:37], v[206:207] op_sel:[0,1] op_sel_hi:[1,1]
    v_pk_mul_f32 v[38:39], v[38:39], v[206:207] op_sel:[0,1] op_sel_hi:[1,1]
    v_pk_mul_f32 v[44:45], v[44:45], v[206:207] op_sel:[0,1] op_sel_hi:[1,1]
    v_pk_mul_f32 v[46:47], v[46:47], v[206:207] op_sel:[0,1] op_sel_hi:[1,1]
    v_pk_mul_f32 v[208:209], v[36:37], s[56:57]
    v_pk_mul_f32 v[210:211], v[38:39], s[56:57]
    v_pk_mul_f32 v[212:213], v[44:45], s[56:57]
    v_pk_mul_f32 v[214:215], v[46:47], s[56:57]
    v_exp_f32 v208, v208
    v_exp_f32 v209, v209
    v_exp_f32 v210, v210
    v_exp_f32 v211, v211
    v_exp_f32 v212, v212
    v_exp_f32 v213, v213
    v_exp_f32 v214, v214
    v_exp_f32 v215, v215
    v_pk_add_f32 v[208:209], v[208:209], 1.0 op_sel_hi:[1,0]
    v_pk_add_f32 v[210:211], v[210:211], 1.0 op_sel_hi:[1,0]
    v_pk_add_f32 v[212:213], v[212:213], 1.0 op_sel_hi:[1,0]
    v_pk_add_f32 v[214:215], v[214:215], 1.0 op_sel_hi:[1,0]
    v_rcp_f32 v208, v208
    v_rcp_f32 v209, v209
    v_rcp_f32 v210, v210
    v_rcp_f32 v211, v211
    v_rcp_f32 v212, v212
    v_rcp_f32 v213, v213
    v_rcp_f32 v214, v214
    v_rcp_f32 v215, v215
    v_pk_mul_f32 v[36:37], v[36:37], v[208:209]
    v_pk_mul_f32 v[38:39], v[38:39], v[210:211]
    v_pk_mul_f32 v[44:45], v[44:45], v[212:213]
    v_pk_mul_f32 v[46:47], v[46:47], v[214:215]
    v_cvt_pk_bf16_f32 v136, v36, v37
    v_cvt_pk_bf16_f32 v137, v38, v39
    v_cvt_pk_bf16_f32 v138, v44, v45
    v_cvt_pk_bf16_f32 v139, v46, v47
    buffer_load_dwordx4 v4, s[28:31], s62 offen offset:2048 sc1 lds
    buffer_load_dwordx4 v4, s[28:31], s62 offen offset:3072 sc1 lds
    buffer_store_dwordx4 v[136:139], v4, s[28:31], s65 offen offset:0 sc1
    v_pk_fma_f32 v[52:53], v[96:97], v[206:207], v[52:53] op_sel_hi:[1,0,1]
    v_pk_fma_f32 v[54:55], v[98:99], v[206:207], v[54:55] op_sel_hi:[1,0,1]
    v_pk_fma_f32 v[60:61], v[100:101], v[206:207], v[60:61] op_sel_hi:[1,0,1]
    v_pk_fma_f32 v[62:63], v[102:103], v[206:207], v[62:63] op_sel_hi:[1,0,1]
    v_pk_mul_f32 v[52:53], v[52:53], v[206:207] op_sel:[0,1] op_sel_hi:[1,1]
    v_pk_mul_f32 v[54:55], v[54:55], v[206:207] op_sel:[0,1] op_sel_hi:[1,1]
    v_pk_mul_f32 v[60:61], v[60:61], v[206:207] op_sel:[0,1] op_sel_hi:[1,1]
    v_pk_mul_f32 v[62:63], v[62:63], v[206:207] op_sel:[0,1] op_sel_hi:[1,1]
    v_pk_mul_f32 v[208:209], v[52:53], s[56:57]
    v_pk_mul_f32 v[210:211], v[54:55], s[56:57]
    v_pk_mul_f32 v[212:213], v[60:61], s[56:57]
    v_pk_mul_f32 v[214:215], v[62:63], s[56:57]
    v_exp_f32 v208, v208
    v_exp_f32 v209, v209
    v_exp_f32 v210, v210
    v_exp_f32 v211, v211
    v_exp_f32 v212, v212
    v_exp_f32 v213, v213
    v_exp_f32 v214, v214
    v_exp_f32 v215, v215
    v_pk_add_f32 v[208:209], v[208:209], 1.0 op_sel_hi:[1,0]
    v_pk_add_f32 v[210:211], v[210:211], 1.0 op_sel_hi:[1,0]
    v_pk_add_f32 v[212:213], v[212:213], 1.0 op_sel_hi:[1,0]
    v_pk_add_f32 v[214:215], v[214:215], 1.0 op_sel_hi:[1,0]
    v_rcp_f32 v208, v208
    v_rcp_f32 v209, v209
    v_rcp_f32 v210, v210
    v_rcp_f32 v211, v211
    v_rcp_f32 v212, v212
    v_rcp_f32 v213, v213
    v_rcp_f32 v214, v214
    v_rcp_f32 v215, v215
    v_pk_mul_f32 v[52:53], v[52:53], v[208:209]
    v_pk_mul_f32 v[54:55], v[54:55], v[210:211]
    v_pk_mul_f32 v[60:61], v[60:61], v[212:213]
    v_pk_mul_f32 v[62:63], v[62:63], v[214:215]
    v_cvt_pk_bf16_f32 v124, v52, v53
    v_cvt_pk_bf16_f32 v125, v54, v55
    v_cvt_pk_bf16_f32 v126, v60, v61
    v_cvt_pk_bf16_f32 v127, v62, v63
    s_add_u32 m0, s100, 0x2000
    s_add_u32 s62, s101, 0x2000
    buffer_load_dwordx4 v4, s[28:31], s62 offen offset:0 sc1 lds
    buffer_load_dwordx4 v4, s[28:31], s62 offen offset:1024 sc1 lds
    buffer_store_dwordx4 v[124:127], v4, s[28:31], s65 offen offset:1024 sc1
    v_pk_fma_f32 v[68:69], v[104:105], v[206:207], v[68:69] op_sel_hi:[1,0,1]
    v_pk_fma_f32 v[70:71], v[106:107], v[206:207], v[70:71] op_sel_hi:[1,0,1]
    v_pk_fma_f32 v[76:77], v[108:109], v[206:207], v[76:77] op_sel_hi:[1,0,1]
    v_pk_fma_f32 v[78:79], v[110:111], v[206:207], v[78:79] op_sel_hi:[1,0,1]
    v_pk_mul_f32 v[68:69], v[68:69], v[206:207] op_sel:[0,1] op_sel_hi:[1,1]
    v_pk_mul_f32 v[70:71], v[70:71], v[206:207] op_sel:[0,1] op_sel_hi:[1,1]
    v_pk_mul_f32 v[76:77], v[76:77], v[206:207] op_sel:[0,1] op_sel_hi:[1,1]
    v_pk_mul_f32 v[78:79], v[78:79], v[206:207] op_sel:[0,1] op_sel_hi:[1,1]
    v_pk_mul_f32 v[208:209], v[68:69], s[56:57]
    v_pk_mul_f32 v[210:211], v[70:71], s[56:57]
    v_pk_mul_f32 v[212:213], v[76:77], s[56:57]
    v_pk_mul_f32 v[214:215], v[78:79], s[56:57]
    v_exp_f32 v208, v208
    v_exp_f32 v209, v209
    v_exp_f32 v210, v210
    v_exp_f32 v211, v211
    v_exp_f32 v212, v212
    v_exp_f32 v213, v213
    v_exp_f32 v214, v214
    v_exp_f32 v215, v215
    v_pk_add_f32 v[208:209], v[208:209], 1.0 op_sel_hi:[1,0]
    v_pk_add_f32 v[210:211], v[210:211], 1.0 op_sel_hi:[1,0]
    v_pk_add_f32 v[212:213], v[212:213], 1.0 op_sel_hi:[1,0]
    v_pk_add_f32 v[214:215], v[214:215], 1.0 op_sel_hi:[1,0]
    v_rcp_f32 v208, v208
    v_rcp_f32 v209, v209
    v_rcp_f32 v210, v210
    v_rcp_f32 v211, v211
    v_rcp_f32 v212, v212
    v_rcp_f32 v213, v213
    v_rcp_f32 v214, v214
    v_rcp_f32 v215, v215
    v_pk_mul_f32 v[68:69], v[68:69], v[208:209]
    v_pk_mul_f32 v[70:71], v[70:71], v[210:211]
    v_pk_mul_f32 v[76:77], v[76:77], v[212:213]
    v_pk_mul_f32 v[78:79], v[78:79], v[214:215]
    v_cvt_pk_bf16_f32 v128, v68, v69
    v_cvt_pk_bf16_f32 v129, v70, v71
    v_cvt_pk_bf16_f32 v130, v76, v77
    v_cvt_pk_bf16_f32 v131, v78, v79
    buffer_load_dwordx4 v4, s[28:31], s62 offen offset:2048 sc1 lds
    buffer_load_dwordx4 v4, s[28:31], s62 offen offset:3072 sc1 lds
    buffer_store_dwordx4 v[128:131], v4, s[28:31], s65 offen offset:2048 sc1
    v_mov_b32 v32, 0
    v_mov_b32 v33, 0
    v_mov_b32 v34, 0
    v_mov_b32 v35, 0
    v_mov_b32 v36, 0
    v_mov_b32 v37, 0
    v_mov_b32 v38, 0
    v_mov_b32 v39, 0
    v_mov_b32 v40, 0
    v_mov_b32 v41, 0
    v_mov_b32 v42, 0
    v_mov_b32 v43, 0
    v_mov_b32 v44, 0
    v_mov_b32 v45, 0
    v_mov_b32 v46, 0
    v_mov_b32 v47, 0
    v_mov_b32 v48, 0
    v_mov_b32 v49, 0
    v_mov_b32 v50, 0
    v_mov_b32 v51, 0
    s_add_u32 m0, s100, 0x3000
    s_add_u32 s62, s101, 0x3000
    buffer_load_dwordx4 v4, s[28:31], s62 offen offset:0 sc1 lds
    buffer_load_dwordx4 v4, s[28:31], s62 offen offset:1024 sc1 lds
    buffer_load_dwordx4 v4, s[28:31], s62 offen offset:2048 sc1 lds
    buffer_load_dwordx4 v4, s[28:31], s62 offen offset:3072 sc1 lds
    s_add_u32 m0, s100, 0x4000
    s_add_u32 s62, s101, 0x4000
    buffer_load_dwordx4 v4, s[28:31], s62 offen offset:0 sc1 lds
    buffer_load_dwordx4 v4, s[28:31], s62 offen offset:1024 sc1 lds
    buffer_load_dwordx4 v4, s[28:31], s62 offen offset:2048 sc1 lds
    buffer_load_dwordx4 v4, s[28:31], s62 offen offset:3072 sc1 lds
    s_waitcnt vmcnt(8)
    s_barrier
    s_cmp_eq_u32 s36, 0
    s_cbranch_scc1 H2_38
    s_branch H3_39
H2_38:
    s_lshl_b32 s52, s39, 4
    s_add_u32 s52, s52, s40
    s_lshl_b32 s44, s52, 6
    s_add_u32 s44, s44, 0xc000
    v_mov_b32 v212, s42
    v_mov_b32 v213, s43
    v_mov_b32 v214, s44
    s_mov_b64 exec, 1
    s_cmp_lg_u32 s99, 0
    s_cbranch_scc1 DF_41
    buffer_store_dwordx2 v[212:213], v214, s[28:31], 0 offen sc1
    s_branch DJ_42
DF_41:
    buffer_store_dwordx2 v[212:213], v214, s[28:31], 0 offen
DJ_42:
    s_mov_b64 exec, -1
FS_40:
    s_lshl_b32 s52, s39, 10
    s_add_u32 s52, s52, 0xc000
    v_lshlrev_b32 v212, 6, v2
    v_add_u32 v212, s52, v212
    s_mov_b32 s44, 0
PL_43:
    buffer_load_dwordx2 v[214:215], v212, s[28:31], 0 offen offset:0 sc1
    s_waitcnt vmcnt(0)
    v_cmp_eq_u32 s[46:47], s42, v214
    v_cmp_eq_u32 s[48:49], s43, v215
    s_nop 1
    s_and_b64 s[46:47], s[46:47], s[48:49]
    s_mov_b64 s[50:51], s[46:47]
    s_cmp_eq_u64 s[50:51], -1
    s_cbranch_scc1 PD_44
    s_add_u32 s44, s44, 1
    s_cmp_gt_u32 s44, 20000
    s_cbranch_scc0 PL_43
    s_mov_b32 s63, 1
PD_44:
H3_39:
    s_waitcnt vmcnt(0)
    s_barrier
    s_mul_i32 s54, s86, 49152
    s_add_u32 s54, s54, 0xf00000
    buffer_load_dwordx4 a[0:3], v4, s[28:31], s54 offen offset:0 sc1
    buffer_load_dwordx4 a[4:7], v4, s[28:31], s54 offen offset:1024 sc1
    buffer_load_dwordx4 a[8:11], v4, s[28:31], s54 offen offset:2048 sc1
    buffer_load_dwordx4 a[12:15], v4, s[28:31], s54 offen offset:3072 sc1
    s_add_u32 s54, s54, 4096
    buffer_load_dwordx4 a[16:19], v4, s[28:31], s54 offen offset:0 sc1
    buffer_load_dwordx4 a[20:23], v4, s[28:31], s54 offen offset:1024 sc1
    buffer_load_dwordx4 a[24:27], v4, s[28:31], s54 offen offset:2048 sc1
    buffer_load_dwordx4 a[28:31], v4, s[28:31], s54 offen offset:3072 sc1
    s_add_u32 s54, s54, 4096
    buffer_load_dwordx4 a[32:35], v4, s[28:31], s54 offen offset:0 sc1
    ds_read_b128 a[192:195], v216 offset:0
    ds_read_b128 a[196:199], v216 offset:1024
    ds_read_b128 a[200:203], v216 offset:2048
    ds_read_b128 a[204:207], v216 offset:3072
    ds_read_b128 a[208:211], v216 offset:4096
    ds_read_b128 a[212:215], v216 offset:5120
    ds_read_b128 a[216:219], v216 offset:6144
    ds_read_b128 a[220:223], v216 offset:7168
    ds_read_b128 a[224:227], v216 offset:8192
    ds_read_b128 a[228:231], v216 offset:9216
    s_waitcnt vmcnt(8) lgkmcnt(5)
    v_mfma_f32_16x16x32_bf16 v[32:35], a[192:195], a[0:3], v[32:35]
    ds_read_b128 a[232:235], v216 offset:10240
    buffer_load_dwordx4 a[36:39], v4, s[28:31], s54 offen offset:1024 sc1
    v_mfma_f32_16x16x32_bf16 v[36:39], a[196:199], a[0:3], v[36:39]
    ds_read_b128 a[236:239], v216 offset:11264
    v_mfma_f32_16x16x32_bf16 v[40:43], a[200:203], a[0:3], v[40:43]
    ds_read_b128 a[240:243], v216 offset:12288
    v_mfma_f32_16x16x32_bf16 v[44:47], a[204:207], a[0:3], v[44:47]
    ds_read_b128 a[244:247], v216 offset:13312
    v_mfma_f32_16x16x32_bf16 v[48:51], a[208:211], a[0:3], v[48:51]
    ds_read_b128 a[248:251], v216 offset:14336
    s_waitcnt vmcnt(8) lgkmcnt(5)
    v_mfma_f32_16x16x32_bf16 v[32:35], a[212:215], a[4:7], v[32:35]
    ds_read_b128 a[192:195], v216 offset:15360
    buffer_load_dwordx4 a[40:43], v4, s[28:31], s54 offen offset:2048 sc1
    v_mfma_f32_16x16x32_bf16 v[36:39], a[216:219], a[4:7], v[36:39]
    ds_read_b128 a[196:199], v216 offset:16384
    v_mfma_f32_16x16x32_bf16 v[40:43], a[220:223], a[4:7], v[40:43]
    ds_read_b128 a[200:203], v216 offset:17408
    v_mfma_f32_16x16x32_bf16 v[44:47], a[224:227], a[4:7], v[44:47]
    ds_read_b128 a[204:207], v216 offset:18432
    v_mfma_f32_16x16x32_bf16 v[48:51], a[228:231], a[4:7], v[48:51]
    ds_read_b128 a[208:211], v216 offset:19456
    s_waitcnt vmcnt(8) lgkmcnt(5)
    v_mfma_f32_16x16x32_bf16 v[32:35], a[232:235], a[8:11], v[32:35]
    ds_read_b128 a[212:215], v216 offset:20480
    buffer_load_dwordx4 a[44:47], v4, s[28:31], s54 offen offset:3072 sc1
    v_mfma_f32_16x16x32_bf16 v[36:39], a[236:239], a[8:11], v[36:39]
    ds_read_b128 a[216:219], v216 offset:21504
    v_mfma_f32_16x16x32_bf16 v[40:43], a[240:243], a[8:11], v[40:43]
    ds_read_b128 a[220:223], v216 offset:22528
    v_mfma_f32_16x16x32_bf16 v[44:47], a[244:247], a[8:11], v[44:47]
    ds_read_b128 a[224:227], v216 offset:23552
    v_mfma_f32_16x16x32_bf16 v[48:51], a[248:251], a[8:11], v[48:51]
    ds_read_b128 a[228:231], v216 offset:24576
    s_waitcnt vmcnt(8) lgkmcnt(5)
    s_add_u32 s54, s54, 4096
    v_mfma_f32_16x16x32_bf16 v[32:35], a[192:195], a[12:15], v[32:35]
    ds_read_b128 a[232:235], v216 offset:25600
    buffer_load_dwordx4 a[48:51], v4, s[28:31], s54 offen offset:0 sc1
    v_mfma_f32_16x16x32_bf16 v[36:39], a[196:199], a[12:15], v[36:39]
    ds_read_b128 a[236:239], v216 offset:26624
    v_mfma_f32_16x16x32_bf16 v[40:43], a[200:203], a[12:15], v[40:43]
    ds_read_b128 a[240:243], v216 offset:27648
    v_mfma_f32_16x16x32_bf16 v[44:47], a[204:207], a[12:15], v[44:47]
    ds_read_b128 a[244:247], v216 offset:28672
    v_mfma_f32_16x16x32_bf16 v[48:51], a[208:211], a[12:15], v[48:51]
    ds_read_b128 a[248:251], v216 offset:29696
    s_waitcnt vmcnt(8) lgkmcnt(5)
    v_mfma_f32_16x16x32_bf16 v[32:35], a[212:215], a[16:19], v[32:35]
    ds_read_b128 a[192:195], v216 offset:30720
    buffer_load_dwordx4 a[52:55], v4, s[28:31], s54 offen offset:1024 sc1
    v_mfma_f32_16x16x32_bf16 v[36:39], a[216:219], a[16:19], v[36:39]
    ds_read_b128 a[196:199], v216 offset:31744
    v_mfma_f32_16x16x32_bf16 v[40:43], a[220:223], a[16:19], v[40:43]
    ds_read_b128 a[200:203], v216 offset:32768
    v_mfma_f32_16x16x32_bf16 v[44:47], a[224:227], a[16:19], v[44:47]
    ds_read_b128 a[204:207], v216 offset:33792
    v_mfma_f32_16x16x32_bf16 v[48:51], a[228:231], a[16:19], v[48:51]
    ds_read_b128 a[208:211], v216 offset:34816
    s_waitcnt vmcnt(8) lgkmcnt(5)
    v_mfma_f32_16x16x32_bf16 v[32:35], a[232:235], a[20:23], v[32:35]
    ds_read_b128 a[212:215], v216 offset:35840
    buffer_load_dwordx4 a[56:59], v4, s[28:31], s54 offen offset:2048 sc1
    v_mfma_f32_16x16x32_bf16 v[36:39], a[236:239], a[20:23], v[36:39]
    ds_read_b128 a[216:219], v216 offset:36864
    v_mfma_f32_16x16x32_bf16 v[40:43], a[240:243], a[20:23], v[40:43]
    ds_read_b128 a[220:223], v216 offset:37888
    v_mfma_f32_16x16x32_bf16 v[44:47], a[244:247], a[20:23], v[44:47]
    ds_read_b128 a[224:227], v216 offset:38912
    v_mfma_f32_16x16x32_bf16 v[48:51], a[248:251], a[20:23], v[48:51]
    ds_read_b128 a[228:231], v216 offset:39936
    s_waitcnt vmcnt(8) lgkmcnt(5)
    v_mfma_f32_16x16x32_bf16 v[32:35], a[192:195], a[24:27], v[32:35]
    ds_read_b128 a[232:235], v216 offset:40960
    buffer_load_dwordx4 a[60:63], v4, s[28:31], s54 offen offset:3072 sc1
    v_mfma_f32_16x16x32_bf16 v[36:39], a[196:199], a[24:27], v[36:39]
    ds_read_b128 a[236:239], v216 offset:41984
    v_mfma_f32_16x16x32_bf16 v[40:43], a[200:203], a[24:27], v[40:43]
    ds_read_b128 a[240:243], v216 offset:43008
    v_mfma_f32_16x16x32_bf16 v[44:47], a[204:207], a[24:27], v[44:47]
    ds_read_b128 a[244:247], v216 offset:44032
    v_mfma_f32_16x16x32_bf16 v[48:51], a[208:211], a[24:27], v[48:51]
    ds_read_b128 a[248:251], v216 offset:45056
    s_waitcnt vmcnt(8) lgkmcnt(5)
    s_add_u32 s54, s54, 4096
    v_mfma_f32_16x16x32_bf16 v[32:35], a[212:215], a[28:31], v[32:35]
    ds_read_b128 a[192:195], v216 offset:46080
    buffer_load_dwordx4 a[64:67], v4, s[28:31], s54 offen offset:0 sc1
    v_mfma_f32_16x16x32_bf16 v[36:39], a[216:219], a[28:31], v[36:39]
    ds_read_b128 a[196:199], v216 offset:47104
    v_mfma_f32_16x16x32_bf16 v[40:43], a[220:223], a[28:31], v[40:43]
    ds_read_b128 a[200:203], v216 offset:48128
    v_mfma_f32_16x16x32_bf16 v[44:47], a[224:227], a[28:31], v[44:47]
    ds_read_b128 a[204:207], v216 offset:49152
    v_mfma_f32_16x16x32_bf16 v[48:51], a[228:231], a[28:31], v[48:51]
    ds_read_b128 a[208:211], v216 offset:50176
    s_waitcnt vmcnt(8) lgkmcnt(5)
    v_mfma_f32_16x16x32_bf16 v[32:35], a[232:235], a[32:35], v[32:35]
    ds_read_b128 a[212:215], v216 offset:51200
    buffer_load_dwordx4 a[68:71], v4, s[28:31], s54 offen offset:1024 sc1
    v_mfma_f32_16x16x32_bf16 v[36:39], a[236:239], a[32:35], v[36:39]
    ds_read_b128 a[216:219], v216 offset:52224
    v_mfma_f32_16x16x32_bf16 v[40:43], a[240:243], a[32:35], v[40:43]
    ds_read_b128 a[220:223], v216 offset:53248
    v_mfma_f32_16x16x32_bf16 v[44:47], a[244:247], a[32:35], v[44:47]
    ds_read_b128 a[224:227], v216 offset:54272
    v_mfma_f32_16x16x32_bf16 v[48:51], a[248:251], a[32:35], v[48:51]
    ds_read_b128 a[228:231], v216 offset:55296
    s_barrier
    s_waitcnt vmcnt(8) lgkmcnt(5)
    v_mfma_f32_16x16x32_bf16 v[32:35], a[192:195], a[36:39], v[32:35]
    ds_read_b128 a[232:235], v216 offset:56320
    buffer_load_dwordx4 a[72:75], v4, s[28:31], s54 offen offset:2048 sc1
    v_mfma_f32_16x16x32_bf16 v[36:39], a[196:199], a[36:39], v[36:39]
    ds_read_b128 a[236:239], v216 offset:57344
    s_mul_i32 s100, s36, 10240
    s_add_u32 s101, s100, s92
    s_sub_u32 s101, s101, s93
    s_add_u32 s101, s101, 0x28000
    s_add_u32 s100, s100, 0x0
    s_add_u32 m0, s100, 0x0
    s_add_u32 s62, s101, 0x0
    v_mfma_f32_16x16x32_bf16 v[40:43], a[200:203], a[36:39], v[40:43]
    ds_read_b128 a[240:243], v216 offset:58368
    buffer_load_dwordx4 v4, s[28:31], s62 offen offset:0 sc1 lds
    v_mfma_f32_16x16x32_bf16 v[44:47], a[204:207], a[36:39], v[44:47]
    ds_read_b128 a[244:247], v216 offset:59392
    v_mfma_f32_16x16x32_bf16 v[48:51], a[208:211], a[36:39], v[48:51]
    ds_read_b128 a[248:251], v216 offset:60416
    s_waitcnt vmcnt(9) lgkmcnt(5)
    v_mfma_f32_16x16x32_bf16 v[32:35], a[212:215], a[40:43], v[32:35]
    ds_read_b128 a[192:195], v216 offset:61440
    buffer_load_dwordx4 a[76:79], v4, s[28:31], s54 offen offset:3072 sc1
    v_mfma_f32_16x16x32_bf16 v[36:39], a[216:219], a[40:43], v[36:39]
    ds_read_b128 a[196:199], v216 offset:62464
    v_mfma_f32_16x16x32_bf16 v[40:43], a[220:223], a[40:43], v[40:43]
    ds_read_b128 a[200:203], v216 offset:63488
    buffer_load_dwordx4 v4, s[28:31], s62 offen offset:1024 sc1 lds
    v_mfma_f32_16x16x32_bf16 v[44:47], a[224:227], a[40:43], v[44:47]
    ds_read_b128 a[204:207], v216 offset:64512
    v_mfma_f32_16x16x32_bf16 v[48:51], a[228:231], a[40:43], v[48:51]
    ds_read_b128 a[208:211], v217 offset:0
    s_waitcnt vmcnt(10) lgkmcnt(5)
    s_add_u32 s54, s54, 4096
    v_mfma_f32_16x16x32_bf16 v[32:35], a[232:235], a[44:47], v[32:35]
    ds_read_b128 a[212:215], v217 offset:1024
    buffer_load_dwordx4 a[80:83], v4, s[28:31], s54 offen offset:0 sc1
    v_mfma_f32_16x16x32_bf16 v[36:39], a[236:239], a[44:47], v[36:39]
    ds_read_b128 a[216:219], v217 offset:2048
    v_mfma_f32_16x16x32_bf16 v[40:43], a[240:243], a[44:47], v[40:43]
    ds_read_b128 a[220:223], v217 offset:3072
    buffer_load_dwordx4 v4, s[28:31], s62 offen offset:2048 sc1 lds
    v_mfma_f32_16x16x32_bf16 v[44:47], a[244:247], a[44:47], v[44:47]
    ds_read_b128 a[224:227], v217 offset:4096
    v_mfma_f32_16x16x32_bf16 v[48:51], a[248:251], a[44:47], v[48:51]
    ds_read_b128 a[228:231], v217 offset:5120
    s_waitcnt vmcnt(11) lgkmcnt(5)
    v_mfma_f32_16x16x32_bf16 v[32:35], a[192:195], a[48:51], v[32:35]
    ds_read_b128 a[232:235], v217 offset:6144
    buffer_load_dwordx4 a[84:87], v4, s[28:31], s54 offen offset:1024 sc1
    v_mfma_f32_16x16x32_bf16 v[36:39], a[196:199], a[48:51], v[36:39]
    ds_read_b128 a[236:239], v217 offset:7168
    v_mfma_f32_16x16x32_bf16 v[40:43], a[200:203], a[48:51], v[40:43]
    ds_read_b128 a[240:243], v217 offset:8192
    buffer_load_dwordx4 v4, s[28:31], s62 offen offset:3072 sc1 lds
    v_mfma_f32_16x16x32_bf16 v[44:47], a[204:207], a[48:51], v[44:47]
    ds_read_b128 a[244:247], v217 offset:9216
    v_mfma_f32_16x16x32_bf16 v[48:51], a[208:211], a[48:51], v[48:51]
    ds_read_b128 a[248:251], v217 offset:10240
    s_waitcnt vmcnt(12) lgkmcnt(5)
    v_mfma_f32_16x16x32_bf16 v[32:35], a[212:215], a[52:55], v[32:35]
    ds_read_b128 a[192:195], v217 offset:11264
    buffer_load_dwordx4 a[88:91], v4, s[28:31], s54 offen offset:2048 sc1
    v_mfma_f32_16x16x32_bf16 v[36:39], a[216:219], a[52:55], v[36:39]
    ds_read_b128 a[196:199], v217 offset:12288
    s_add_u32 m0, s100, 0x1000
    s_add_u32 s62, s101, 0x1000
    v_mfma_f32_16x16x32_bf16 v[40:43], a[220:223], a[52:55], v[40:43]
    ds_read_b128 a[200:203], v217 offset:13312
    buffer_load_dwordx4 v4, s[28:31], s62 offen offset:0 sc1 lds
    v_mfma_f32_16x16x32_bf16 v[44:47], a[224:227], a[52:55], v[44:47]
    ds_read_b128 a[204:207], v217 offset:14336
    v_mfma_f32_16x16x32_bf16 v[48:51], a[228:231], a[52:55], v[48:51]
    ds_read_b128 a[208:211], v217 offset:15360
    s_waitcnt vmcnt(13) lgkmcnt(5)
    v_mfma_f32_16x16x32_bf16 v[32:35], a[232:235], a[56:59], v[32:35]
    ds_read_b128 a[212:215], v217 offset:16384
    buffer_load_dwordx4 a[92:95], v4, s[28:31], s54 offen offset:3072 sc1
    v_mfma_f32_16x16x32_bf16 v[36:39], a[236:239], a[56:59], v[36:39]
    ds_read_b128 a[216:219], v217 offset:17408
    v_mfma_f32_16x16x32_bf16 v[40:43], a[240:243], a[56:59], v[40:43]
    ds_read_b128 a[220:223], v217 offset:18432
    buffer_load_dwordx4 v4, s[28:31], s62 offen offset:1024 sc1 lds
    v_mfma_f32_16x16x32_bf16 v[44:47], a[244:247], a[56:59], v[44:47]
    ds_read_b128 a[224:227], v217 offset:19456
    v_mfma_f32_16x16x32_bf16 v[48:51], a[248:251], a[56:59], v[48:51]
    ds_read_b128 a[228:231], v217 offset:20480
    s_waitcnt vmcnt(14) lgkmcnt(5)
    s_add_u32 s54, s54, 4096
    v_mfma_f32_16x16x32_bf16 v[32:35], a[192:195], a[60:63], v[32:35]
    ds_read_b128 a[232:235], v217 offset:21504
    buffer_load_dwordx4 a[96:99], v4, s[28:31], s54 offen offset:0 sc1
    v_mfma_f32_16x16x32_bf16 v[36:39], a[196:199], a[60:63], v[36:39]
    ds_read_b128 a[236:239], v217 offset:22528
    v_mfma_f32_16x16x32_bf16 v[40:43], a[200:203], a[60:63], v[40:43]
    ds_read_b128 a[240:243], v217 offset:23552
    buffer_load_dwordx4 v4, s[28:31], s62 offen offset:2048 sc1 lds
    v_mfma_f32_16x16x32_bf16 v[44:47], a[204:207], a[60:63], v[44:47]
    ds_read_b128 a[244:247], v217 offset:24576
    v_mfma_f32_16x16x32_bf16 v[48:51], a[208:211], a[60:63], v[48:51]
    ds_read_b128 a[248:251], v217 offset:25600
    s_waitcnt vmcnt(15) lgkmcnt(5)
    v_mfma_f32_16x16x32_bf16 v[32:35], a[212:215], a[64:67], v[32:35]
    ds_read_b128 a[192:195], v217 offset:26624
    buffer_load_dwordx4 a[100:103], v4, s[28:31], s54 offen offset:1024 sc1
    v_mfma_f32_16x16x32_bf16 v[36:39], a[216:219], a[64:67], v[36:39]
    ds_read_b128 a[196:199], v217 offset:27648
    v_mfma_f32_16x16x32_bf16 v[40:43], a[220:223], a[64:67], v[40:43]
    ds_read_b128 a[200:203], v217 offset:28672
    buffer_load_dwordx4 v4, s[28:31], s62 offen offset:3072 sc1 lds
    v_mfma_f32_16x16x32_bf16 v[44:47], a[224:227], a[64:67], v[44:47]
    ds_read_b128 a[204:207], v217 offset:29696
    v_mfma_f32_16x16x32_bf16 v[48:51], a[228:231], a[64:67], v[48:51]
    ds_read_b128 a[208:211], v217 offset:30720
    s_waitcnt vmcnt(16) lgkmcnt(5)
    v_mfma_f32_16x16x32_bf16 v[32:35], a[232:235], a[68:71], v[32:35]
    ds_read_b128 a[212:215], v217 offset:31744
    buffer_load_dwordx4 a[104:107], v4, s[28:31], s54 offen offset:2048 sc1
    v_mfma_f32_16x16x32_bf16 v[36:39], a[236:239], a[68:71], v[36:39]
    ds_read_b128 a[216:219], v217 offset:32768
    s_add_u32 m0, s100, 0x2000
    s_add_u32 s62, s101, 0x2000
    v_mfma_f32_16x16x32_bf16 v[40:43], a[240:243], a[68:71], v[40:43]
    ds_read_b128 a[220:223], v217 offset:33792
    buffer_load_dwordx4 v4, s[28:31], s62 offen offset:0 sc1 lds
    v_mfma_f32_16x16x32_bf16 v[44:47], a[244:247], a[68:71], v[44:47]
    ds_read_b128 a[224:227], v217 offset:34816
    v_mfma_f32_16x16x32_bf16 v[48:51], a[248:251], a[68:71], v[48:51]
    ds_read_b128 a[228:231], v217 offset:35840
    s_waitcnt vmcnt(17) lgkmcnt(5)
    v_mfma_f32_16x16x32_bf16 v[32:35], a[192:195], a[72:75], v[32:35]
    ds_read_b128 a[232:235], v217 offset:36864
    buffer_load_dwordx4 a[108:111], v4, s[28:31], s54 offen offset:3072 sc1
    v_mfma_f32_16x16x32_bf16 v[36:39], a[196:199], a[72:75], v[36:39]
    ds_read_b128 a[236:239], v217 offset:37888
    v_mfma_f32_16x16x32_bf16 v[40:43], a[200:203], a[72:75], v[40:43]
    ds_read_b128 a[240:243], v217 offset:38912
    buffer_load_dwordx4 v4, s[28:31], s62 offen offset:1024 sc1 lds
    v_mfma_f32_16x16x32_bf16 v[44:47], a[204:207], a[72:75], v[44:47]
    ds_read_b128 a[244:247], v217 offset:39936
    v_mfma_f32_16x16x32_bf16 v[48:51], a[208:211], a[72:75], v[48:51]
    ds_read_b128 a[248:251], v217 offset:40960
    s_barrier
    s_waitcnt vmcnt(17) lgkmcnt(5)
    s_add_u32 s54, s54, 4096
    v_mfma_f32_16x16x32_bf16 v[32:35], a[212:215], a[76:79], v[32:35]
    ds_read_b128 a[192:195], v217 offset:41984
    buffer_load_dwordx4 a[112:115], v4, s[28:31], s54 offen offset:0 sc1
    v_mfma_f32_16x16x32_bf16 v[36:39], a[216:219], a[76:79], v[36:39]
    ds_read_b128 a[196:199], v217 offset:43008
    s_mul_i32 s100, s36, 10240
    s_add_u32 s101, s100, s92
    s_sub_u32 s101, s101, s93
    s_add_u32 s101, s101, 0x32000
    s_add_u32 s100, s100, 0xa000
    s_add_u32 m0, s100, 0x0
    s_add_u32 s62, s101, 0x0
    v_mfma_f32_16x16x32_bf16 v[40:43], a[220:223], a[76:79], v[40:43]
    ds_read_b128 a[200:203], v217 offset:44032
    buffer_load_dwordx4 v4, s[28:31], s62 offen offset:0 sc1 lds
    v_mfma_f32_16x16x32_bf16 v[44:47], a[224:227], a[76:79], v[44:47]
    ds_read_b128 a[204:207], v217 offset:45056
    v_mfma_f32_16x16x32_bf16 v[48:51], a[228:231], a[76:79], v[48:51]
    ds_read_b128 a[208:211], v217 offset:46080
    s_waitcnt vmcnt(17) lgkmcnt(5)
    v_mfma_f32_16x16x32_bf16 v[32:35], a[232:235], a[80:83], v[32:35]
    ds_read_b128 a[212:215], v217 offset:47104
    buffer_load_dwordx4 a[116:119], v4, s[28:31], s54 offen offset:1024 sc1
    v_mfma_f32_16x16x32_bf16 v[36:39], a[236:239], a[80:83], v[36:39]
    ds_read_b128 a[216:219], v217 offset:48128
    v_mfma_f32_16x16x32_bf16 v[40:43], a[240:243], a[80:83], v[40:43]
    ds_read_b128 a[220:223], v217 offset:49152
    buffer_load_dwordx4 v4, s[28:31], s62 offen offset:1024 sc1 lds
    v_mfma_f32_16x16x32_bf16 v[44:47], a[244:247], a[80:83], v[44:47]
    ds_read_b128 a[224:227], v217 offset:50176
    v_mfma_f32_16x16x32_bf16 v[48:51], a[248:251], a[80:83], v[48:51]
    ds_read_b128 a[228:231], v217 offset:51200
    s_waitcnt vmcnt(17) lgkmcnt(5)
    v_mfma_f32_16x16x32_bf16 v[32:35], a[192:195], a[84:87], v[32:35]
    ds_read_b128 a[232:235], v217 offset:52224
    buffer_load_dwordx4 a[120:123], v4, s[28:31], s54 offen offset:2048 sc1
    v_mfma_f32_16x16x32_bf16 v[36:39], a[196:199], a[84:87], v[36:39]
    ds_read_b128 a[236:239], v217 offset:53248
    v_mfma_f32_16x16x32_bf16 v[40:43], a[200:203], a[84:87], v[40:43]
    ds_read_b128 a[240:243], v217 offset:54272
    buffer_load_dwordx4 v4, s[28:31], s62 offen offset:2048 sc1 lds
    v_mfma_f32_16x16x32_bf16 v[44:47], a[204:207], a[84:87], v[44:47]
    ds_read_b128 a[244:247], v217 offset:55296
    v_mfma_f32_16x16x32_bf16 v[48:51], a[208:211], a[84:87], v[48:51]
    ds_read_b128 a[248:251], v217 offset:56320
    s_waitcnt vmcnt(17) lgkmcnt(5)
    v_mfma_f32_16x16x32_bf16 v[32:35], a[212:215], a[88:91], v[32:35]
    ds_read_b128 a[192:195], v217 offset:57344
    buffer_load_dwordx4 a[124:127], v4, s[28:31], s54 offen offset:3072 sc1
    v_mfma_f32_16x16x32_bf16 v[36:39], a[216:219], a[88:91], v[36:39]
    ds_read_b128 a[196:199], v217 offset:58368
    v_mfma_f32_16x16x32_bf16 v[40:43], a[220:223], a[88:91], v[40:43]
    ds_read_b128 a[200:203], v217 offset:59392
    buffer_load_dwordx4 v4, s[28:31], s62 offen offset:3072 sc1 lds
    v_mfma_f32_16x16x32_bf16 v[44:47], a[224:227], a[88:91], v[44:47]
    ds_read_b128 a[204:207], v217 offset:60416
    v_mfma_f32_16x16x32_bf16 v[48:51], a[228:231], a[88:91], v[48:51]
    ds_read_b128 a[208:211], v217 offset:61440
    s_waitcnt vmcnt(17) lgkmcnt(5)
    s_add_u32 s54, s54, 4096
    v_mfma_f32_16x16x32_bf16 v[32:35], a[232:235], a[92:95], v[32:35]
    ds_read_b128 a[212:215], v217 offset:62464
    buffer_load_dwordx4 a[128:131], v4, s[28:31], s54 offen offset:0 sc1
    v_mfma_f32_16x16x32_bf16 v[36:39], a[236:239], a[92:95], v[36:39]
    ds_read_b128 a[216:219], v217 offset:63488
    s_add_u32 m0, s100, 0x1000
    s_add_u32 s62, s101, 0x1000
    v_mfma_f32_16x16x32_bf16 v[40:43], a[240:243], a[92:95], v[40:43]
    ds_read_b128 a[220:223], v217 offset:64512
    buffer_load_dwordx4 v4, s[28:31], s62 offen offset:0 sc1 lds
    v_mfma_f32_16x16x32_bf16 v[44:47], a[244:247], a[92:95], v[44:47]
    ds_read_b128 a[224:227], v218 offset:0
    v_mfma_f32_16x16x32_bf16 v[48:51], a[248:251], a[92:95], v[48:51]
    ds_read_b128 a[228:231], v218 offset:1024
    s_waitcnt vmcnt(17) lgkmcnt(5)
    v_mfma_f32_16x16x32_bf16 v[32:35], a[192:195], a[96:99], v[32:35]
    ds_read_b128 a[232:235], v218 offset:2048
    buffer_load_dwordx4 a[132:135], v4, s[28:31], s54 offen offset:1024 sc1
    v_mfma_f32_16x16x32_bf16 v[36:39], a[196:199], a[96:99], v[36:39]
    ds_read_b128 a[236:239], v218 offset:3072
    v_mfma_f32_16x16x32_bf16 v[40:43], a[200:203], a[96:99], v[40:43]
    ds_read_b128 a[240:243], v218 offset:4096
    buffer_load_dwordx4 v4, s[28:31], s62 offen offset:1024 sc1 lds
    v_mfma_f32_16x16x32_bf16 v[44:47], a[204:207], a[96:99], v[44:47]
    ds_read_b128 a[244:247], v218 offset:5120
    v_mfma_f32_16x16x32_bf16 v[48:51], a[208:211], a[96:99], v[48:51]
    ds_read_b128 a[248:251], v218 offset:6144
    s_waitcnt vmcnt(17) lgkmcnt(5)
    v_mfma_f32_16x16x32_bf16 v[32:35], a[212:215], a[100:103], v[32:35]
    ds_read_b128 a[192:195], v218 offset:7168
    buffer_load_dwordx4 a[136:139], v4, s[28:31], s54 offen offset:2048 sc1
    v_mfma_f32_16x16x32_bf16 v[36:39], a[216:219], a[100:103], v[36:39]
    ds_read_b128 a[196:199], v218 offset:8192
    v_mfma_f32_16x16x32_bf16 v[40:43], a[220:223], a[100:103], v[40:43]
    ds_read_b128 a[200:203], v218 offset:9216
    buffer_load_dwordx4 v4, s[28:31], s62 offen offset:2048 sc1 lds
    v_mfma_f32_16x16x32_bf16 v[44:47], a[224:227], a[100:103], v[44:47]
    ds_read_b128 a[204:207], v218 offset:10240
    v_mfma_f32_16x16x32_bf16 v[48:51], a[228:231], a[100:103], v[48:51]
    ds_read_b128 a[208:211], v218 offset:11264
    s_waitcnt vmcnt(17) lgkmcnt(5)
    v_mfma_f32_16x16x32_bf16 v[32:35], a[232:235], a[104:107], v[32:35]
    ds_read_b128 a[212:215], v218 offset:12288
    buffer_load_dwordx4 a[140:143], v4, s[28:31], s54 offen offset:3072 sc1
    v_mfma_f32_16x16x32_bf16 v[36:39], a[236:239], a[104:107], v[36:39]
    ds_read_b128 a[216:219], v218 offset:13312
    v_mfma_f32_16x16x32_bf16 v[40:43], a[240:243], a[104:107], v[40:43]
    ds_read_b128 a[220:223], v218 offset:14336
    buffer_load_dwordx4 v4, s[28:31], s62 offen offset:3072 sc1 lds
    v_mfma_f32_16x16x32_bf16 v[44:47], a[244:247], a[104:107], v[44:47]
    ds_read_b128 a[224:227], v218 offset:15360
    v_mfma_f32_16x16x32_bf16 v[48:51], a[248:251], a[104:107], v[48:51]
    ds_read_b128 a[228:231], v218 offset:16384
    s_waitcnt vmcnt(17) lgkmcnt(5)
    s_add_u32 s54, s54, 4096
    v_mfma_f32_16x16x32_bf16 v[32:35], a[192:195], a[108:111], v[32:35]
    ds_read_b128 a[232:235], v218 offset:17408
    buffer_load_dwordx4 a[144:147], v4, s[28:31], s54 offen offset:0 sc1
    v_mfma_f32_16x16x32_bf16 v[36:39], a[196:199], a[108:111], v[36:39]
    ds_read_b128 a[236:239], v218 offset:18432
    s_add_u32 m0, s100, 0x2000
    s_add_u32 s62, s101, 0x2000
    v_mfma_f32_16x16x32_bf16 v[40:43], a[200:203], a[108:111], v[40:43]
    ds_read_b128 a[240:243], v218 offset:19456
    buffer_load_dwordx4 v4, s[28:31], s62 offen offset:0 sc1 lds
    v_mfma_f32_16x16x32_bf16 v[44:47], a[204:207], a[108:111], v[44:47]
    ds_read_b128 a[244:247], v218 offset:20480
    v_mfma_f32_16x16x32_bf16 v[48:51], a[208:211], a[108:111], v[48:51]
    ds_read_b128 a[248:251], v218 offset:21504
    s_waitcnt vmcnt(17) lgkmcnt(5)
    v_mfma_f32_16x16x32_bf16 v[32:35], a[212:215], a[112:115], v[32:35]
    ds_read_b128 a[192:195], v218 offset:22528
    buffer_load_dwordx4 a[148:151], v4, s[28:31], s54 offen offset:1024 sc1
    v_mfma_f32_16x16x32_bf16 v[36:39], a[216:219], a[112:115], v[36:39]
    ds_read_b128 a[196:199], v218 offset:23552
    v_mfma_f32_16x16x32_bf16 v[40:43], a[220:223], a[112:115], v[40:43]
    ds_read_b128 a[200:203], v218 offset:24576
    buffer_load_dwordx4 v4, s[28:31], s62 offen offset:1024 sc1 lds
    v_mfma_f32_16x16x32_bf16 v[44:47], a[224:227], a[112:115], v[44:47]
    ds_read_b128 a[204:207], v218 offset:25600
    v_mfma_f32_16x16x32_bf16 v[48:51], a[228:231], a[112:115], v[48:51]
    ds_read_b128 a[208:211], v218 offset:26624
    s_waitcnt vmcnt(17) lgkmcnt(5)
    v_mfma_f32_16x16x32_bf16 v[32:35], a[232:235], a[116:119], v[32:35]
    ds_read_b128 a[212:215], v218 offset:27648
    buffer_load_dwordx4 a[152:155], v4, s[28:31], s54 offen offset:2048 sc1
    v_mfma_f32_16x16x32_bf16 v[36:39], a[236:239], a[116:119], v[36:39]
    ds_read_b128 a[216:219], v218 offset:28672
    v_mfma_f32_16x16x32_bf16 v[40:43], a[240:243], a[116:119], v[40:43]
    ds_read_b128 a[220:223], v218 offset:29696
    v_mfma_f32_16x16x32_bf16 v[44:47], a[244:247], a[116:119], v[44:47]
    ds_read_b128 a[224:227], v218 offset:30720
    v_mfma_f32_16x16x32_bf16 v[48:51], a[248:251], a[116:119], v[48:51]
    ds_read_b128 a[228:231], v218 offset:31744
    s_waitcnt vmcnt(21)
    s_barrier
    s_waitcnt vmcnt(16) lgkmcnt(5)
    v_mfma_f32_16x16x32_bf16 v[32:35], a[192:195], a[120:123], v[32:35]
    ds_read_b128 a[232:235], v216 offset:0
    buffer_load_dwordx4 a[156:159], v4, s[28:31], s54 offen offset:3072 sc1
    v_mfma_f32_16x16x32_bf16 v[36:39], a[196:199], a[120:123], v[36:39]
    ds_read_b128 a[236:239], v216 offset:1024
    v_mfma_f32_16x16x32_bf16 v[40:43], a[200:203], a[120:123], v[40:43]
    ds_read_b128 a[240:243], v216 offset:2048
    v_mfma_f32_16x16x32_bf16 v[44:47], a[204:207], a[120:123], v[44:47]
    ds_read_b128 a[244:247], v216 offset:3072
    v_mfma_f32_16x16x32_bf16 v[48:51], a[208:211], a[120:123], v[48:51]
    ds_read_b128 a[248:251], v216 offset:4096
    s_waitcnt vmcnt(15) lgkmcnt(5)
    s_add_u32 s54, s54, 4096
    v_mfma_f32_16x16x32_bf16 v[32:35], a[212:215], a[124:127], v[32:35]
    ds_read_b128 a[192:195], v216 offset:5120
    buffer_load_dwordx4 a[160:163], v4, s[28:31], s54 offen offset:0 sc1
    v_mfma_f32_16x16x32_bf16 v[36:39], a[216:219], a[124:127], v[36:39]
    ds_read_b128 a[196:199], v216 offset:6144
    v_mfma_f32_16x16x32_bf16 v[40:43], a[220:223], a[124:127], v[40:43]
    ds_read_b128 a[200:203], v216 offset:7168
    v_mfma_f32_16x16x32_bf16 v[44:47], a[224:227], a[124:127], v[44:47]
    ds_read_b128 a[204:207], v216 offset:8192
    v_mfma_f32_16x16x32_bf16 v[48:51], a[228:231], a[124:127], v[48:51]
    ds_read_b128 a[208:211], v216 offset:9216
    s_waitcnt vmcnt(14) lgkmcnt(5)
    v_mfma_f32_16x16x32_bf16 v[32:35], a[232:235], a[128:131], v[32:35]
    ds_read_b128 a[212:215], v216 offset:10240
    buffer_load_dwordx4 a[164:167], v4, s[28:31], s54 offen offset:1024 sc1
    v_mfma_f32_16x16x32_bf16 v[36:39], a[236:239], a[128:131], v[36:39]
    ds_read_b128 a[216:219], v216 offset:11264
    v_mfma_f32_16x16x32_bf16 v[40:43], a[240:243], a[128:131], v[40:43]
    ds_read_b128 a[220:223], v216 offset:12288
    v_mfma_f32_16x16x32_bf16 v[44:47], a[244:247], a[128:131], v[44:47]
    ds_read_b128 a[224:227], v216 offset:13312
    v_mfma_f32_16x16x32_bf16 v[48:51], a[248:251], a[128:131], v[48:51]
    ds_read_b128 a[228:231], v216 offset:14336
    s_waitcnt vmcnt(13) lgkmcnt(5)
    v_mfma_f32_16x16x32_bf16 v[32:35], a[192:195], a[132:135], v[32:35]
    ds_read_b128 a[232:235], v216 offset:15360
    buffer_load_dwordx4 a[168:171], v4, s[28:31], s54 offen offset:2048 sc1
    v_mfma_f32_16x16x32_bf16 v[36:39], a[196:199], a[132:135], v[36:39]
    ds_read_b128 a[236:239], v216 offset:16384
    v_mfma_f32_16x16x32_bf16 v[40:43], a[200:203], a[132:135], v[40:43]
    ds_read_b128 a[240:243], v216 offset:17408
    v_mfma_f32_16x16x32_bf16 v[44:47], a[204:207], a[132:135], v[44:47]
    ds_read_b128 a[244:247], v216 offset:18432
    v_mfma_f32_16x16x32_bf16 v[48:51], a[208:211], a[132:135], v[48:51]
    ds_read_b128 a[248:251], v216 offset:19456
    s_waitcnt vmcnt(12) lgkmcnt(5)
    v_mfma_f32_16x16x32_bf16 v[32:35], a[212:215], a[136:139], v[32:35]
    ds_read_b128 a[192:195], v216 offset:20480
    buffer_load_dwordx4 a[172:175], v4, s[28:31], s54 offen offset:3072 sc1
    v_mfma_f32_16x16x32_bf16 v[36:39], a[216:219], a[136:139], v[36:39]
    ds_read_b128 a[196:199], v216 offset:21504
    v_mfma_f32_16x16x32_bf16 v[40:43], a[220:223], a[136:139], v[40:43]
    ds_read_b128 a[200:203], v216 offset:22528
    v_mfma_f32_16x16x32_bf16 v[44:47], a[224:227], a[136:139], v[44:47]
    ds_read_b128 a[204:207], v216 offset:23552
    v_mfma_f32_16x16x32_bf16 v[48:51], a[228:231], a[136:139], v[48:51]
    ds_read_b128 a[208:211], v216 offset:24576
    s_waitcnt vmcnt(11) lgkmcnt(5)
    s_add_u32 s54, s54, 4096
    v_mfma_f32_16x16x32_bf16 v[32:35], a[232:235], a[140:143], v[32:35]
    ds_read_b128 a[212:215], v216 offset:25600
    buffer_load_dwordx4 a[176:179], v4, s[28:31], s54 offen offset:0 sc1
    v_mfma_f32_16x16x32_bf16 v[36:39], a[236:239], a[140:143], v[36:39]
    ds_read_b128 a[216:219], v216 offset:26624
    v_mfma_f32_16x16x32_bf16 v[40:43], a[240:243], a[140:143], v[40:43]
    ds_read_b128 a[220:223], v216 offset:27648
    v_mfma_f32_16x16x32_bf16 v[44:47], a[244:247], a[140:143], v[44:47]
    ds_read_b128 a[224:227], v216 offset:28672
    v_mfma_f32_16x16x32_bf16 v[48:51], a[248:251], a[140:143], v[48:51]
    ds_read_b128 a[228:231], v216 offset:29696
    s_waitcnt vmcnt(10) lgkmcnt(5)
    v_mfma_f32_16x16x32_bf16 v[32:35], a[192:195], a[144:147], v[32:35]
    ds_read_b128 a[232:235], v216 offset:30720
    buffer_load_dwordx4 a[180:183], v4, s[28:31], s54 offen offset:1024 sc1
    v_mfma_f32_16x16x32_bf16 v[36:39], a[196:199], a[144:147], v[36:39]
    ds_read_b128 a[236:239], v216 offset:31744
    v_mfma_f32_16x16x32_bf16 v[40:43], a[200:203], a[144:147], v[40:43]
    ds_read_b128 a[240:243], v216 offset:32768
    v_mfma_f32_16x16x32_bf16 v[44:47], a[204:207], a[144:147], v[44:47]
    ds_read_b128 a[244:247], v216 offset:33792
    v_mfma_f32_16x16x32_bf16 v[48:51], a[208:211], a[144:147], v[48:51]
    ds_read_b128 a[248:251], v216 offset:34816
    s_waitcnt vmcnt(9) lgkmcnt(5)
    v_mfma_f32_16x16x32_bf16 v[32:35], a[212:215], a[148:151], v[32:35]
    ds_read_b128 a[192:195], v216 offset:35840
    buffer_load_dwordx4 a[184:187], v4, s[28:31], s54 offen offset:2048 sc1
    v_mfma_f32_16x16x32_bf16 v[36:39], a[216:219], a[148:151], v[36:39]
    ds_read_b128 a[196:199], v216 offset:36864
    v_mfma_f32_16x16x32_bf16 v[40:43], a[220:223], a[148:151], v[40:43]
    ds_read_b128 a[200:203], v216 offset:37888
    v_mfma_f32_16x16x32_bf16 v[44:47], a[224:227], a[148:151], v[44:47]
    ds_read_b128 a[204:207], v216 offset:38912
    v_mfma_f32_16x16x32_bf16 v[48:51], a[228:231], a[148:151], v[48:51]
    ds_read_b128 a[208:211], v216 offset:39936
    s_waitcnt vmcnt(9)
    s_barrier
    s_waitcnt vmcnt(8) lgkmcnt(5)
    v_mfma_f32_16x16x32_bf16 v[32:35], a[232:235], a[152:155], v[32:35]
    ds_read_b128 a[212:215], v216 offset:40960
    buffer_load_dwordx4 a[188:191], v4, s[28:31], s54 offen offset:3072 sc1
    v_mfma_f32_16x16x32_bf16 v[36:39], a[236:239], a[152:155], v[36:39]
    ds_read_b128 a[216:219], v216 offset:41984
    v_mfma_f32_16x16x32_bf16 v[40:43], a[240:243], a[152:155], v[40:43]
    ds_read_b128 a[220:223], v216 offset:43008
    v_mfma_f32_16x16x32_bf16 v[44:47], a[244:247], a[152:155], v[44:47]
    ds_read_b128 a[224:227], v216 offset:44032
    v_mfma_f32_16x16x32_bf16 v[48:51], a[248:251], a[152:155], v[48:51]
    ds_read_b128 a[228:231], v216 offset:45056
    s_waitcnt vmcnt(8) lgkmcnt(5)
    v_mfma_f32_16x16x32_bf16 v[32:35], a[192:195], a[156:159], v[32:35]
    ds_read_b128 a[232:235], v216 offset:46080
    v_mfma_f32_16x16x32_bf16 v[36:39], a[196:199], a[156:159], v[36:39]
    ds_read_b128 a[236:239], v216 offset:47104
    v_mfma_f32_16x16x32_bf16 v[40:43], a[200:203], a[156:159], v[40:43]
    ds_read_b128 a[240:243], v216 offset:48128
    v_mfma_f32_16x16x32_bf16 v[44:47], a[204:207], a[156:159], v[44:47]
    ds_read_b128 a[244:247], v216 offset:49152
    v_mfma_f32_16x16x32_bf16 v[48:51], a[208:211], a[156:159], v[48:51]
    ds_read_b128 a[248:251], v216 offset:50176
    s_waitcnt vmcnt(7) lgkmcnt(5)
    v_mfma_f32_16x16x32_bf16 v[32:35], a[212:215], a[160:163], v[32:35]
    ds_read_b128 a[192:195], v216 offset:51200
    v_mfma_f32_16x16x32_bf16 v[36:39], a[216:219], a[160:163], v[36:39]
    ds_read_b128 a[196:199], v216 offset:52224
    v_mfma_f32_16x16x32_bf16 v[40:43], a[220:223], a[160:163], v[40:43]
    ds_read_b128 a[200:203], v216 offset:53248
    v_mfma_f32_16x16x32_bf16 v[44:47], a[224:227], a[160:163], v[44:47]
    ds_read_b128 a[204:207], v216 offset:54272
    v_mfma_f32_16x16x32_bf16 v[48:51], a[228:231], a[160:163], v[48:51]
    ds_read_b128 a[208:211], v216 offset:55296
    s_waitcnt vmcnt(6) lgkmcnt(5)
    v_mfma_f32_16x16x32_bf16 v[32:35], a[232:235], a[164:167], v[32:35]
    ds_read_b128 a[212:215], v216 offset:56320
    v_mfma_f32_16x16x32_bf16 v[36:39], a[236:239], a[164:167], v[36:39]
    ds_read_b128 a[216:219], v216 offset:57344
    v_mfma_f32_16x16x32_bf16 v[40:43], a[240:243], a[164:167], v[40:43]
    ds_read_b128 a[220:223], v216 offset:58368
    v_mfma_f32_16x16x32_bf16 v[44:47], a[244:247], a[164:167], v[44:47]
    ds_read_b128 a[224:227], v216 offset:59392
    v_mfma_f32_16x16x32_bf16 v[48:51], a[248:251], a[164:167], v[48:51]
    ds_read_b128 a[228:231], v216 offset:60416
    s_waitcnt vmcnt(5) lgkmcnt(5)
    v_mfma_f32_16x16x32_bf16 v[32:35], a[192:195], a[168:171], v[32:35]
    ds_read_b128 a[232:235], v216 offset:61440
    v_mfma_f32_16x16x32_bf16 v[36:39], a[196:199], a[168:171], v[36:39]
    ds_read_b128 a[236:239], v216 offset:62464
    v_mfma_f32_16x16x32_bf16 v[40:43], a[200:203], a[168:171], v[40:43]
    ds_read_b128 a[240:243], v216 offset:63488
    v_mfma_f32_16x16x32_bf16 v[44:47], a[204:207], a[168:171], v[44:47]
    ds_read_b128 a[244:247], v216 offset:64512
    v_mfma_f32_16x16x32_bf16 v[48:51], a[208:211], a[168:171], v[48:51]
    ds_read_b128 a[248:251], v217 offset:0
    s_waitcnt vmcnt(4) lgkmcnt(5)
    v_mfma_f32_16x16x32_bf16 v[32:35], a[212:215], a[172:175], v[32:35]
    ds_read_b128 a[192:195], v217 offset:1024
    v_mfma_f32_16x16x32_bf16 v[36:39], a[216:219], a[172:175], v[36:39]
    ds_read_b128 a[196:199], v217 offset:2048
    v_mfma_f32_16x16x32_bf16 v[40:43], a[220:223], a[172:175], v[40:43]
    ds_read_b128 a[200:203], v217 offset:3072
    v_mfma_f32_16x16x32_bf16 v[44:47], a[224:227], a[172:175], v[44:47]
    ds_read_b128 a[204:207], v217 offset:4096
    v_mfma_f32_16x16x32_bf16 v[48:51], a[228:231], a[172:175], v[48:51]
    ds_read_b128 a[208:211], v217 offset:5120
    s_waitcnt vmcnt(3) lgkmcnt(5)
    v_mfma_f32_16x16x32_bf16 v[32:35], a[232:235], a[176:179], v[32:35]
    ds_read_b128 a[212:215], v217 offset:6144
    v_mfma_f32_16x16x32_bf16 v[36:39], a[236:239], a[176:179], v[36:39]
    ds_read_b128 a[216:219], v217 offset:7168
    v_mfma_f32_16x16x32_bf16 v[40:43], a[240:243], a[176:179], v[40:43]
    ds_read_b128 a[220:223], v217 offset:8192
    v_mfma_f32_16x16x32_bf16 v[44:47], a[244:247], a[176:179], v[44:47]
    ds_read_b128 a[224:227], v217 offset:9216
    v_mfma_f32_16x16x32_bf16 v[48:51], a[248:251], a[176:179], v[48:51]
    ds_read_b128 a[228:231], v217 offset:10240
    s_waitcnt vmcnt(2) lgkmcnt(5)
    v_mfma_f32_16x16x32_bf16 v[32:35], a[192:195], a[180:183], v[32:35]
    ds_read_b128 a[232:235], v217 offset:11264
    v_mfma_f32_16x16x32_bf16 v[36:39], a[196:199], a[180:183], v[36:39]
    ds_read_b128 a[236:239], v217 offset:12288
    v_mfma_f32_16x16x32_bf16 v[40:43], a[200:203], a[180:183], v[40:43]
    ds_read_b128 a[240:243], v217 offset:13312
    v_mfma_f32_16x16x32_bf16 v[44:47], a[204:207], a[180:183], v[44:47]
    ds_read_b128 a[244:247], v217 offset:14336
    v_mfma_f32_16x16x32_bf16 v[48:51], a[208:211], a[180:183], v[48:51]
    ds_read_b128 a[248:251], v217 offset:15360
    s_waitcnt vmcnt(1) lgkmcnt(5)
    v_mfma_f32_16x16x32_bf16 v[32:35], a[212:215], a[184:187], v[32:35]
    v_mfma_f32_16x16x32_bf16 v[36:39], a[216:219], a[184:187], v[36:39]
    v_mfma_f32_16x16x32_bf16 v[40:43], a[220:223], a[184:187], v[40:43]
    v_mfma_f32_16x16x32_bf16 v[44:47], a[224:227], a[184:187], v[44:47]
    v_mfma_f32_16x16x32_bf16 v[48:51], a[228:231], a[184:187], v[48:51]
    s_waitcnt vmcnt(0) lgkmcnt(0)
    v_mfma_f32_16x16x32_bf16 v[32:35], a[232:235], a[188:191], v[32:35]
    v_mfma_f32_16x16x32_bf16 v[36:39], a[236:239], a[188:191], v[36:39]
    v_mfma_f32_16x16x32_bf16 v[40:43], a[240:243], a[188:191], v[40:43]
    v_mfma_f32_16x16x32_bf16 v[44:47], a[244:247], a[188:191], v[44:47]
    v_mfma_f32_16x16x32_bf16 v[48:51], a[248:251], a[188:191], v[48:51]
    v_lshlrev_b32 v200, 16, v240
    v_and_b32 v201, 0xffff0000, v240
    s_nop 1
    v_pk_add_f32 v[32:33], v[32:33], v[200:201]
    v_cvt_pk_bf16_f32 v64, v32, v33
    v_lshlrev_b32 v200, 16, v241
    v_and_b32 v201, 0xffff0000, v241
    v_pk_add_f32 v[34:35], v[34:35], v[200:201]
    v_cvt_pk_bf16_f32 v65, v34, v35
    v_lshlrev_b32 v200, 16, v242
    v_and_b32 v201, 0xffff0000, v242
    v_pk_add_f32 v[36:37], v[36:37], v[200:201]
    v_cvt_pk_bf16_f32 v66, v36, v37
    v_lshlrev_b32 v200, 16, v243
    v_and_b32 v201, 0xffff0000, v243
    v_pk_add_f32 v[38:39], v[38:39], v[200:201]
    v_cvt_pk_bf16_f32 v67, v38, v39
    buffer_store_dwordx4 v[64:67], v20, s[24:27], 0 offen
    v_lshlrev_b32 v200, 16, v244
    v_and_b32 v201, 0xffff0000, v244
    v_pk_add_f32 v[40:41], v[40:41], v[200:201]
    v_cvt_pk_bf16_f32 v68, v40, v41
    v_lshlrev_b32 v200, 16, v245
    v_and_b32 v201, 0xffff0000, v245
    v_pk_add_f32 v[42:43], v[42:43], v[200:201]
    v_cvt_pk_bf16_f32 v69, v42, v43
    v_lshlrev_b32 v200, 16, v246
    v_and_b32 v201, 0xffff0000, v246
    v_pk_add_f32 v[44:45], v[44:45], v[200:201]
    v_cvt_pk_bf16_f32 v70, v44, v45
    v_lshlrev_b32 v200, 16, v247
    v_and_b32 v201, 0xffff0000, v247
    v_pk_add_f32 v[46:47], v[46:47], v[200:201]
    v_cvt_pk_bf16_f32 v71, v46, v47
    buffer_store_dwordx4 v[68:71], v20, s[24:27], 0 offen offset:64
    v_lshlrev_b32 v200, 16, v248
    v_and_b32 v201, 0xffff0000, v248
    v_pk_add_f32 v[48:49], v[48:49], v[200:201]
    v_cvt_pk_bf16_f32 v72, v48, v49
    v_lshlrev_b32 v200, 16, v249
    v_and_b32 v201, 0xffff0000, v249
    v_pk_add_f32 v[50:51], v[50:51], v[200:201]
    v_cvt_pk_bf16_f32 v73, v50, v51
    buffer_store_dwordx2 v[72:73], v21, s[24:27], 0 offen offset:128
    s_waitcnt vmcnt(0)
L_end:
    s_endpgm
.section .rodata,"a"
.p2align 6
.amdhsa_kernel sequential_preLN__sliding_block__dense_activation_silu__prompt_kernel
  .amdhsa_next_free_vgpr 512
  .amdhsa_next_free_sgpr 102
  .amdhsa_accum_offset 256
  .amdhsa_group_segment_fixed_size 0
  .amdhsa_kernarg_size 72
  .amdhsa_user_sgpr_count 2
  .amdhsa_user_sgpr_kernarg_segment_ptr 1
  .amdhsa_system_sgpr_workgroup_id_x 1
  .amdhsa_float_denorm_mode_32 3
.end_amdhsa_kernel
```
